```python
import torch

def _softmax(x, axis=-1):
    return torch.softmax(x, dim=axis)

def _gelu(x):
    return torch.nn.functional.gelu(x, approximate='tanh')

def _silu(x):
    return torch.nn.functional.silu(x)

def _sigmoid(x):
    return torch.sigmoid(x)

def _layernorm(x, axis=-1, eps=1e-05):
    m = x.mean(dim=axis, keepdim=True)
    v = x.var(dim=axis, keepdim=True, unbiased=False)
    return (x - m) / torch.sqrt(v + eps)

def _scatter_add(tgt, idx, src, axis=0):
    return tgt.clone().index_add_(axis, idx, src)

def _segment_sum(src, seg, n):
    out = torch.zeros((n,) + src.shape[1:], dtype=src.dtype)
    return out.index_add_(0, seg, src)

def _pad(x, pw):
    flat = tuple((v for pair in reversed(pw) for v in pair))
    return torch.nn.functional.pad(x, flat)
kernel_name = 'recurrent_scan__mha_block__mixer_gmlp__prompt'

def setup_inputs():

    _w = lambda a: (lambda t: t.to(torch.bfloat16) if t.is_floating_point() else t)(torch.as_tensor(a))

    def _A_setup():
        B, S, D, H = (1, 2048, 576, 32)
        return {'x': _w((lambda *s: torch.randn(*s, dtype=torch.bfloat16) * 0.05)(B, S, D)), 'wqkv': _w((lambda *s: torch.randn(*s, dtype=torch.bfloat16) * 0.05)(D, 3 * D)), 'wo': _w((lambda *s: torch.randn(*s, dtype=torch.bfloat16) * 0.05)(D, D))}
    _A_in = _A_setup()

    def _B_setup():
        B, S, D, F = (1, 2048, 576, 4608)
        Fh = F // 2
        return {'x': _w((lambda *s: torch.randn(*s, dtype=torch.bfloat16) * 0.05)(B, S, D)), 'w_in': _w((lambda *s: torch.randn(*s, dtype=torch.bfloat16) * 1.6)(D, 2 * Fh)), 'w_sp': _w(0.01 * (lambda *s: torch.randn(*s, dtype=torch.bfloat16) * 1.6)(S, S)), 'b_sp': _w(1.0 + 0.01 * (lambda *s: torch.randn(*s, dtype=torch.bfloat16) * 0.05)(S)), 'w_out': _w((lambda *s: torch.randn(*s, dtype=torch.bfloat16) * 0.05)(Fh, D))}
    _B_in = _B_setup()
    return {'A_x': _A_in['x'], 'A_wqkv': _A_in['wqkv'], 'A_wo': _A_in['wo'], 'B_x': _B_in['x'], 'B_w_in': _B_in['w_in'], 'B_w_sp': _B_in['w_sp'], 'B_b_sp': _B_in['b_sp'], 'B_w_out': _B_in['w_out']}

def reference(A_x, A_wqkv, A_wo, B_x, B_w_in, B_w_sp, B_b_sp, B_w_out):

    def _A_ref(x, wqkv, wo):
        B, S, D = x.shape
        H = 32
        Dh = D // H
        qkv = (lambda x, *d: x.permute(*d))((x @ wqkv).reshape(B, S, 3, H, Dh), 2, 0, 3, 1, 4)
        q, k, v = (qkv[0], qkv[1], qkv[2])
        scores = torch.einsum('bhqd,bhkd->bhqk', q, k) * Dh ** (-0.5)
        p = _softmax(scores, axis=-1)
        o = torch.einsum('bhqk,bhkd->bhqd', p, v)
        return (lambda x, *d: x.permute(*d))(o, 0, 2, 1, 3).reshape(B, S, D) @ wo

    def _B_ref(x, w_in, w_sp, b_sp, w_out):
        B, S, D = x.shape
        F = w_in.shape[-1]
        Fh = F // 2
        z = _gelu(torch.einsum('bsd,df->bsf', x, w_in))
        z1 = z[..., :Fh].clone()
        z2 = _layernorm(z[..., Fh:], axis=-1)
        g = torch.einsum('ts,bsf->btf', w_sp, z2) + b_sp[None, :, None]
        return torch.einsum('bsf,fd->bsd', z1 * g, w_out)
    x = A_x
    xn = _layernorm(x, axis=-1)
    s = _A_ref(xn, A_wqkv, A_wo)
    g = _silu(_B_ref(xn, B_w_in, B_w_sp, B_b_sp, B_w_out))
    return x + s * g
```

```asm
; @launch kernel=k0_prep_kernel grid=(704,1,1) block=(256,1,1) lds=36864
; @launch kernel=k2_mix_kernel grid=(512,1,1) block=(256,1,1) lds=81920
.amdgcn_target "amdgcn-amd-amdhsa--gfx950"
.text
.globl k0_prep_kernel
.p2align 8
.type k0_prep_kernel,@function
k0_prep_kernel:
    s_cmp_lt_u32 s2, 16
    s_cbranch_scc1 K0_CPF
    s_sub_u32 s2, s2, 16
    s_cmp_ge_u32 s2, 688
    s_cbranch_scc1 K0_SP
    s_load_dwordx4 s[4:7], s[0:1], 0
    s_load_dwordx2 s[24:25], s[0:1], 32
    s_load_dwordx2 s[26:27], s[0:1], 80
    v_and_b32 v1, 63, v0
    v_lshrrev_b32 v2, 6, v0
    s_waitcnt lgkmcnt(0)
    s_mov_b32 s8, s4
    s_and_b32 s9, s5, 0xffff
    s_mov_b32 s10, 2359296
    s_mov_b32 s11, 0x00020000
    s_mov_b32 s12, s6
    s_and_b32 s13, s7, 0xffff
    s_mov_b32 s14, 1990656
    s_mov_b32 s15, 0x00020000
    s_mov_b32 s16, s24
    s_and_b32 s17, s25, 0xffff
    s_mov_b32 s18, 5308416
    s_mov_b32 s19, 0x00020000
    s_mov_b32 s20, s26
    s_and_b32 s21, s27, 0xffff
    s_mov_b32 s22, 45088768
    s_mov_b32 s23, 0x00020000
    s_cmp_ge_u32 s2, 144
    s_cbranch_scc1 K0_NOTCV
    s_lshr_b32 s28, s2, 3
    s_and_b32 s29, s2, 7
    v_readfirstlane_b32 s30, v2
    s_mul_i32 s31, s28, 294912
    s_mul_i32 s32, s29, 576
    s_add_u32 s31, s31, s32
    s_mul_i32 s33, s30, 9216
    s_mul_i32 s34, s30, 73728
    s_add_u32 s31, s31, s34
    s_and_b32 s36, s30, 1
    v_add_u32 v3, 0, v1
    v_mul_u32_u24 v4, 1821, v3
    v_lshrrev_b32 v4, 16, v4
    v_mul_u32_u24 v5, 36, v4
    v_sub_u32 v5, v3, v5
    v_mul_u32_u24 v4, 4608, v4
    v_lshl_add_u32 v4, v5, 4, v4
    s_add_u32 m0, s33, 0
    s_nop 0
    buffer_load_dwordx4 v4, s[16:19], s31 offen nt lds
    v_add_u32 v3, 64, v1
    v_mul_u32_u24 v4, 1821, v3
    v_lshrrev_b32 v4, 16, v4
    v_mul_u32_u24 v5, 36, v4
    v_sub_u32 v5, v3, v5
    v_mul_u32_u24 v4, 4608, v4
    v_lshl_add_u32 v4, v5, 4, v4
    s_add_u32 m0, s33, 1024
    s_nop 0
    buffer_load_dwordx4 v4, s[16:19], s31 offen nt lds
    v_add_u32 v3, 128, v1
    v_mul_u32_u24 v4, 1821, v3
    v_lshrrev_b32 v4, 16, v4
    v_mul_u32_u24 v5, 36, v4
    v_sub_u32 v5, v3, v5
    v_mul_u32_u24 v4, 4608, v4
    v_lshl_add_u32 v4, v5, 4, v4
    s_add_u32 m0, s33, 2048
    s_nop 0
    buffer_load_dwordx4 v4, s[16:19], s31 offen nt lds
    v_add_u32 v3, 192, v1
    v_mul_u32_u24 v4, 1821, v3
    v_lshrrev_b32 v4, 16, v4
    v_mul_u32_u24 v5, 36, v4
    v_sub_u32 v5, v3, v5
    v_mul_u32_u24 v4, 4608, v4
    v_lshl_add_u32 v4, v5, 4, v4
    s_add_u32 m0, s33, 3072
    s_nop 0
    buffer_load_dwordx4 v4, s[16:19], s31 offen nt lds
    v_add_u32 v3, 256, v1
    v_mul_u32_u24 v4, 1821, v3
    v_lshrrev_b32 v4, 16, v4
    v_mul_u32_u24 v5, 36, v4
    v_sub_u32 v5, v3, v5
    v_mul_u32_u24 v4, 4608, v4
    v_lshl_add_u32 v4, v5, 4, v4
    s_add_u32 m0, s33, 4096
    s_nop 0
    buffer_load_dwordx4 v4, s[16:19], s31 offen nt lds
    v_add_u32 v3, 320, v1
    v_mul_u32_u24 v4, 1821, v3
    v_lshrrev_b32 v4, 16, v4
    v_mul_u32_u24 v5, 36, v4
    v_sub_u32 v5, v3, v5
    v_mul_u32_u24 v4, 4608, v4
    v_lshl_add_u32 v4, v5, 4, v4
    s_add_u32 m0, s33, 5120
    s_nop 0
    buffer_load_dwordx4 v4, s[16:19], s31 offen nt lds
    v_add_u32 v3, 384, v1
    v_mul_u32_u24 v4, 1821, v3
    v_lshrrev_b32 v4, 16, v4
    v_mul_u32_u24 v5, 36, v4
    v_sub_u32 v5, v3, v5
    v_mul_u32_u24 v4, 4608, v4
    v_lshl_add_u32 v4, v5, 4, v4
    s_add_u32 m0, s33, 6144
    s_nop 0
    buffer_load_dwordx4 v4, s[16:19], s31 offen nt lds
    v_add_u32 v3, 448, v1
    v_mul_u32_u24 v4, 1821, v3
    v_lshrrev_b32 v4, 16, v4
    v_mul_u32_u24 v5, 36, v4
    v_sub_u32 v5, v3, v5
    v_mul_u32_u24 v4, 4608, v4
    v_lshl_add_u32 v4, v5, 4, v4
    s_add_u32 m0, s33, 7168
    s_nop 0
    buffer_load_dwordx4 v4, s[16:19], s31 offen nt lds
    v_add_u32 v3, 512, v1
    v_mul_u32_u24 v4, 1821, v3
    v_lshrrev_b32 v4, 16, v4
    v_mul_u32_u24 v5, 36, v4
    v_sub_u32 v5, v3, v5
    v_mul_u32_u24 v4, 4608, v4
    v_lshl_add_u32 v4, v5, 4, v4
    s_add_u32 m0, s33, 8192
    s_nop 0
    buffer_load_dwordx4 v4, s[16:19], s31 offen nt lds
    s_lshr_b32 s35, s30, 1
    s_lshl_b32 s37, s29, 1
    s_add_u32 s42, s37, s35
    s_mul_i32 s37, s35, 288
    v_lshlrev_b32 v7, 4, v1
    s_cmp_lg_u32 s36, 0
    s_cbranch_scc1 K0_CVZ1
    v_lshrrev_b32 v3, 4, v1
    v_bfe_u32 v4, v1, 2, 2
    v_lshl_add_u32 v3, v3, 3, v4
    v_mul_u32_u24 v3, 1152, v3
    s_add_u32 s37, s37, 576
    v_add_u32 v3, s37, v3
    v_and_b32 v4, 3, v1
    v_lshl_add_u32 v6, v4, 3, v3
    v_lshl_add_u32 v5, v4, 4, v3
    v_bfe_u32 v4, v1, 1, 1
    v_lshl_add_u32 v5, v4, 3, v5
    v_xor_b32 v46, 8, v5
    s_mul_i32 s37, s42, 165888
    s_mul_i32 s38, s28, 9216
    s_add_u32 s39, s37, s38
    s_add_u32 s39, s39, 12648448
    s_add_u32 s40, s39, 4096
    s_add_u32 s41, s39, 8192
    s_waitcnt vmcnt(0)
    s_barrier
    ds_read_b64_tr_b16 v[8:9], v5 offset:0
    ds_read_b64_tr_b16 v[10:11], v5 offset:4608
    ds_read_b64_tr_b16 v[12:13], v46 offset:0
    ds_read_b64_tr_b16 v[14:15], v46 offset:4608
    ds_read_b64_tr_b16 v[16:17], v5 offset:64
    ds_read_b64_tr_b16 v[18:19], v5 offset:4672
    ds_read_b64_tr_b16 v[20:21], v46 offset:64
    ds_read_b64_tr_b16 v[22:23], v46 offset:4672
    ds_read_b64_tr_b16 v[24:25], v5 offset:128
    ds_read_b64_tr_b16 v[26:27], v5 offset:4736
    ds_read_b64_tr_b16 v[28:29], v46 offset:128
    ds_read_b64_tr_b16 v[30:31], v46 offset:4736
    ds_read_b64_tr_b16 v[32:33], v5 offset:192
    ds_read_b64_tr_b16 v[34:35], v5 offset:4800
    ds_read_b64_tr_b16 v[36:37], v46 offset:192
    ds_read_b64_tr_b16 v[38:39], v46 offset:4800
    ds_read_b64_tr_b16 v[40:41], v6 offset:256
    ds_read_b64_tr_b16 v[42:43], v6 offset:4864
    s_waitcnt lgkmcnt(15)
    buffer_store_dwordx4 v[8:11], v7, s[20:23], s39 offen offset:0
    s_waitcnt lgkmcnt(14)
    buffer_store_dwordx4 v[12:15], v7, s[20:23], s39 offen offset:1024
    s_waitcnt lgkmcnt(12)
    buffer_store_dwordx4 v[16:19], v7, s[20:23], s39 offen offset:2048
    s_waitcnt lgkmcnt(10)
    buffer_store_dwordx4 v[20:23], v7, s[20:23], s39 offen offset:3072
    s_waitcnt lgkmcnt(8)
    buffer_store_dwordx4 v[24:27], v7, s[20:23], s40 offen offset:0
    s_waitcnt lgkmcnt(6)
    buffer_store_dwordx4 v[28:31], v7, s[20:23], s40 offen offset:1024
    s_waitcnt lgkmcnt(4)
    buffer_store_dwordx4 v[32:35], v7, s[20:23], s40 offen offset:2048
    s_waitcnt lgkmcnt(2)
    buffer_store_dwordx4 v[36:39], v7, s[20:23], s40 offen offset:3072
    s_waitcnt lgkmcnt(0)
    buffer_store_dwordx4 v[40:43], v7, s[20:23], s41 offen offset:0
    s_branch K0_CVEND
K0_CVZ1:
    v_lshrrev_b32 v3, 5, v1
    v_bfe_u32 v4, v1, 2, 2
    v_lshl_add_u32 v3, v3, 3, v4
    v_mul_u32_u24 v3, 1152, v3
    v_add_u32 v3, s37, v3
    v_and_b32 v4, 1, v1
    v_lshl_add_u32 v3, v4, 4, v3
    v_bfe_u32 v4, v1, 1, 1
    v_lshl_add_u32 v6, v4, 3, v3
    v_bfe_u32 v4, v1, 4, 1
    v_lshl_add_u32 v5, v4, 5, v6
    s_mul_i32 s37, s42, 294912
    s_lshl_b32 s38, s28, 14
    s_add_u32 s39, s37, s38
    s_add_u32 s39, s39, 15306752
    s_add_u32 s40, s39, 8192
    s_sub_u32 s41, s39, 1024
    s_sub_u32 s43, s40, 1024
    s_waitcnt vmcnt(0)
    s_barrier
    ds_read_b64_tr_b16 v[8:9], v5 offset:0
    ds_read_b64_tr_b16 v[10:11], v5 offset:4608
    ds_read_b64_tr_b16 v[12:13], v5 offset:64
    ds_read_b64_tr_b16 v[14:15], v5 offset:4672
    ds_read_b64_tr_b16 v[16:17], v5 offset:128
    ds_read_b64_tr_b16 v[18:19], v5 offset:4736
    ds_read_b64_tr_b16 v[20:21], v5 offset:192
    ds_read_b64_tr_b16 v[22:23], v5 offset:4800
    ds_read_b64_tr_b16 v[24:25], v6 offset:256
    ds_read_b64_tr_b16 v[26:27], v6 offset:4864
    ds_read_b64_tr_b16 v[28:29], v5 offset:18432
    ds_read_b64_tr_b16 v[30:31], v5 offset:23040
    ds_read_b64_tr_b16 v[32:33], v5 offset:18496
    ds_read_b64_tr_b16 v[34:35], v5 offset:23104
    ds_read_b64_tr_b16 v[36:37], v5 offset:18560
    ds_read_b64_tr_b16 v[38:39], v5 offset:23168
    ds_read_b64_tr_b16 v[40:41], v5 offset:18624
    ds_read_b64_tr_b16 v[42:43], v5 offset:23232
    ds_read_b64_tr_b16 v[44:45], v6 offset:18688
    ds_read_b64_tr_b16 v[46:47], v6 offset:23296
    s_waitcnt lgkmcnt(0)
    buffer_store_dwordx4 v[8:11], v7, s[20:23], s39 offen offset:0
    buffer_store_dwordx4 v[12:15], v7, s[20:23], s39 offen offset:1024
    buffer_store_dwordx4 v[16:19], v7, s[20:23], s39 offen offset:2048
    buffer_store_dwordx4 v[20:23], v7, s[20:23], s39 offen offset:3072
    buffer_store_dwordx4 v[28:31], v7, s[20:23], s40 offen offset:0
    buffer_store_dwordx4 v[32:35], v7, s[20:23], s40 offen offset:1024
    buffer_store_dwordx4 v[36:39], v7, s[20:23], s40 offen offset:2048
    buffer_store_dwordx4 v[40:43], v7, s[20:23], s40 offen offset:3072
    s_mov_b32 exec_lo, 0xffff0000
    s_mov_b32 exec_hi, 0xffff0000
    buffer_store_dwordx4 v[24:27], v7, s[20:23], s41 offen
    buffer_store_dwordx4 v[44:47], v7, s[20:23], s43 offen
K0_CVEND:
    s_endpgm
K0_NOTCV:
    s_cmp_ge_u32 s2, 400
    s_cbranch_scc1 K0_WB
    v_lshrrev_b32 v3, 5, v1
    v_lshl_add_u32 v3, v2, 1, v3
    s_sub_u32 s28, s2, 144
    s_lshl_b32 s28, s28, 3
    v_add_u32 v3, s28, v3
    v_and_b32 v4, 31, v1
    v_mul_u32_u24 v5, 1152, v3
    v_lshl_add_u32 v5, v4, 4, v5
    v_mov_b32 v8, 0
    v_mov_b32 v9, 0
    v_mov_b32 v10, 0
    v_mov_b32 v11, 0
    v_mov_b32 v12, 0
    v_mov_b32 v13, 0
    v_mov_b32 v14, 0
    v_mov_b32 v15, 0
    v_mov_b32 v16, 0
    v_mov_b32 v17, 0
    v_mov_b32 v18, 0
    v_mov_b32 v19, 0
    s_mov_b32 s30, 0x00ffffff
    s_mov_b32 s31, 0x00ffffff
    s_mov_b64 exec, s[30:31]
    buffer_load_dwordx4 v[8:11], v5, s[8:11], 0 offen
    buffer_load_dwordx4 v[12:15], v5, s[8:11], 0 offen offset:384
    buffer_load_dwordx4 v[16:19], v5, s[8:11], 0 offen offset:768
    s_mov_b64 exec, -1
    v_lshlrev_b32 v6, 2, v0
    v_mov_b32 v7, -1.0
    s_lshl_b32 s29, s28, 7
    s_add_u32 s29, s29, 12337152
    buffer_store_dword v7, v6, s[20:23], s29 offen
    s_cmp_ge_u32 s28, 320
    s_cbranch_scc1 K0_NOFLG
    v_mov_b32 v7, 0
    s_add_u32 s29, s29, 262144
    buffer_store_dword v7, v6, s[20:23], s29 offen
    s_waitcnt vmcnt(0)
K0_NOFLG:
    v_lshrrev_b32 v6, 5, v3
    v_mul_u32_u24 v6, 36, v6
    v_lshrrev_b32 v7, 1, v4
    v_add_u32 v6, v6, v7
    v_lshlrev_b32 v6, 10, v6
    v_and_b32 v7, 1, v4
    v_lshlrev_b32 v7, 5, v7
    v_and_b32 v20, 31, v3
    v_add_u32 v7, v7, v20
    v_lshl_add_u32 v6, v7, 4, v6
    s_waitcnt vmcnt(1)
    v_lshlrev_b32 v24, 16, v8
    v_and_b32 v25, 0xffff0000, v8
    v_lshlrev_b32 v26, 16, v9
    v_and_b32 v27, 0xffff0000, v9
    v_lshlrev_b32 v28, 16, v10
    v_and_b32 v29, 0xffff0000, v10
    v_lshlrev_b32 v30, 16, v11
    v_and_b32 v31, 0xffff0000, v11
    v_lshlrev_b32 v32, 16, v12
    v_and_b32 v33, 0xffff0000, v12
    v_lshlrev_b32 v34, 16, v13
    v_and_b32 v35, 0xffff0000, v13
    v_lshlrev_b32 v36, 16, v14
    v_and_b32 v37, 0xffff0000, v14
    v_lshlrev_b32 v38, 16, v15
    v_and_b32 v39, 0xffff0000, v15
    v_lshlrev_b32 v40, 16, v16
    v_and_b32 v41, 0xffff0000, v16
    v_lshlrev_b32 v42, 16, v17
    v_and_b32 v43, 0xffff0000, v17
    v_lshlrev_b32 v44, 16, v18
    v_and_b32 v45, 0xffff0000, v18
    v_lshlrev_b32 v46, 16, v19
    v_and_b32 v47, 0xffff0000, v19
    v_add_f32 v50, v24, v25
    v_add_f32 v51, v26, v27
    v_add_f32 v50, v50, v28
    v_add_f32 v51, v51, v29
    v_add_f32 v50, v50, v30
    v_add_f32 v51, v51, v31
    v_add_f32 v50, v50, v32
    v_add_f32 v51, v51, v33
    v_add_f32 v50, v50, v34
    v_add_f32 v51, v51, v35
    v_add_f32 v50, v50, v36
    v_add_f32 v51, v51, v37
    v_add_f32 v50, v50, v38
    v_add_f32 v51, v51, v39
    v_add_f32 v50, v50, v40
    v_add_f32 v51, v51, v41
    v_add_f32 v50, v50, v42
    v_add_f32 v51, v51, v43
    v_add_f32 v50, v50, v44
    v_add_f32 v51, v51, v45
    v_add_f32 v50, v50, v46
    v_add_f32 v51, v51, v47
    v_add_f32 v50, v50, v51
    s_nop 1
    v_add_f32_dpp v50, v50, v50 quad_perm:[1,0,3,2] row_mask:0xf bank_mask:0xf
    s_nop 1
    v_add_f32_dpp v50, v50, v50 quad_perm:[2,3,0,1] row_mask:0xf bank_mask:0xf
    s_nop 1
    v_add_f32_dpp v50, v50, v50 row_half_mirror row_mask:0xf bank_mask:0xf
    s_nop 1
    v_add_f32_dpp v50, v50, v50 row_mirror row_mask:0xf bank_mask:0xf
    v_mov_b32 v52, v50
    s_nop 1
    v_permlane16_swap_b32 v50, v52
    v_add_f32 v50, v50, v52
    v_mul_f32 v50, 0x3ae38e39, v50
    v_mov_b32 v51, 0
    v_mov_b32 v53, 0
    s_mov_b64 exec, s[30:31]
    v_sub_f32 v52, v24, v50
    v_fmac_f32 v51, v52, v52
    v_sub_f32 v52, v25, v50
    v_fmac_f32 v53, v52, v52
    v_sub_f32 v52, v26, v50
    v_fmac_f32 v51, v52, v52
    v_sub_f32 v52, v27, v50
    v_fmac_f32 v53, v52, v52
    v_sub_f32 v52, v28, v50
    v_fmac_f32 v51, v52, v52
    v_sub_f32 v52, v29, v50
    v_fmac_f32 v53, v52, v52
    v_sub_f32 v52, v30, v50
    v_fmac_f32 v51, v52, v52
    v_sub_f32 v52, v31, v50
    v_fmac_f32 v53, v52, v52
    v_sub_f32 v52, v32, v50
    v_fmac_f32 v51, v52, v52
    v_sub_f32 v52, v33, v50
    v_fmac_f32 v53, v52, v52
    v_sub_f32 v52, v34, v50
    v_fmac_f32 v51, v52, v52
    v_sub_f32 v52, v35, v50
    v_fmac_f32 v53, v52, v52
    v_sub_f32 v52, v36, v50
    v_fmac_f32 v51, v52, v52
    v_sub_f32 v52, v37, v50
    v_fmac_f32 v53, v52, v52
    v_sub_f32 v52, v38, v50
    v_fmac_f32 v51, v52, v52
    v_sub_f32 v52, v39, v50
    v_fmac_f32 v53, v52, v52
    v_sub_f32 v52, v40, v50
    v_fmac_f32 v51, v52, v52
    v_sub_f32 v52, v41, v50
    v_fmac_f32 v53, v52, v52
    v_sub_f32 v52, v42, v50
    v_fmac_f32 v51, v52, v52
    v_sub_f32 v52, v43, v50
    v_fmac_f32 v53, v52, v52
    v_sub_f32 v52, v44, v50
    v_fmac_f32 v51, v52, v52
    v_sub_f32 v52, v45, v50
    v_fmac_f32 v53, v52, v52
    v_sub_f32 v52, v46, v50
    v_fmac_f32 v51, v52, v52
    v_sub_f32 v52, v47, v50
    v_fmac_f32 v53, v52, v52
    s_mov_b64 exec, -1
    v_add_f32 v51, v51, v53
    s_nop 1
    v_add_f32_dpp v51, v51, v51 quad_perm:[1,0,3,2] row_mask:0xf bank_mask:0xf
    s_nop 1
    v_add_f32_dpp v51, v51, v51 quad_perm:[2,3,0,1] row_mask:0xf bank_mask:0xf
    s_nop 1
    v_add_f32_dpp v51, v51, v51 row_half_mirror row_mask:0xf bank_mask:0xf
    s_nop 1
    v_add_f32_dpp v51, v51, v51 row_mirror row_mask:0xf bank_mask:0xf
    v_mov_b32 v52, v51
    s_nop 1
    v_permlane16_swap_b32 v51, v52
    v_add_f32 v51, v51, v52
    v_mul_f32 v51, 0x3ae38e39, v51
    v_cvt_pk_bf16_f32 v50, v50, v50
    v_lshlrev_b32 v50, 16, v50
    v_cvt_pk_bf16_f32 v51, v51, v51
    v_lshlrev_b32 v51, 16, v51
    v_add_f32 v51, 0x3727c5ac, v51
    v_cvt_pk_bf16_f32 v51, v51, v51
    v_lshlrev_b32 v51, 16, v51
    v_sqrt_f32 v51, v51
    s_nop 0
    v_cvt_pk_bf16_f32 v51, v51, v51
    v_lshlrev_b32 v51, 16, v51
    v_rcp_f32 v51, v51
    v_sub_f32 v24, v24, v50
    v_sub_f32 v25, v25, v50
    v_sub_f32 v26, v26, v50
    v_sub_f32 v27, v27, v50
    v_sub_f32 v28, v28, v50
    v_sub_f32 v29, v29, v50
    v_sub_f32 v30, v30, v50
    v_sub_f32 v31, v31, v50
    v_sub_f32 v32, v32, v50
    v_sub_f32 v33, v33, v50
    v_sub_f32 v34, v34, v50
    v_sub_f32 v35, v35, v50
    v_sub_f32 v36, v36, v50
    v_sub_f32 v37, v37, v50
    v_sub_f32 v38, v38, v50
    v_sub_f32 v39, v39, v50
    v_sub_f32 v40, v40, v50
    v_sub_f32 v41, v41, v50
    v_sub_f32 v42, v42, v50
    v_sub_f32 v43, v43, v50
    v_sub_f32 v44, v44, v50
    v_sub_f32 v45, v45, v50
    v_sub_f32 v46, v46, v50
    v_sub_f32 v47, v47, v50
    v_cvt_pk_bf16_f32 v8, v24, v25
    v_cvt_pk_bf16_f32 v9, v26, v27
    v_cvt_pk_bf16_f32 v10, v28, v29
    v_cvt_pk_bf16_f32 v11, v30, v31
    v_cvt_pk_bf16_f32 v12, v32, v33
    v_cvt_pk_bf16_f32 v13, v34, v35
    v_cvt_pk_bf16_f32 v14, v36, v37
    v_cvt_pk_bf16_f32 v15, v38, v39
    v_cvt_pk_bf16_f32 v16, v40, v41
    v_cvt_pk_bf16_f32 v17, v42, v43
    v_cvt_pk_bf16_f32 v18, v44, v45
    v_cvt_pk_bf16_f32 v19, v46, v47
    v_lshlrev_b32 v24, 16, v8
    v_and_b32 v25, 0xffff0000, v8
    v_lshlrev_b32 v26, 16, v9
    v_and_b32 v27, 0xffff0000, v9
    v_lshlrev_b32 v28, 16, v10
    v_and_b32 v29, 0xffff0000, v10
    v_lshlrev_b32 v30, 16, v11
    v_and_b32 v31, 0xffff0000, v11
    v_lshlrev_b32 v32, 16, v12
    v_and_b32 v33, 0xffff0000, v12
    v_lshlrev_b32 v34, 16, v13
    v_and_b32 v35, 0xffff0000, v13
    v_lshlrev_b32 v36, 16, v14
    v_and_b32 v37, 0xffff0000, v14
    v_lshlrev_b32 v38, 16, v15
    v_and_b32 v39, 0xffff0000, v15
    v_lshlrev_b32 v40, 16, v16
    v_and_b32 v41, 0xffff0000, v16
    v_lshlrev_b32 v42, 16, v17
    v_and_b32 v43, 0xffff0000, v17
    v_lshlrev_b32 v44, 16, v18
    v_and_b32 v45, 0xffff0000, v18
    v_lshlrev_b32 v46, 16, v19
    v_and_b32 v47, 0xffff0000, v19
    v_mul_f32 v24, v24, v51
    v_mul_f32 v25, v25, v51
    v_mul_f32 v26, v26, v51
    v_mul_f32 v27, v27, v51
    v_mul_f32 v28, v28, v51
    v_mul_f32 v29, v29, v51
    v_mul_f32 v30, v30, v51
    v_mul_f32 v31, v31, v51
    v_mul_f32 v32, v32, v51
    v_mul_f32 v33, v33, v51
    v_mul_f32 v34, v34, v51
    v_mul_f32 v35, v35, v51
    v_mul_f32 v36, v36, v51
    v_mul_f32 v37, v37, v51
    v_mul_f32 v38, v38, v51
    v_mul_f32 v39, v39, v51
    v_mul_f32 v40, v40, v51
    v_mul_f32 v41, v41, v51
    v_mul_f32 v42, v42, v51
    v_mul_f32 v43, v43, v51
    v_mul_f32 v44, v44, v51
    v_mul_f32 v45, v45, v51
    v_mul_f32 v46, v46, v51
    v_mul_f32 v47, v47, v51
    v_cvt_pk_bf16_f32 v8, v24, v25
    v_cvt_pk_bf16_f32 v9, v26, v27
    v_cvt_pk_bf16_f32 v10, v28, v29
    v_cvt_pk_bf16_f32 v11, v30, v31
    v_cvt_pk_bf16_f32 v12, v32, v33
    v_cvt_pk_bf16_f32 v13, v34, v35
    v_cvt_pk_bf16_f32 v14, v36, v37
    v_cvt_pk_bf16_f32 v15, v38, v39
    v_cvt_pk_bf16_f32 v16, v40, v41
    v_cvt_pk_bf16_f32 v17, v42, v43
    v_cvt_pk_bf16_f32 v18, v44, v45
    v_cvt_pk_bf16_f32 v19, v46, v47
    s_mov_b64 exec, s[30:31]
    s_mov_b32 s32, 0
    s_mov_b32 s33, 12288
    s_mov_b32 s34, 24576
    buffer_store_dwordx4 v[8:11], v6, s[20:23], s32 offen
    buffer_store_dwordx4 v[12:15], v6, s[20:23], s33 offen
    buffer_store_dwordx4 v[16:19], v6, s[20:23], s34 offen
    s_endpgm
K0_WB:
    s_sub_u32 s28, s2, 400
    s_and_b32 s29, s28, 7
    s_lshl_b32 s29, s29, 1
    s_bfe_u32 s30, s28, 0x10003
    s_add_u32 s29, s29, s30
    s_lshr_b32 s30, s28, 4
    v_readfirstlane_b32 s31, v2
    v_and_b32 v3, 31, v1
    v_lshrrev_b32 v4, 5, v1
    v_and_b32 v5, 19, v3
    v_and_b32 v6, 4, v3
    v_lshlrev_b32 v6, 1, v6
    v_or_b32 v5, v5, v6
    v_and_b32 v6, 8, v3
    v_lshrrev_b32 v6, 1, v6
    v_or_b32 v5, v5, v6
    s_lshl_b32 s32, s30, 5
    v_lshlrev_b32 v6, 3, v4
    v_add_u32 v6, s32, v6
    s_mul_i32 s33, s29, 36
    v_mov_b32 v16, 0
    v_mov_b32 v17, 0
    v_mov_b32 v18, 0
    v_mov_b32 v19, 0
    v_mov_b32 v20, 0
    v_mov_b32 v21, 0
    v_mov_b32 v22, 0
    v_mov_b32 v23, 0
    v_mov_b32 v24, 0
    v_mov_b32 v25, 0
    v_mov_b32 v26, 0
    v_mov_b32 v27, 0
    v_mov_b32 v28, 0
    v_mov_b32 v29, 0
    v_mov_b32 v30, 0
    v_mov_b32 v31, 0
    s_cmp_eq_u32 s31, 3
    s_cbranch_scc1 K0_WB3
    s_mul_i32 s34, s31, 576
    s_add_u32 s34, s34, s33
    v_lshrrev_b32 v7, 4, v5
    v_mul_u32_u24 v7, 18, v7
    v_and_b32 v8, 15, v5
    v_add3_u32 v7, v7, v8, s34
    s_branch K0_WBQ
K0_WB3:
    v_lshrrev_b32 v10, 3, v5
    v_bfe_u32 v11, v5, 1, 2
    v_and_b32 v12, 1, v5
    v_mul_u32_u24 v7, 576, v11
    v_mul_u32_u24 v10, 18, v10
    v_add3_u32 v7, v7, v10, v12
    v_add3_u32 v7, v7, s33, 16
    v_cmp_gt_u32 vcc, 16, v5
    v_cmp_ne_u32 s[38:39], 3, v11
    s_nop 1
    s_and_b64 vcc, vcc, s[38:39]
    s_mov_b64 exec, vcc
K0_WBQ:
    v_mul_u32_u24 v9, 1728, v6
    v_add_lshl_u32 v9, v9, v7, 1
    s_mov_b32 s38, 0
    buffer_load_ushort v16, v9, s[12:15], s38 offen
    s_mov_b32 s38, 3456
    buffer_load_ushort v24, v9, s[12:15], s38 offen
    s_mov_b32 s38, 6912
    buffer_load_ushort v17, v9, s[12:15], s38 offen
    s_mov_b32 s38, 10368
    buffer_load_ushort v25, v9, s[12:15], s38 offen
    s_mov_b32 s38, 13824
    buffer_load_ushort v18, v9, s[12:15], s38 offen
    s_mov_b32 s38, 17280
    buffer_load_ushort v26, v9, s[12:15], s38 offen
    s_mov_b32 s38, 20736
    buffer_load_ushort v19, v9, s[12:15], s38 offen
    s_mov_b32 s38, 24192
    buffer_load_ushort v27, v9, s[12:15], s38 offen
    s_mov_b32 s38, 55296
    buffer_load_ushort v20, v9, s[12:15], s38 offen
    s_mov_b32 s38, 58752
    buffer_load_ushort v28, v9, s[12:15], s38 offen
    s_mov_b32 s38, 62208
    buffer_load_ushort v21, v9, s[12:15], s38 offen
    s_mov_b32 s38, 65664
    buffer_load_ushort v29, v9, s[12:15], s38 offen
    s_mov_b32 s38, 69120
    buffer_load_ushort v22, v9, s[12:15], s38 offen
    s_mov_b32 s38, 72576
    buffer_load_ushort v30, v9, s[12:15], s38 offen
    s_mov_b32 s38, 76032
    buffer_load_ushort v23, v9, s[12:15], s38 offen
    s_mov_b32 s38, 79488
    buffer_load_ushort v31, v9, s[12:15], s38 offen
    s_mov_b64 exec, -1
    s_mul_i32 s34, s29, 294912
    s_lshl_b32 s35, s30, 4
    s_add_u32 s35, s35, s31
    s_lshl_b32 s35, s35, 10
    s_add_u32 s34, s34, s35
    s_add_u32 s34, s34, 15302656
    s_add_u32 s35, s34, 8192
    v_lshlrev_b32 v9, 4, v1
    s_waitcnt vmcnt(0)
    v_lshl_or_b32 v16, v24, 16, v16
    v_lshl_or_b32 v17, v25, 16, v17
    v_lshl_or_b32 v18, v26, 16, v18
    v_lshl_or_b32 v19, v27, 16, v19
    v_lshl_or_b32 v20, v28, 16, v20
    v_lshl_or_b32 v21, v29, 16, v21
    v_lshl_or_b32 v22, v30, 16, v22
    v_lshl_or_b32 v23, v31, 16, v23
    s_cmp_eq_u32 s31, 3
    s_cselect_b32 exec_lo, 0xffff, -1
    s_cselect_b32 exec_hi, 0xffff, -1
    buffer_store_dwordx4 v[16:19], v9, s[20:23], s34 offen
    buffer_store_dwordx4 v[20:23], v9, s[20:23], s35 offen
K0_END:
    s_endpgm
K0_SP:
    s_sub_u32 s2, s2, 688
    s_cmp_ge_u32 s2, 0
    s_cbranch_scc1 K0_END
    s_load_dwordx2 s[4:5], s[0:1], 40
    v_lshlrev_b32 v1, 7, v0
    s_lshl_b32 s12, s2, 15
    s_add_u32 s13, s12, 32768
    s_waitcnt lgkmcnt(0)
    s_mov_b32 s8, s4
    s_and_b32 s9, s5, 0xffff
    s_mov_b32 s10, 8388608
    s_mov_b32 s11, 0x00020000
    buffer_load_dword v2, v1, s[8:11], s12 offen
    s_endpgm
K0_CPF:
    s_getpc_b64 s[4:5]
K0_PC:
    s_lshr_b32 s6, s2, 3
    s_lshl_b32 s6, s6, 15
    v_lshlrev_b32 v1, 7, v0
    v_add_u32 v1, s6, v1
    v_min_u32 v1, ALL_CODE_END-K0_PC-4, v1
    global_load_dword v2, v1, s[4:5]
    s_endpgm
.globl k2_mix_kernel
.p2align 8
.type k2_mix_kernel,@function
k2_mix_kernel:
    s_cmp_ge_u32 s2, 512
    s_cbranch_scc1 K2_END
    s_load_dwordx4 s[4:7], s[0:1], 40
    s_load_dwordx2 s[24:25], s[0:1], 56
    s_load_dwordx2 s[26:27], s[0:1], 80
    s_load_dwordx2 s[60:61], s[0:1], 16
    s_waitcnt lgkmcnt(0)
    s_mov_b32 s12, s4
    s_and_b32 s13, s5, 0xffff
    s_mov_b32 s14, 8388608
    s_mov_b32 s15, 0x00020000
    s_mov_b32 s16, s6
    s_and_b32 s17, s7, 0xffff
    s_mov_b32 s18, 4096
    s_mov_b32 s19, 0x00020000
    s_mov_b32 s20, s26
    s_and_b32 s21, s27, 0xffff
    s_mov_b32 s22, 45088768
    s_mov_b32 s23, 0x00020000
    s_and_b32 s3, s2, 255
    s_cmp_ge_u32 s2, 256
    s_cbranch_scc1 K2_ATT
    s_setprio 2
    s_mov_b32 s8, s24
    s_and_b32 s9, s25, 0xffff
    s_mov_b32 s10, 2654208
    s_mov_b32 s11, 0x00020000
    v_and_b32 v1, 63, v0
    v_lshrrev_b32 v232, 6, v0
    s_and_b32 s28, s3, 7
    s_lshr_b32 s29, s3, 3
    s_and_b32 s30, s28, 1
    s_lshl_b32 s30, s30, 3
    s_and_b32 s31, s29, 7
    s_add_u32 s30, s30, s31
    s_lshr_b32 s31, s28, 1
    s_lshl_b32 s31, s31, 2
    s_lshr_b32 s32, s29, 3
    s_add_u32 s31, s31, s32
    v_readfirstlane_b32 s32, v232
    v_lshlrev_b32 v2, 4, v1
    s_lshl_b32 s33, s30, 2
    s_add_u32 s33, s33, s32
    v_and_b32 v232, 15, v1
    v_lshrrev_b32 v12, 4, v1
    v_lshlrev_b32 v12, 9, v12
    v_lshl_add_u32 v12, v232, 4, v12
    v_add_u32 v3, 36864, v2
    s_mul_i32 s34, s33, 36864
    s_add_u32 s34, s34, 0
    s_lshl_b32 s35, s32, 11
    s_lshl_b32 s36, s32, 8
    s_add_u32 s36, s36, 8192
    s_mul_i32 s37, s31, 165888
    s_add_u32 s37, s37, 12648448
    s_add_u32 s38, s37, s36
    s_add_u32 s37, s37, s35
    buffer_load_dwordx4 v[16:19], v12, s[20:23], s34 offen offset:0
    buffer_load_dwordx4 v[20:23], v12, s[20:23], s34 offen offset:256
    s_add_u32 m0, s35, 0
    s_nop 0
    buffer_load_dwordx4 v2, s[20:23], s37 offen lds
    buffer_load_dwordx4 v2, s[20:23], s37 offen offset:1024 lds
    s_add_u32 s37, s37, 9216
    s_add_u32 m0, s36, 0
    s_mov_b64 exec, 0xffff
    buffer_load_dwordx4 v2, s[20:23], s38 offen lds
    s_mov_b64 exec, -1
    s_add_u32 s38, s38, 9216
    buffer_load_dwordx4 v[24:27], v12, s[20:23], s34 offen offset:2048
    buffer_load_dwordx4 v[28:31], v12, s[20:23], s34 offen offset:2304
    s_add_u32 s34, s34, 4096
    s_add_u32 m0, s35, 9216
    s_nop 0
    buffer_load_dwordx4 v2, s[20:23], s37 offen lds
    buffer_load_dwordx4 v2, s[20:23], s37 offen offset:1024 lds
    s_add_u32 s37, s37, 9216
    s_add_u32 m0, s36, 9216
    s_mov_b64 exec, 0xffff
    buffer_load_dwordx4 v2, s[20:23], s38 offen lds
    s_mov_b64 exec, -1
    s_add_u32 s38, s38, 9216
    buffer_load_dwordx4 v[32:35], v12, s[20:23], s34 offen offset:0
    buffer_load_dwordx4 v[36:39], v12, s[20:23], s34 offen offset:256
    s_add_u32 m0, s35, 18432
    s_nop 0
    buffer_load_dwordx4 v2, s[20:23], s37 offen lds
    buffer_load_dwordx4 v2, s[20:23], s37 offen offset:1024 lds
    s_add_u32 s37, s37, 9216
    s_add_u32 m0, s36, 18432
    s_mov_b64 exec, 0xffff
    buffer_load_dwordx4 v2, s[20:23], s38 offen lds
    s_mov_b64 exec, -1
    s_add_u32 s38, s38, 9216
    buffer_load_dwordx4 v[40:43], v12, s[20:23], s34 offen offset:2048
    buffer_load_dwordx4 v[44:47], v12, s[20:23], s34 offen offset:2304
    s_add_u32 s34, s34, 4096
    s_add_u32 m0, s35, 27648
    s_nop 0
    buffer_load_dwordx4 v2, s[20:23], s37 offen lds
    buffer_load_dwordx4 v2, s[20:23], s37 offen offset:1024 lds
    s_add_u32 s37, s37, 9216
    s_add_u32 m0, s36, 27648
    s_mov_b64 exec, 0xffff
    buffer_load_dwordx4 v2, s[20:23], s38 offen lds
    s_mov_b64 exec, -1
    s_add_u32 s38, s38, 9216
    v_and_b32 v4, 15, v1
    v_lshrrev_b32 v5, 4, v1
    s_mov_b32 s40, 0xc0135761
    v_mov_b32 v10, 0xbdd2d3e8
    v_and_b32 v6, 31, v1
    v_lshlrev_b32 v6, 3, v6
    v_lshlrev_b32 v7, 10, v5
    v_lshl_add_u32 v7, v4, 3, v7
    s_lshl_b32 s45, s33, 12
    s_add_u32 s45, s45, 12337152
    s_lshl_b32 s46, s31, 8
    s_add_u32 s46, s46, s45
    v_and_b32 v232, 1, v5
    v_lshlrev_b32 v233, 2, v232
    v_xor_b32 v233, v233, v4
    v_lshlrev_b32 v8, 9, v5
    v_lshl_add_u32 v8, v233, 4, v8
    v_lshrrev_b32 v234, 1, v5
    v_lshlrev_b32 v233, 2, v234
    v_xor_b32 v233, v233, v4
    v_lshlrev_b32 v9, 9, v234
    v_lshl_add_u32 v9, v233, 4, v9
    v_lshl_add_u32 v9, v232, 3, v9
    s_lshl_b32 s48, s31, 6
    s_add_u32 s48, s48, s33
    s_mul_i32 s48, s48, 9216
    s_add_u32 s48, s48, 20447232
    s_add_u32 s49, s48, 4096
    s_add_u32 s50, s48, 8192
    s_mov_b32 s52, 0xffff0000
    s_mov_b32 s53, 0xffff0000
    v_mov_b32 v248, 0
    v_mov_b32 v249, 0
    v_mov_b32 v250, 0
    v_mov_b32 v251, 0
    s_waitcnt vmcnt(10)
    s_barrier
    ds_read_b128 v[160:163], v2 offset:0
    ds_read_b128 v[164:167], v2 offset:1024
    ds_read_b128 v[168:171], v2 offset:2048
    ds_read_b128 v[172:175], v2 offset:3072
    ds_read_b128 v[176:179], v2 offset:4096
    s_waitcnt lgkmcnt(4)
    v_mfma_f32_16x16x32_bf16 v[88:91], v[160:163], v[16:19], 0
    ds_read_b128 v[180:183], v2 offset:5120
    v_mfma_f32_16x16x32_bf16 v[92:95], v[160:163], v[20:23], 0
    buffer_load_dwordx4 v[48:51], v12, s[20:23], s34 offen offset:0
    s_waitcnt lgkmcnt(4)
    v_mfma_f32_16x16x32_bf16 v[96:99], v[164:167], v[16:19], 0
    ds_read_b128 v[160:163], v2 offset:6144
    v_mfma_f32_16x16x32_bf16 v[100:103], v[164:167], v[20:23], 0
    buffer_load_dwordx4 v[52:55], v12, s[20:23], s34 offen offset:256
    s_waitcnt lgkmcnt(4)
    v_mfma_f32_16x16x32_bf16 v[104:107], v[168:171], v[16:19], 0
    ds_read_b128 v[164:167], v2 offset:7168
    v_mfma_f32_16x16x32_bf16 v[108:111], v[168:171], v[20:23], 0
    s_waitcnt lgkmcnt(4)
    v_mfma_f32_16x16x32_bf16 v[112:115], v[172:175], v[16:19], 0
    ds_read_b128 v[168:171], v2 offset:8192
    v_mfma_f32_16x16x32_bf16 v[116:119], v[172:175], v[20:23], 0
    s_add_u32 m0, s35, 36864
    s_nop 0
    buffer_load_dwordx4 v2, s[20:23], s37 offen lds
    s_waitcnt lgkmcnt(4)
    v_mfma_f32_16x16x32_bf16 v[120:123], v[176:179], v[16:19], 0
    ds_read_b128 v[172:175], v2 offset:9216
    v_mfma_f32_16x16x32_bf16 v[124:127], v[176:179], v[20:23], 0
    buffer_load_dwordx4 v2, s[20:23], s37 offen offset:1024 lds
    s_add_u32 s37, s37, 9216
    s_waitcnt lgkmcnt(4)
    v_mfma_f32_16x16x32_bf16 v[128:131], v[180:183], v[16:19], 0
    ds_read_b128 v[176:179], v2 offset:10240
    v_mfma_f32_16x16x32_bf16 v[132:135], v[180:183], v[20:23], 0
    s_waitcnt lgkmcnt(4)
    v_mfma_f32_16x16x32_bf16 v[136:139], v[160:163], v[16:19], 0
    ds_read_b128 v[180:183], v2 offset:11264
    v_mfma_f32_16x16x32_bf16 v[140:143], v[160:163], v[20:23], 0
    s_add_u32 m0, s36, 36864
    s_mov_b64 exec, 0xffff
    buffer_load_dwordx4 v2, s[20:23], s38 offen lds
    s_mov_b64 exec, -1
    s_add_u32 s38, s38, 9216
    s_waitcnt lgkmcnt(4)
    v_mfma_f32_16x16x32_bf16 v[144:147], v[164:167], v[16:19], 0
    ds_read_b128 v[160:163], v2 offset:12288
    v_mfma_f32_16x16x32_bf16 v[148:151], v[164:167], v[20:23], 0
    buffer_load_dwordx4 v[56:59], v12, s[20:23], s34 offen offset:2048
    s_waitcnt lgkmcnt(4)
    v_mfma_f32_16x16x32_bf16 v[152:155], v[168:171], v[16:19], 0
    ds_read_b128 v[164:167], v2 offset:13312
    v_mfma_f32_16x16x32_bf16 v[156:159], v[168:171], v[20:23], 0
    s_waitcnt lgkmcnt(4)
    v_mfma_f32_16x16x32_bf16 v[88:91], v[172:175], v[24:27], v[88:91]
    ds_read_b128 v[168:171], v2 offset:14336
    v_mfma_f32_16x16x32_bf16 v[92:95], v[172:175], v[28:31], v[92:95]
    buffer_load_dwordx4 v[60:63], v12, s[20:23], s34 offen offset:2304
    s_add_u32 s34, s34, 4096
    s_waitcnt lgkmcnt(4)
    v_mfma_f32_16x16x32_bf16 v[96:99], v[176:179], v[24:27], v[96:99]
    ds_read_b128 v[172:175], v2 offset:15360
    v_mfma_f32_16x16x32_bf16 v[100:103], v[176:179], v[28:31], v[100:103]
    s_add_u32 m0, s35, 46080
    s_nop 0
    buffer_load_dwordx4 v2, s[20:23], s37 offen lds
    s_waitcnt lgkmcnt(4)
    v_mfma_f32_16x16x32_bf16 v[104:107], v[180:183], v[24:27], v[104:107]
    ds_read_b128 v[176:179], v2 offset:16384
    v_mfma_f32_16x16x32_bf16 v[108:111], v[180:183], v[28:31], v[108:111]
    s_waitcnt lgkmcnt(4)
    v_mfma_f32_16x16x32_bf16 v[112:115], v[160:163], v[24:27], v[112:115]
    ds_read_b128 v[180:183], v2 offset:17408
    v_mfma_f32_16x16x32_bf16 v[116:119], v[160:163], v[28:31], v[116:119]
    buffer_load_dwordx4 v2, s[20:23], s37 offen offset:1024 lds
    s_add_u32 s37, s37, 9216
    s_waitcnt vmcnt(9)
    s_barrier
    s_waitcnt lgkmcnt(4)
    v_mfma_f32_16x16x32_bf16 v[120:123], v[164:167], v[24:27], v[120:123]
    ds_read_b128 v[160:163], v2 offset:18432
    v_mfma_f32_16x16x32_bf16 v[124:127], v[164:167], v[28:31], v[124:127]
    s_add_u32 m0, s36, 46080
    s_mov_b64 exec, 0xffff
    buffer_load_dwordx4 v2, s[20:23], s38 offen lds
    s_mov_b64 exec, -1
    s_add_u32 s38, s38, 9216
    s_waitcnt lgkmcnt(4)
    v_mfma_f32_16x16x32_bf16 v[128:131], v[168:171], v[24:27], v[128:131]
    ds_read_b128 v[164:167], v2 offset:19456
    v_mfma_f32_16x16x32_bf16 v[132:135], v[168:171], v[28:31], v[132:135]
    s_waitcnt lgkmcnt(4)
    v_mfma_f32_16x16x32_bf16 v[136:139], v[172:175], v[24:27], v[136:139]
    ds_read_b128 v[168:171], v2 offset:20480
    v_mfma_f32_16x16x32_bf16 v[140:143], v[172:175], v[28:31], v[140:143]
    buffer_load_dwordx4 v[64:67], v12, s[20:23], s34 offen offset:0
    s_waitcnt lgkmcnt(4)
    v_mfma_f32_16x16x32_bf16 v[144:147], v[176:179], v[24:27], v[144:147]
    ds_read_b128 v[172:175], v2 offset:21504
    v_mfma_f32_16x16x32_bf16 v[148:151], v[176:179], v[28:31], v[148:151]
    buffer_load_dwordx4 v[68:71], v12, s[20:23], s34 offen offset:256
    s_waitcnt lgkmcnt(4)
    v_mfma_f32_16x16x32_bf16 v[152:155], v[180:183], v[24:27], v[152:155]
    ds_read_b128 v[176:179], v2 offset:22528
    v_mfma_f32_16x16x32_bf16 v[156:159], v[180:183], v[28:31], v[156:159]
    s_waitcnt lgkmcnt(4)
    v_mfma_f32_16x16x32_bf16 v[88:91], v[160:163], v[32:35], v[88:91]
    ds_read_b128 v[180:183], v2 offset:23552
    v_mfma_f32_16x16x32_bf16 v[92:95], v[160:163], v[36:39], v[92:95]
    s_add_u32 m0, s35, 55296
    s_nop 0
    buffer_load_dwordx4 v2, s[20:23], s37 offen lds
    s_waitcnt lgkmcnt(4)
    v_mfma_f32_16x16x32_bf16 v[96:99], v[164:167], v[32:35], v[96:99]
    ds_read_b128 v[160:163], v2 offset:24576
    v_mfma_f32_16x16x32_bf16 v[100:103], v[164:167], v[36:39], v[100:103]
    buffer_load_dwordx4 v2, s[20:23], s37 offen offset:1024 lds
    s_add_u32 s37, s37, 9216
    s_waitcnt lgkmcnt(4)
    v_mfma_f32_16x16x32_bf16 v[104:107], v[168:171], v[32:35], v[104:107]
    ds_read_b128 v[164:167], v2 offset:25600
    v_mfma_f32_16x16x32_bf16 v[108:111], v[168:171], v[36:39], v[108:111]
    s_waitcnt lgkmcnt(4)
    v_mfma_f32_16x16x32_bf16 v[112:115], v[172:175], v[32:35], v[112:115]
    ds_read_b128 v[168:171], v2 offset:26624
    v_mfma_f32_16x16x32_bf16 v[116:119], v[172:175], v[36:39], v[116:119]
    s_add_u32 m0, s36, 55296
    s_mov_b64 exec, 0xffff
    buffer_load_dwordx4 v2, s[20:23], s38 offen lds
    s_mov_b64 exec, -1
    s_add_u32 s38, s38, 9216
    s_waitcnt lgkmcnt(4)
    v_mfma_f32_16x16x32_bf16 v[120:123], v[176:179], v[32:35], v[120:123]
    ds_read_b128 v[172:175], v2 offset:27648
    v_mfma_f32_16x16x32_bf16 v[124:127], v[176:179], v[36:39], v[124:127]
    buffer_load_dwordx4 v[72:75], v12, s[20:23], s34 offen offset:2048
    s_waitcnt lgkmcnt(4)
    v_mfma_f32_16x16x32_bf16 v[128:131], v[180:183], v[32:35], v[128:131]
    ds_read_b128 v[176:179], v2 offset:28672
    v_mfma_f32_16x16x32_bf16 v[132:135], v[180:183], v[36:39], v[132:135]
    s_waitcnt lgkmcnt(4)
    v_mfma_f32_16x16x32_bf16 v[136:139], v[160:163], v[32:35], v[136:139]
    ds_read_b128 v[180:183], v2 offset:29696
    v_mfma_f32_16x16x32_bf16 v[140:143], v[160:163], v[36:39], v[140:143]
    buffer_load_dwordx4 v[76:79], v12, s[20:23], s34 offen offset:2304
    s_add_u32 s34, s34, 4096
    s_waitcnt lgkmcnt(4)
    v_mfma_f32_16x16x32_bf16 v[144:147], v[164:167], v[32:35], v[144:147]
    ds_read_b128 v[160:163], v2 offset:30720
    v_mfma_f32_16x16x32_bf16 v[148:151], v[164:167], v[36:39], v[148:151]
    s_add_u32 m0, s35, 64512
    s_nop 0
    buffer_load_dwordx4 v2, s[20:23], s37 offen lds
    s_waitcnt lgkmcnt(4)
    v_mfma_f32_16x16x32_bf16 v[152:155], v[168:171], v[32:35], v[152:155]
    ds_read_b128 v[164:167], v2 offset:31744
    v_mfma_f32_16x16x32_bf16 v[156:159], v[168:171], v[36:39], v[156:159]
    s_waitcnt lgkmcnt(4)
    v_mfma_f32_16x16x32_bf16 v[88:91], v[172:175], v[40:43], v[88:91]
    ds_read_b128 v[168:171], v2 offset:32768
    v_mfma_f32_16x16x32_bf16 v[92:95], v[172:175], v[44:47], v[92:95]
    buffer_load_dwordx4 v2, s[20:23], s37 offen offset:1024 lds
    s_add_u32 s37, s37, 9216
    s_waitcnt lgkmcnt(4)
    v_mfma_f32_16x16x32_bf16 v[96:99], v[176:179], v[40:43], v[96:99]
    ds_read_b128 v[172:175], v2 offset:33792
    v_mfma_f32_16x16x32_bf16 v[100:103], v[176:179], v[44:47], v[100:103]
    s_add_u32 m0, s36, 64512
    s_mov_b64 exec, 0xffff
    buffer_load_dwordx4 v2, s[20:23], s38 offen lds
    s_mov_b64 exec, -1
    s_add_u32 s38, s38, 9216
    s_waitcnt lgkmcnt(4)
    v_mfma_f32_16x16x32_bf16 v[104:107], v[180:183], v[40:43], v[104:107]
    ds_read_b128 v[176:179], v2 offset:34816
    v_mfma_f32_16x16x32_bf16 v[108:111], v[180:183], v[44:47], v[108:111]
    s_waitcnt lgkmcnt(4)
    v_mfma_f32_16x16x32_bf16 v[112:115], v[160:163], v[40:43], v[112:115]
    ds_read_b128 v[180:183], v2 offset:35840
    v_mfma_f32_16x16x32_bf16 v[116:119], v[160:163], v[44:47], v[116:119]
    buffer_load_dwordx4 v[16:19], v12, s[20:23], s34 offen offset:0
    s_waitcnt vmcnt(11)
    s_barrier
    s_waitcnt lgkmcnt(4)
    v_mfma_f32_16x16x32_bf16 v[120:123], v[164:167], v[40:43], v[120:123]
    ds_read_b128 v[160:163], v3 offset:0
    v_mfma_f32_16x16x32_bf16 v[124:127], v[164:167], v[44:47], v[124:127]
    buffer_load_dwordx4 v[20:23], v12, s[20:23], s34 offen offset:256
    s_waitcnt lgkmcnt(4)
    v_mfma_f32_16x16x32_bf16 v[128:131], v[168:171], v[40:43], v[128:131]
    ds_read_b128 v[164:167], v3 offset:1024
    v_mfma_f32_16x16x32_bf16 v[132:135], v[168:171], v[44:47], v[132:135]
    s_waitcnt lgkmcnt(4)
    v_mfma_f32_16x16x32_bf16 v[136:139], v[172:175], v[40:43], v[136:139]
    ds_read_b128 v[168:171], v3 offset:2048
    v_mfma_f32_16x16x32_bf16 v[140:143], v[172:175], v[44:47], v[140:143]
    s_add_u32 m0, s35, 0
    s_nop 0
    buffer_load_dwordx4 v2, s[20:23], s37 offen lds
    s_waitcnt lgkmcnt(4)
    v_mfma_f32_16x16x32_bf16 v[144:147], v[176:179], v[40:43], v[144:147]
    ds_read_b128 v[172:175], v3 offset:3072
    v_mfma_f32_16x16x32_bf16 v[148:151], v[176:179], v[44:47], v[148:151]
    buffer_load_dwordx4 v2, s[20:23], s37 offen offset:1024 lds
    s_add_u32 s37, s37, 9216
    s_waitcnt lgkmcnt(4)
    v_mfma_f32_16x16x32_bf16 v[152:155], v[180:183], v[40:43], v[152:155]
    ds_read_b128 v[176:179], v3 offset:4096
    v_mfma_f32_16x16x32_bf16 v[156:159], v[180:183], v[44:47], v[156:159]
    s_waitcnt lgkmcnt(4)
    v_mfma_f32_16x16x32_bf16 v[88:91], v[160:163], v[48:51], v[88:91]
    ds_read_b128 v[180:183], v3 offset:5120
    v_mfma_f32_16x16x32_bf16 v[92:95], v[160:163], v[52:55], v[92:95]
    s_add_u32 m0, s36, 0
    s_mov_b64 exec, 0xffff
    buffer_load_dwordx4 v2, s[20:23], s38 offen lds
    s_mov_b64 exec, -1
    s_add_u32 s38, s38, 9216
    s_waitcnt lgkmcnt(4)
    v_mfma_f32_16x16x32_bf16 v[96:99], v[164:167], v[48:51], v[96:99]
    ds_read_b128 v[160:163], v3 offset:6144
    v_mfma_f32_16x16x32_bf16 v[100:103], v[164:167], v[52:55], v[100:103]
    buffer_load_dwordx4 v[24:27], v12, s[20:23], s34 offen offset:2048
    s_waitcnt lgkmcnt(4)
    v_mfma_f32_16x16x32_bf16 v[104:107], v[168:171], v[48:51], v[104:107]
    ds_read_b128 v[164:167], v3 offset:7168
    v_mfma_f32_16x16x32_bf16 v[108:111], v[168:171], v[52:55], v[108:111]
    s_waitcnt lgkmcnt(4)
    v_mfma_f32_16x16x32_bf16 v[112:115], v[172:175], v[48:51], v[112:115]
    ds_read_b128 v[168:171], v3 offset:8192
    v_mfma_f32_16x16x32_bf16 v[116:119], v[172:175], v[52:55], v[116:119]
    buffer_load_dwordx4 v[28:31], v12, s[20:23], s34 offen offset:2304
    s_add_u32 s34, s34, 4096
    s_waitcnt lgkmcnt(4)
    v_mfma_f32_16x16x32_bf16 v[120:123], v[176:179], v[48:51], v[120:123]
    ds_read_b128 v[172:175], v3 offset:9216
    v_mfma_f32_16x16x32_bf16 v[124:127], v[176:179], v[52:55], v[124:127]
    s_add_u32 m0, s35, 9216
    s_nop 0
    buffer_load_dwordx4 v2, s[20:23], s37 offen lds
    s_waitcnt lgkmcnt(4)
    v_mfma_f32_16x16x32_bf16 v[128:131], v[180:183], v[48:51], v[128:131]
    ds_read_b128 v[176:179], v3 offset:10240
    v_mfma_f32_16x16x32_bf16 v[132:135], v[180:183], v[52:55], v[132:135]
    s_waitcnt lgkmcnt(4)
    v_mfma_f32_16x16x32_bf16 v[136:139], v[160:163], v[48:51], v[136:139]
    ds_read_b128 v[180:183], v3 offset:11264
    v_mfma_f32_16x16x32_bf16 v[140:143], v[160:163], v[52:55], v[140:143]
    buffer_load_dwordx4 v2, s[20:23], s37 offen offset:1024 lds
    s_add_u32 s37, s37, 9216
    s_waitcnt lgkmcnt(4)
    v_mfma_f32_16x16x32_bf16 v[144:147], v[164:167], v[48:51], v[144:147]
    ds_read_b128 v[160:163], v3 offset:12288
    v_mfma_f32_16x16x32_bf16 v[148:151], v[164:167], v[52:55], v[148:151]
    s_add_u32 m0, s36, 9216
    s_mov_b64 exec, 0xffff
    buffer_load_dwordx4 v2, s[20:23], s38 offen lds
    s_mov_b64 exec, -1
    s_add_u32 s38, s38, 9216
    s_waitcnt lgkmcnt(4)
    v_mfma_f32_16x16x32_bf16 v[152:155], v[168:171], v[48:51], v[152:155]
    ds_read_b128 v[164:167], v3 offset:13312
    v_mfma_f32_16x16x32_bf16 v[156:159], v[168:171], v[52:55], v[156:159]
    s_waitcnt lgkmcnt(4)
    v_mfma_f32_16x16x32_bf16 v[88:91], v[172:175], v[56:59], v[88:91]
    ds_read_b128 v[168:171], v3 offset:14336
    v_mfma_f32_16x16x32_bf16 v[92:95], v[172:175], v[60:63], v[92:95]
    buffer_load_dwordx4 v[32:35], v12, s[20:23], s34 offen offset:0
    s_waitcnt lgkmcnt(4)
    v_mfma_f32_16x16x32_bf16 v[96:99], v[176:179], v[56:59], v[96:99]
    ds_read_b128 v[172:175], v3 offset:15360
    v_mfma_f32_16x16x32_bf16 v[100:103], v[176:179], v[60:63], v[100:103]
    buffer_load_dwordx4 v[36:39], v12, s[20:23], s34 offen offset:256
    s_waitcnt lgkmcnt(4)
    v_mfma_f32_16x16x32_bf16 v[104:107], v[180:183], v[56:59], v[104:107]
    ds_read_b128 v[176:179], v3 offset:16384
    v_mfma_f32_16x16x32_bf16 v[108:111], v[180:183], v[60:63], v[108:111]
    s_waitcnt lgkmcnt(4)
    v_mfma_f32_16x16x32_bf16 v[112:115], v[160:163], v[56:59], v[112:115]
    ds_read_b128 v[180:183], v3 offset:17408
    v_mfma_f32_16x16x32_bf16 v[116:119], v[160:163], v[60:63], v[116:119]
    s_add_u32 m0, s35, 18432
    s_nop 0
    buffer_load_dwordx4 v2, s[20:23], s37 offen lds
    s_waitcnt vmcnt(13)
    s_barrier
    s_waitcnt lgkmcnt(4)
    v_mfma_f32_16x16x32_bf16 v[120:123], v[164:167], v[56:59], v[120:123]
    ds_read_b128 v[160:163], v3 offset:18432
    v_mfma_f32_16x16x32_bf16 v[124:127], v[164:167], v[60:63], v[124:127]
    buffer_load_dwordx4 v2, s[20:23], s37 offen offset:1024 lds
    s_add_u32 s37, s37, 9216
    s_waitcnt lgkmcnt(4)
    v_mfma_f32_16x16x32_bf16 v[128:131], v[168:171], v[56:59], v[128:131]
    ds_read_b128 v[164:167], v3 offset:19456
    v_mfma_f32_16x16x32_bf16 v[132:135], v[168:171], v[60:63], v[132:135]
    s_waitcnt lgkmcnt(4)
    v_mfma_f32_16x16x32_bf16 v[136:139], v[172:175], v[56:59], v[136:139]
    ds_read_b128 v[168:171], v3 offset:20480
    v_mfma_f32_16x16x32_bf16 v[140:143], v[172:175], v[60:63], v[140:143]
    s_add_u32 m0, s36, 18432
    s_mov_b64 exec, 0xffff
    buffer_load_dwordx4 v2, s[20:23], s38 offen lds
    s_mov_b64 exec, -1
    s_add_u32 s38, s38, 9216
    s_waitcnt lgkmcnt(4)
    v_mfma_f32_16x16x32_bf16 v[144:147], v[176:179], v[56:59], v[144:147]
    ds_read_b128 v[172:175], v3 offset:21504
    v_mfma_f32_16x16x32_bf16 v[148:151], v[176:179], v[60:63], v[148:151]
    buffer_load_dwordx4 v[40:43], v12, s[20:23], s34 offen offset:2048
    s_waitcnt lgkmcnt(4)
    v_mfma_f32_16x16x32_bf16 v[152:155], v[180:183], v[56:59], v[152:155]
    ds_read_b128 v[176:179], v3 offset:22528
    v_mfma_f32_16x16x32_bf16 v[156:159], v[180:183], v[60:63], v[156:159]
    s_waitcnt lgkmcnt(4)
    v_mfma_f32_16x16x32_bf16 v[88:91], v[160:163], v[64:67], v[88:91]
    ds_read_b128 v[180:183], v3 offset:23552
    v_mfma_f32_16x16x32_bf16 v[92:95], v[160:163], v[68:71], v[92:95]
    buffer_load_dwordx4 v[44:47], v12, s[20:23], s34 offen offset:2304
    s_add_u32 s34, s34, 4096
    s_waitcnt lgkmcnt(4)
    v_mfma_f32_16x16x32_bf16 v[96:99], v[164:167], v[64:67], v[96:99]
    ds_read_b128 v[160:163], v3 offset:24576
    v_mfma_f32_16x16x32_bf16 v[100:103], v[164:167], v[68:71], v[100:103]
    s_add_u32 m0, s35, 27648
    s_nop 0
    buffer_load_dwordx4 v2, s[20:23], s37 offen lds
    s_waitcnt lgkmcnt(4)
    v_mfma_f32_16x16x32_bf16 v[104:107], v[168:171], v[64:67], v[104:107]
    ds_read_b128 v[164:167], v3 offset:25600
    v_mfma_f32_16x16x32_bf16 v[108:111], v[168:171], v[68:71], v[108:111]
    s_waitcnt lgkmcnt(4)
    v_mfma_f32_16x16x32_bf16 v[112:115], v[172:175], v[64:67], v[112:115]
    ds_read_b128 v[168:171], v3 offset:26624
    v_mfma_f32_16x16x32_bf16 v[116:119], v[172:175], v[68:71], v[116:119]
    buffer_load_dwordx4 v2, s[20:23], s37 offen offset:1024 lds
    s_add_u32 s37, s37, 9216
    s_waitcnt lgkmcnt(4)
    v_mfma_f32_16x16x32_bf16 v[120:123], v[176:179], v[64:67], v[120:123]
    ds_read_b128 v[172:175], v3 offset:27648
    v_mfma_f32_16x16x32_bf16 v[124:127], v[176:179], v[68:71], v[124:127]
    s_add_u32 m0, s36, 27648
    s_mov_b64 exec, 0xffff
    buffer_load_dwordx4 v2, s[20:23], s38 offen lds
    s_mov_b64 exec, -1
    s_add_u32 s38, s38, 9216
    s_waitcnt lgkmcnt(4)
    v_mfma_f32_16x16x32_bf16 v[128:131], v[180:183], v[64:67], v[128:131]
    ds_read_b128 v[176:179], v3 offset:28672
    v_mfma_f32_16x16x32_bf16 v[132:135], v[180:183], v[68:71], v[132:135]
    s_waitcnt lgkmcnt(4)
    v_mfma_f32_16x16x32_bf16 v[136:139], v[160:163], v[64:67], v[136:139]
    ds_read_b128 v[180:183], v3 offset:29696
    v_mfma_f32_16x16x32_bf16 v[140:143], v[160:163], v[68:71], v[140:143]
    buffer_load_dwordx4 v[48:51], v12, s[20:23], s34 offen offset:0
    s_waitcnt lgkmcnt(4)
    v_mfma_f32_16x16x32_bf16 v[144:147], v[164:167], v[64:67], v[144:147]
    ds_read_b128 v[160:163], v3 offset:30720
    v_mfma_f32_16x16x32_bf16 v[148:151], v[164:167], v[68:71], v[148:151]
    buffer_load_dwordx4 v[52:55], v12, s[20:23], s34 offen offset:256
    s_waitcnt lgkmcnt(4)
    v_mfma_f32_16x16x32_bf16 v[152:155], v[168:171], v[64:67], v[152:155]
    ds_read_b128 v[164:167], v3 offset:31744
    v_mfma_f32_16x16x32_bf16 v[156:159], v[168:171], v[68:71], v[156:159]
    s_waitcnt lgkmcnt(4)
    v_mfma_f32_16x16x32_bf16 v[88:91], v[172:175], v[72:75], v[88:91]
    ds_read_b128 v[168:171], v3 offset:32768
    v_mfma_f32_16x16x32_bf16 v[92:95], v[172:175], v[76:79], v[92:95]
    s_add_u32 m0, s35, 36864
    s_nop 0
    buffer_load_dwordx4 v2, s[20:23], s37 offen lds
    s_waitcnt lgkmcnt(4)
    v_mfma_f32_16x16x32_bf16 v[96:99], v[176:179], v[72:75], v[96:99]
    ds_read_b128 v[172:175], v3 offset:33792
    v_mfma_f32_16x16x32_bf16 v[100:103], v[176:179], v[76:79], v[100:103]
    buffer_load_dwordx4 v2, s[20:23], s37 offen offset:1024 lds
    s_add_u32 s37, s37, 9216
    s_waitcnt lgkmcnt(4)
    v_mfma_f32_16x16x32_bf16 v[104:107], v[180:183], v[72:75], v[104:107]
    ds_read_b128 v[176:179], v3 offset:34816
    v_mfma_f32_16x16x32_bf16 v[108:111], v[180:183], v[76:79], v[108:111]
    s_waitcnt lgkmcnt(4)
    v_mfma_f32_16x16x32_bf16 v[112:115], v[160:163], v[72:75], v[112:115]
    ds_read_b128 v[180:183], v3 offset:35840
    v_mfma_f32_16x16x32_bf16 v[116:119], v[160:163], v[76:79], v[116:119]
    s_add_u32 m0, s36, 36864
    s_mov_b64 exec, 0xffff
    buffer_load_dwordx4 v2, s[20:23], s38 offen lds
    s_mov_b64 exec, -1
    s_add_u32 s38, s38, 9216
    s_waitcnt vmcnt(15)
    s_barrier
    s_waitcnt lgkmcnt(4)
    v_mfma_f32_16x16x32_bf16 v[120:123], v[164:167], v[72:75], v[120:123]
    ds_read_b128 v[160:163], v2 offset:0
    v_mfma_f32_16x16x32_bf16 v[124:127], v[164:167], v[76:79], v[124:127]
    buffer_load_dwordx4 v[56:59], v12, s[20:23], s34 offen offset:2048
    s_waitcnt lgkmcnt(4)
    v_mfma_f32_16x16x32_bf16 v[128:131], v[168:171], v[72:75], v[128:131]
    ds_read_b128 v[164:167], v2 offset:1024
    v_mfma_f32_16x16x32_bf16 v[132:135], v[168:171], v[76:79], v[132:135]
    s_waitcnt lgkmcnt(4)
    v_mfma_f32_16x16x32_bf16 v[136:139], v[172:175], v[72:75], v[136:139]
    ds_read_b128 v[168:171], v2 offset:2048
    v_mfma_f32_16x16x32_bf16 v[140:143], v[172:175], v[76:79], v[140:143]
    buffer_load_dwordx4 v[60:63], v12, s[20:23], s34 offen offset:2304
    s_add_u32 s34, s34, 4096
    s_waitcnt lgkmcnt(4)
    v_mfma_f32_16x16x32_bf16 v[144:147], v[176:179], v[72:75], v[144:147]
    ds_read_b128 v[172:175], v2 offset:3072
    v_mfma_f32_16x16x32_bf16 v[148:151], v[176:179], v[76:79], v[148:151]
    s_add_u32 m0, s35, 46080
    s_nop 0
    buffer_load_dwordx4 v2, s[20:23], s37 offen lds
    s_waitcnt lgkmcnt(4)
    v_mfma_f32_16x16x32_bf16 v[152:155], v[180:183], v[72:75], v[152:155]
    ds_read_b128 v[176:179], v2 offset:4096
    v_mfma_f32_16x16x32_bf16 v[156:159], v[180:183], v[76:79], v[156:159]
    s_waitcnt lgkmcnt(4)
    v_mfma_f32_16x16x32_bf16 v[88:91], v[160:163], v[16:19], v[88:91]
    ds_read_b128 v[180:183], v2 offset:5120
    v_mfma_f32_16x16x32_bf16 v[92:95], v[160:163], v[20:23], v[92:95]
    buffer_load_dwordx4 v2, s[20:23], s37 offen offset:1024 lds
    s_add_u32 s37, s37, 9216
    s_waitcnt lgkmcnt(4)
    v_mfma_f32_16x16x32_bf16 v[96:99], v[164:167], v[16:19], v[96:99]
    ds_read_b128 v[160:163], v2 offset:6144
    v_mfma_f32_16x16x32_bf16 v[100:103], v[164:167], v[20:23], v[100:103]
    s_add_u32 m0, s36, 46080
    s_mov_b64 exec, 0xffff
    buffer_load_dwordx4 v2, s[20:23], s38 offen lds
    s_mov_b64 exec, -1
    s_add_u32 s38, s38, 9216
    s_waitcnt lgkmcnt(4)
    v_mfma_f32_16x16x32_bf16 v[104:107], v[168:171], v[16:19], v[104:107]
    ds_read_b128 v[164:167], v2 offset:7168
    v_mfma_f32_16x16x32_bf16 v[108:111], v[168:171], v[20:23], v[108:111]
    s_waitcnt lgkmcnt(4)
    v_mfma_f32_16x16x32_bf16 v[112:115], v[172:175], v[16:19], v[112:115]
    ds_read_b128 v[168:171], v2 offset:8192
    v_mfma_f32_16x16x32_bf16 v[116:119], v[172:175], v[20:23], v[116:119]
    buffer_load_dwordx4 v[64:67], v12, s[20:23], s34 offen offset:0
    s_waitcnt lgkmcnt(4)
    v_mfma_f32_16x16x32_bf16 v[120:123], v[176:179], v[16:19], v[120:123]
    ds_read_b128 v[172:175], v2 offset:9216
    v_mfma_f32_16x16x32_bf16 v[124:127], v[176:179], v[20:23], v[124:127]
    buffer_load_dwordx4 v[68:71], v12, s[20:23], s34 offen offset:256
    s_waitcnt lgkmcnt(4)
    v_mfma_f32_16x16x32_bf16 v[128:131], v[180:183], v[16:19], v[128:131]
    ds_read_b128 v[176:179], v2 offset:10240
    v_mfma_f32_16x16x32_bf16 v[132:135], v[180:183], v[20:23], v[132:135]
    s_waitcnt lgkmcnt(4)
    v_mfma_f32_16x16x32_bf16 v[136:139], v[160:163], v[16:19], v[136:139]
    ds_read_b128 v[180:183], v2 offset:11264
    v_mfma_f32_16x16x32_bf16 v[140:143], v[160:163], v[20:23], v[140:143]
    s_add_u32 m0, s35, 55296
    s_nop 0
    buffer_load_dwordx4 v2, s[20:23], s37 offen lds
    s_waitcnt lgkmcnt(4)
    v_mfma_f32_16x16x32_bf16 v[144:147], v[164:167], v[16:19], v[144:147]
    ds_read_b128 v[160:163], v2 offset:12288
    v_mfma_f32_16x16x32_bf16 v[148:151], v[164:167], v[20:23], v[148:151]
    buffer_load_dwordx4 v2, s[20:23], s37 offen offset:1024 lds
    s_add_u32 s37, s37, 9216
    s_waitcnt lgkmcnt(4)
    v_mfma_f32_16x16x32_bf16 v[152:155], v[168:171], v[16:19], v[152:155]
    ds_read_b128 v[164:167], v2 offset:13312
    v_mfma_f32_16x16x32_bf16 v[156:159], v[168:171], v[20:23], v[156:159]
    s_waitcnt lgkmcnt(4)
    v_mfma_f32_16x16x32_bf16 v[88:91], v[172:175], v[24:27], v[88:91]
    ds_read_b128 v[168:171], v2 offset:14336
    v_mfma_f32_16x16x32_bf16 v[92:95], v[172:175], v[28:31], v[92:95]
    s_add_u32 m0, s36, 55296
    s_mov_b64 exec, 0xffff
    buffer_load_dwordx4 v2, s[20:23], s38 offen lds
    s_mov_b64 exec, -1
    s_add_u32 s38, s38, 9216
    s_waitcnt lgkmcnt(4)
    v_mfma_f32_16x16x32_bf16 v[96:99], v[176:179], v[24:27], v[96:99]
    ds_read_b128 v[172:175], v2 offset:15360
    v_mfma_f32_16x16x32_bf16 v[100:103], v[176:179], v[28:31], v[100:103]
    buffer_load_dwordx4 v[72:75], v12, s[20:23], s34 offen offset:2048
    s_waitcnt lgkmcnt(4)
    v_mfma_f32_16x16x32_bf16 v[104:107], v[180:183], v[24:27], v[104:107]
    ds_read_b128 v[176:179], v2 offset:16384
    v_mfma_f32_16x16x32_bf16 v[108:111], v[180:183], v[28:31], v[108:111]
    s_waitcnt lgkmcnt(4)
    v_mfma_f32_16x16x32_bf16 v[112:115], v[160:163], v[24:27], v[112:115]
    ds_read_b128 v[180:183], v2 offset:17408
    v_mfma_f32_16x16x32_bf16 v[116:119], v[160:163], v[28:31], v[116:119]
    buffer_load_dwordx4 v[76:79], v12, s[20:23], s34 offen offset:2304
    s_add_u32 s34, s34, 4096
    s_waitcnt vmcnt(17)
    s_barrier
    s_waitcnt lgkmcnt(4)
    v_mfma_f32_16x16x32_bf16 v[120:123], v[164:167], v[24:27], v[120:123]
    ds_read_b128 v[160:163], v2 offset:18432
    v_mfma_f32_16x16x32_bf16 v[124:127], v[164:167], v[28:31], v[124:127]
    s_add_u32 m0, s35, 64512
    s_nop 0
    buffer_load_dwordx4 v2, s[20:23], s37 offen lds
    s_waitcnt lgkmcnt(4)
    v_mfma_f32_16x16x32_bf16 v[128:131], v[168:171], v[24:27], v[128:131]
    ds_read_b128 v[164:167], v2 offset:19456
    v_mfma_f32_16x16x32_bf16 v[132:135], v[168:171], v[28:31], v[132:135]
    s_waitcnt lgkmcnt(4)
    v_mfma_f32_16x16x32_bf16 v[136:139], v[172:175], v[24:27], v[136:139]
    ds_read_b128 v[168:171], v2 offset:20480
    v_mfma_f32_16x16x32_bf16 v[140:143], v[172:175], v[28:31], v[140:143]
    buffer_load_dwordx4 v2, s[20:23], s37 offen offset:1024 lds
    s_add_u32 s37, s37, 9216
    s_waitcnt lgkmcnt(4)
    v_mfma_f32_16x16x32_bf16 v[144:147], v[176:179], v[24:27], v[144:147]
    ds_read_b128 v[172:175], v2 offset:21504
    v_mfma_f32_16x16x32_bf16 v[148:151], v[176:179], v[28:31], v[148:151]
    s_add_u32 m0, s36, 64512
    s_mov_b64 exec, 0xffff
    buffer_load_dwordx4 v2, s[20:23], s38 offen lds
    s_mov_b64 exec, -1
    s_add_u32 s38, s38, 9216
    s_waitcnt lgkmcnt(4)
    v_mfma_f32_16x16x32_bf16 v[152:155], v[180:183], v[24:27], v[152:155]
    ds_read_b128 v[176:179], v2 offset:22528
    v_mfma_f32_16x16x32_bf16 v[156:159], v[180:183], v[28:31], v[156:159]
    s_waitcnt lgkmcnt(4)
    v_mfma_f32_16x16x32_bf16 v[88:91], v[160:163], v[32:35], v[88:91]
    ds_read_b128 v[180:183], v2 offset:23552
    v_mfma_f32_16x16x32_bf16 v[92:95], v[160:163], v[36:39], v[92:95]
    buffer_load_dwordx4 v[16:19], v12, s[20:23], s34 offen offset:0
    s_waitcnt lgkmcnt(4)
    v_mfma_f32_16x16x32_bf16 v[96:99], v[164:167], v[32:35], v[96:99]
    ds_read_b128 v[160:163], v2 offset:24576
    v_mfma_f32_16x16x32_bf16 v[100:103], v[164:167], v[36:39], v[100:103]
    buffer_load_dwordx4 v[20:23], v12, s[20:23], s34 offen offset:256
    s_waitcnt lgkmcnt(4)
    v_mfma_f32_16x16x32_bf16 v[104:107], v[168:171], v[32:35], v[104:107]
    ds_read_b128 v[164:167], v2 offset:25600
    v_mfma_f32_16x16x32_bf16 v[108:111], v[168:171], v[36:39], v[108:111]
    s_waitcnt lgkmcnt(4)
    v_mfma_f32_16x16x32_bf16 v[112:115], v[172:175], v[32:35], v[112:115]
    ds_read_b128 v[168:171], v2 offset:26624
    v_mfma_f32_16x16x32_bf16 v[116:119], v[172:175], v[36:39], v[116:119]
    s_add_u32 m0, s35, 0
    s_nop 0
    buffer_load_dwordx4 v2, s[20:23], s37 offen lds
    s_waitcnt lgkmcnt(4)
    v_mfma_f32_16x16x32_bf16 v[120:123], v[176:179], v[32:35], v[120:123]
    ds_read_b128 v[172:175], v2 offset:27648
    v_mfma_f32_16x16x32_bf16 v[124:127], v[176:179], v[36:39], v[124:127]
    buffer_load_dwordx4 v2, s[20:23], s37 offen offset:1024 lds
    s_add_u32 s37, s37, 9216
    s_waitcnt lgkmcnt(4)
    v_mfma_f32_16x16x32_bf16 v[128:131], v[180:183], v[32:35], v[128:131]
    ds_read_b128 v[176:179], v2 offset:28672
    v_mfma_f32_16x16x32_bf16 v[132:135], v[180:183], v[36:39], v[132:135]
    s_waitcnt lgkmcnt(4)
    v_mfma_f32_16x16x32_bf16 v[136:139], v[160:163], v[32:35], v[136:139]
    ds_read_b128 v[180:183], v2 offset:29696
    v_mfma_f32_16x16x32_bf16 v[140:143], v[160:163], v[36:39], v[140:143]
    s_add_u32 m0, s36, 0
    s_mov_b64 exec, 0xffff
    buffer_load_dwordx4 v2, s[20:23], s38 offen lds
    s_mov_b64 exec, -1
    s_add_u32 s38, s38, 9216
    s_waitcnt lgkmcnt(4)
    v_mfma_f32_16x16x32_bf16 v[144:147], v[164:167], v[32:35], v[144:147]
    ds_read_b128 v[160:163], v2 offset:30720
    v_mfma_f32_16x16x32_bf16 v[148:151], v[164:167], v[36:39], v[148:151]
    s_waitcnt lgkmcnt(4)
    v_mfma_f32_16x16x32_bf16 v[152:155], v[168:171], v[32:35], v[152:155]
    ds_read_b128 v[164:167], v2 offset:31744
    v_mfma_f32_16x16x32_bf16 v[156:159], v[168:171], v[36:39], v[156:159]
    s_waitcnt lgkmcnt(4)
    v_mfma_f32_16x16x32_bf16 v[88:91], v[172:175], v[40:43], v[88:91]
    ds_read_b128 v[168:171], v2 offset:32768
    v_mfma_f32_16x16x32_bf16 v[92:95], v[172:175], v[44:47], v[92:95]
    buffer_load_dwordx4 v[24:27], v12, s[20:23], s34 offen offset:2048
    s_waitcnt lgkmcnt(4)
    v_mfma_f32_16x16x32_bf16 v[96:99], v[176:179], v[40:43], v[96:99]
    ds_read_b128 v[172:175], v2 offset:33792
    v_mfma_f32_16x16x32_bf16 v[100:103], v[176:179], v[44:47], v[100:103]
    buffer_load_dwordx4 v[28:31], v12, s[20:23], s34 offen offset:2304
    s_add_u32 s34, s34, 4096
    s_waitcnt lgkmcnt(4)
    v_mfma_f32_16x16x32_bf16 v[104:107], v[180:183], v[40:43], v[104:107]
    ds_read_b128 v[176:179], v2 offset:34816
    v_mfma_f32_16x16x32_bf16 v[108:111], v[180:183], v[44:47], v[108:111]
    s_waitcnt lgkmcnt(4)
    v_mfma_f32_16x16x32_bf16 v[112:115], v[160:163], v[40:43], v[112:115]
    ds_read_b128 v[180:183], v2 offset:35840
    v_mfma_f32_16x16x32_bf16 v[116:119], v[160:163], v[44:47], v[116:119]
    s_waitcnt vmcnt(17)
    s_barrier
    s_waitcnt lgkmcnt(4)
    v_mfma_f32_16x16x32_bf16 v[120:123], v[164:167], v[40:43], v[120:123]
    ds_read_b128 v[160:163], v3 offset:0
    v_mfma_f32_16x16x32_bf16 v[124:127], v[164:167], v[44:47], v[124:127]
    s_add_u32 m0, s35, 9216
    s_nop 0
    buffer_load_dwordx4 v2, s[20:23], s37 offen lds
    s_waitcnt lgkmcnt(4)
    v_mfma_f32_16x16x32_bf16 v[128:131], v[168:171], v[40:43], v[128:131]
    ds_read_b128 v[164:167], v3 offset:1024
    v_mfma_f32_16x16x32_bf16 v[132:135], v[168:171], v[44:47], v[132:135]
    s_waitcnt lgkmcnt(4)
    v_mfma_f32_16x16x32_bf16 v[136:139], v[172:175], v[40:43], v[136:139]
    ds_read_b128 v[168:171], v3 offset:2048
    v_mfma_f32_16x16x32_bf16 v[140:143], v[172:175], v[44:47], v[140:143]
    buffer_load_dwordx4 v2, s[20:23], s37 offen offset:1024 lds
    s_add_u32 s37, s37, 9216
    s_waitcnt lgkmcnt(4)
    v_mfma_f32_16x16x32_bf16 v[144:147], v[176:179], v[40:43], v[144:147]
    ds_read_b128 v[172:175], v3 offset:3072
    v_mfma_f32_16x16x32_bf16 v[148:151], v[176:179], v[44:47], v[148:151]
    s_add_u32 m0, s36, 9216
    s_mov_b64 exec, 0xffff
    buffer_load_dwordx4 v2, s[20:23], s38 offen lds
    s_mov_b64 exec, -1
    s_add_u32 s38, s38, 9216
    s_waitcnt lgkmcnt(4)
    v_mfma_f32_16x16x32_bf16 v[152:155], v[180:183], v[40:43], v[152:155]
    ds_read_b128 v[176:179], v3 offset:4096
    v_mfma_f32_16x16x32_bf16 v[156:159], v[180:183], v[44:47], v[156:159]
    s_waitcnt lgkmcnt(4)
    v_mfma_f32_16x16x32_bf16 v[88:91], v[160:163], v[48:51], v[88:91]
    ds_read_b128 v[180:183], v3 offset:5120
    v_mfma_f32_16x16x32_bf16 v[92:95], v[160:163], v[52:55], v[92:95]
    s_waitcnt lgkmcnt(4)
    v_mfma_f32_16x16x32_bf16 v[96:99], v[164:167], v[48:51], v[96:99]
    ds_read_b128 v[160:163], v3 offset:6144
    v_mfma_f32_16x16x32_bf16 v[100:103], v[164:167], v[52:55], v[100:103]
    s_waitcnt lgkmcnt(4)
    v_mfma_f32_16x16x32_bf16 v[104:107], v[168:171], v[48:51], v[104:107]
    ds_read_b128 v[164:167], v3 offset:7168
    v_mfma_f32_16x16x32_bf16 v[108:111], v[168:171], v[52:55], v[108:111]
    s_waitcnt lgkmcnt(4)
    v_mfma_f32_16x16x32_bf16 v[112:115], v[172:175], v[48:51], v[112:115]
    ds_read_b128 v[168:171], v3 offset:8192
    v_mfma_f32_16x16x32_bf16 v[116:119], v[172:175], v[52:55], v[116:119]
    s_waitcnt lgkmcnt(4)
    v_mfma_f32_16x16x32_bf16 v[120:123], v[176:179], v[48:51], v[120:123]
    ds_read_b128 v[172:175], v3 offset:9216
    v_mfma_f32_16x16x32_bf16 v[124:127], v[176:179], v[52:55], v[124:127]
    s_waitcnt lgkmcnt(4)
    v_mfma_f32_16x16x32_bf16 v[128:131], v[180:183], v[48:51], v[128:131]
    ds_read_b128 v[176:179], v3 offset:10240
    v_mfma_f32_16x16x32_bf16 v[132:135], v[180:183], v[52:55], v[132:135]
    s_waitcnt lgkmcnt(4)
    v_mfma_f32_16x16x32_bf16 v[136:139], v[160:163], v[48:51], v[136:139]
    ds_read_b128 v[180:183], v3 offset:11264
    v_mfma_f32_16x16x32_bf16 v[140:143], v[160:163], v[52:55], v[140:143]
    s_waitcnt lgkmcnt(4)
    v_mfma_f32_16x16x32_bf16 v[144:147], v[164:167], v[48:51], v[144:147]
    ds_read_b128 v[160:163], v3 offset:12288
    v_mfma_f32_16x16x32_bf16 v[148:151], v[164:167], v[52:55], v[148:151]
    s_waitcnt lgkmcnt(4)
    v_mfma_f32_16x16x32_bf16 v[152:155], v[168:171], v[48:51], v[152:155]
    ds_read_b128 v[164:167], v3 offset:13312
    v_mfma_f32_16x16x32_bf16 v[156:159], v[168:171], v[52:55], v[156:159]
    s_waitcnt lgkmcnt(4)
    v_mfma_f32_16x16x32_bf16 v[88:91], v[172:175], v[56:59], v[88:91]
    ds_read_b128 v[168:171], v3 offset:14336
    v_mfma_f32_16x16x32_bf16 v[92:95], v[172:175], v[60:63], v[92:95]
    s_waitcnt lgkmcnt(4)
    v_mfma_f32_16x16x32_bf16 v[96:99], v[176:179], v[56:59], v[96:99]
    ds_read_b128 v[172:175], v3 offset:15360
    v_mfma_f32_16x16x32_bf16 v[100:103], v[176:179], v[60:63], v[100:103]
    s_waitcnt lgkmcnt(4)
    v_mfma_f32_16x16x32_bf16 v[104:107], v[180:183], v[56:59], v[104:107]
    ds_read_b128 v[176:179], v3 offset:16384
    v_mfma_f32_16x16x32_bf16 v[108:111], v[180:183], v[60:63], v[108:111]
    s_waitcnt lgkmcnt(4)
    v_mfma_f32_16x16x32_bf16 v[112:115], v[160:163], v[56:59], v[112:115]
    ds_read_b128 v[180:183], v3 offset:17408
    v_mfma_f32_16x16x32_bf16 v[116:119], v[160:163], v[60:63], v[116:119]
    s_waitcnt vmcnt(10)
    s_barrier
    s_waitcnt lgkmcnt(4)
    v_mfma_f32_16x16x32_bf16 v[120:123], v[164:167], v[56:59], v[120:123]
    ds_read_b128 v[160:163], v3 offset:18432
    v_mfma_f32_16x16x32_bf16 v[124:127], v[164:167], v[60:63], v[124:127]
    s_waitcnt lgkmcnt(4)
    v_mfma_f32_16x16x32_bf16 v[128:131], v[168:171], v[56:59], v[128:131]
    ds_read_b128 v[164:167], v3 offset:19456
    v_mfma_f32_16x16x32_bf16 v[132:135], v[168:171], v[60:63], v[132:135]
    s_waitcnt lgkmcnt(4)
    v_mfma_f32_16x16x32_bf16 v[136:139], v[172:175], v[56:59], v[136:139]
    ds_read_b128 v[168:171], v3 offset:20480
    v_mfma_f32_16x16x32_bf16 v[140:143], v[172:175], v[60:63], v[140:143]
    s_waitcnt lgkmcnt(4)
    v_mfma_f32_16x16x32_bf16 v[144:147], v[176:179], v[56:59], v[144:147]
    ds_read_b128 v[172:175], v3 offset:21504
    v_mfma_f32_16x16x32_bf16 v[148:151], v[176:179], v[60:63], v[148:151]
    s_waitcnt lgkmcnt(4)
    v_mfma_f32_16x16x32_bf16 v[152:155], v[180:183], v[56:59], v[152:155]
    ds_read_b128 v[176:179], v3 offset:22528
    v_mfma_f32_16x16x32_bf16 v[156:159], v[180:183], v[60:63], v[156:159]
    s_waitcnt lgkmcnt(4)
    v_mfma_f32_16x16x32_bf16 v[88:91], v[160:163], v[64:67], v[88:91]
    ds_read_b128 v[180:183], v3 offset:23552
    v_mfma_f32_16x16x32_bf16 v[92:95], v[160:163], v[68:71], v[92:95]
    s_waitcnt lgkmcnt(4)
    v_mfma_f32_16x16x32_bf16 v[96:99], v[164:167], v[64:67], v[96:99]
    ds_read_b128 v[160:163], v3 offset:24576
    v_mfma_f32_16x16x32_bf16 v[100:103], v[164:167], v[68:71], v[100:103]
    s_waitcnt lgkmcnt(4)
    v_mfma_f32_16x16x32_bf16 v[104:107], v[168:171], v[64:67], v[104:107]
    ds_read_b128 v[164:167], v3 offset:25600
    v_mfma_f32_16x16x32_bf16 v[108:111], v[168:171], v[68:71], v[108:111]
    s_waitcnt lgkmcnt(4)
    v_mfma_f32_16x16x32_bf16 v[112:115], v[172:175], v[64:67], v[112:115]
    ds_read_b128 v[168:171], v3 offset:26624
    v_mfma_f32_16x16x32_bf16 v[116:119], v[172:175], v[68:71], v[116:119]
    s_waitcnt lgkmcnt(4)
    v_mfma_f32_16x16x32_bf16 v[120:123], v[176:179], v[64:67], v[120:123]
    ds_read_b128 v[172:175], v3 offset:27648
    v_mfma_f32_16x16x32_bf16 v[124:127], v[176:179], v[68:71], v[124:127]
    s_waitcnt lgkmcnt(4)
    v_mfma_f32_16x16x32_bf16 v[128:131], v[180:183], v[64:67], v[128:131]
    ds_read_b128 v[176:179], v3 offset:28672
    v_mfma_f32_16x16x32_bf16 v[132:135], v[180:183], v[68:71], v[132:135]
    s_waitcnt lgkmcnt(4)
    v_mfma_f32_16x16x32_bf16 v[136:139], v[160:163], v[64:67], v[136:139]
    ds_read_b128 v[180:183], v3 offset:29696
    v_mfma_f32_16x16x32_bf16 v[140:143], v[160:163], v[68:71], v[140:143]
    s_waitcnt lgkmcnt(4)
    v_mfma_f32_16x16x32_bf16 v[144:147], v[164:167], v[64:67], v[144:147]
    ds_read_b128 v[160:163], v3 offset:30720
    v_mfma_f32_16x16x32_bf16 v[148:151], v[164:167], v[68:71], v[148:151]
    s_waitcnt lgkmcnt(4)
    v_mfma_f32_16x16x32_bf16 v[152:155], v[168:171], v[64:67], v[152:155]
    ds_read_b128 v[164:167], v3 offset:31744
    v_mfma_f32_16x16x32_bf16 v[156:159], v[168:171], v[68:71], v[156:159]
    s_waitcnt lgkmcnt(4)
    v_mfma_f32_16x16x32_bf16 v[88:91], v[172:175], v[72:75], v[88:91]
    ds_read_b128 v[168:171], v3 offset:32768
    v_mfma_f32_16x16x32_bf16 v[92:95], v[172:175], v[76:79], v[92:95]
    s_waitcnt lgkmcnt(4)
    v_mfma_f32_16x16x32_bf16 v[96:99], v[176:179], v[72:75], v[96:99]
    ds_read_b128 v[172:175], v3 offset:33792
    v_mfma_f32_16x16x32_bf16 v[100:103], v[176:179], v[76:79], v[100:103]
    s_waitcnt lgkmcnt(4)
    v_mfma_f32_16x16x32_bf16 v[104:107], v[180:183], v[72:75], v[104:107]
    ds_read_b128 v[176:179], v3 offset:34816
    v_mfma_f32_16x16x32_bf16 v[108:111], v[180:183], v[76:79], v[108:111]
    s_waitcnt lgkmcnt(4)
    v_mfma_f32_16x16x32_bf16 v[112:115], v[160:163], v[72:75], v[112:115]
    ds_read_b128 v[180:183], v3 offset:35840
    v_mfma_f32_16x16x32_bf16 v[116:119], v[160:163], v[76:79], v[116:119]
    s_waitcnt vmcnt(0)
    s_barrier
    s_waitcnt lgkmcnt(4)
    v_mfma_f32_16x16x32_bf16 v[120:123], v[164:167], v[72:75], v[120:123]
    ds_read_b128 v[160:163], v2 offset:0
    v_mfma_f32_16x16x32_bf16 v[124:127], v[164:167], v[76:79], v[124:127]
    s_waitcnt lgkmcnt(4)
    v_mfma_f32_16x16x32_bf16 v[128:131], v[168:171], v[72:75], v[128:131]
    ds_read_b128 v[164:167], v2 offset:1024
    v_mfma_f32_16x16x32_bf16 v[132:135], v[168:171], v[76:79], v[132:135]
    s_waitcnt lgkmcnt(4)
    v_mfma_f32_16x16x32_bf16 v[136:139], v[172:175], v[72:75], v[136:139]
    ds_read_b128 v[168:171], v2 offset:2048
    v_mfma_f32_16x16x32_bf16 v[140:143], v[172:175], v[76:79], v[140:143]
    s_waitcnt lgkmcnt(4)
    v_mfma_f32_16x16x32_bf16 v[144:147], v[176:179], v[72:75], v[144:147]
    ds_read_b128 v[172:175], v2 offset:3072
    v_mfma_f32_16x16x32_bf16 v[148:151], v[176:179], v[76:79], v[148:151]
    s_waitcnt lgkmcnt(4)
    v_mfma_f32_16x16x32_bf16 v[152:155], v[180:183], v[72:75], v[152:155]
    ds_read_b128 v[176:179], v2 offset:4096
    v_mfma_f32_16x16x32_bf16 v[156:159], v[180:183], v[76:79], v[156:159]
    s_waitcnt lgkmcnt(4)
    v_mfma_f32_16x16x32_bf16 v[88:91], v[160:163], v[16:19], v[88:91]
    ds_read_b128 v[180:183], v2 offset:5120
    v_mfma_f32_16x16x32_bf16 v[92:95], v[160:163], v[20:23], v[92:95]
    s_waitcnt lgkmcnt(4)
    v_mfma_f32_16x16x32_bf16 v[96:99], v[164:167], v[16:19], v[96:99]
    ds_read_b128 v[160:163], v2 offset:6144
    v_mfma_f32_16x16x32_bf16 v[100:103], v[164:167], v[20:23], v[100:103]
    s_waitcnt lgkmcnt(4)
    v_mfma_f32_16x16x32_bf16 v[104:107], v[168:171], v[16:19], v[104:107]
    ds_read_b128 v[164:167], v2 offset:7168
    v_mfma_f32_16x16x32_bf16 v[108:111], v[168:171], v[20:23], v[108:111]
    s_waitcnt lgkmcnt(4)
    v_mfma_f32_16x16x32_bf16 v[112:115], v[172:175], v[16:19], v[112:115]
    ds_read_b128 v[168:171], v2 offset:8192
    v_mfma_f32_16x16x32_bf16 v[116:119], v[172:175], v[20:23], v[116:119]
    s_waitcnt lgkmcnt(4)
    v_mfma_f32_16x16x32_bf16 v[120:123], v[176:179], v[16:19], v[120:123]
    ds_read_b128 v[172:175], v2 offset:9216
    v_mfma_f32_16x16x32_bf16 v[124:127], v[176:179], v[20:23], v[124:127]
    s_waitcnt lgkmcnt(4)
    v_mfma_f32_16x16x32_bf16 v[128:131], v[180:183], v[16:19], v[128:131]
    ds_read_b128 v[176:179], v2 offset:10240
    v_mfma_f32_16x16x32_bf16 v[132:135], v[180:183], v[20:23], v[132:135]
    s_waitcnt lgkmcnt(4)
    v_mfma_f32_16x16x32_bf16 v[136:139], v[160:163], v[16:19], v[136:139]
    ds_read_b128 v[180:183], v2 offset:11264
    v_mfma_f32_16x16x32_bf16 v[140:143], v[160:163], v[20:23], v[140:143]
    s_waitcnt lgkmcnt(4)
    v_mfma_f32_16x16x32_bf16 v[144:147], v[164:167], v[16:19], v[144:147]
    ds_read_b128 v[160:163], v2 offset:12288
    v_mfma_f32_16x16x32_bf16 v[148:151], v[164:167], v[20:23], v[148:151]
    s_waitcnt lgkmcnt(4)
    v_mfma_f32_16x16x32_bf16 v[152:155], v[168:171], v[16:19], v[152:155]
    ds_read_b128 v[164:167], v2 offset:13312
    v_mfma_f32_16x16x32_bf16 v[156:159], v[168:171], v[20:23], v[156:159]
    s_waitcnt lgkmcnt(4)
    v_mfma_f32_16x16x32_bf16 v[88:91], v[172:175], v[24:27], v[88:91]
    ds_read_b128 v[168:171], v2 offset:14336
    v_mfma_f32_16x16x32_bf16 v[92:95], v[172:175], v[28:31], v[92:95]
    s_waitcnt lgkmcnt(4)
    v_mfma_f32_16x16x32_bf16 v[96:99], v[176:179], v[24:27], v[96:99]
    ds_read_b128 v[172:175], v2 offset:15360
    v_mfma_f32_16x16x32_bf16 v[100:103], v[176:179], v[28:31], v[100:103]
    s_waitcnt lgkmcnt(4)
    v_mfma_f32_16x16x32_bf16 v[104:107], v[180:183], v[24:27], v[104:107]
    ds_read_b128 v[176:179], v2 offset:16384
    v_mfma_f32_16x16x32_bf16 v[108:111], v[180:183], v[28:31], v[108:111]
    s_waitcnt lgkmcnt(4)
    v_mfma_f32_16x16x32_bf16 v[112:115], v[160:163], v[24:27], v[112:115]
    ds_read_b128 v[180:183], v2 offset:17408
    v_mfma_f32_16x16x32_bf16 v[116:119], v[160:163], v[28:31], v[116:119]
    s_waitcnt lgkmcnt(4)
    v_mfma_f32_16x16x32_bf16 v[120:123], v[164:167], v[24:27], v[120:123]
    v_mfma_f32_16x16x32_bf16 v[124:127], v[164:167], v[28:31], v[124:127]
    s_waitcnt lgkmcnt(3)
    v_mfma_f32_16x16x32_bf16 v[128:131], v[168:171], v[24:27], v[128:131]
    v_mfma_f32_16x16x32_bf16 v[132:135], v[168:171], v[28:31], v[132:135]
    s_waitcnt lgkmcnt(2)
    v_mfma_f32_16x16x32_bf16 v[136:139], v[172:175], v[24:27], v[136:139]
    v_mfma_f32_16x16x32_bf16 v[140:143], v[172:175], v[28:31], v[140:143]
    s_waitcnt lgkmcnt(1)
    v_mfma_f32_16x16x32_bf16 v[144:147], v[176:179], v[24:27], v[144:147]
    v_mfma_f32_16x16x32_bf16 v[148:151], v[176:179], v[28:31], v[148:151]
    s_waitcnt lgkmcnt(0)
    v_mfma_f32_16x16x32_bf16 v[152:155], v[180:183], v[24:27], v[152:155]
    v_mfma_f32_16x16x32_bf16 v[156:159], v[180:183], v[28:31], v[156:159]
    s_setprio 2
    v_mul_f32 v232, v88, v88
    v_mul_f32 v233, v89, v89
    v_mul_f32 v234, v90, v90
    v_mul_f32 v235, v91, v91
    v_mul_f32 v236, v92, v92
    v_mul_f32 v237, v93, v93
    v_mul_f32 v238, v94, v94
    v_mul_f32 v239, v95, v95
    v_fma_f32 v232, v232, v10, s40
    v_fma_f32 v233, v233, v10, s40
    v_fma_f32 v234, v234, v10, s40
    v_fma_f32 v235, v235, v10, s40
    v_fma_f32 v236, v236, v10, s40
    v_fma_f32 v237, v237, v10, s40
    v_fma_f32 v238, v238, v10, s40
    v_fma_f32 v239, v239, v10, s40
    v_mul_f32 v232, v232, v88
    v_mul_f32 v233, v233, v89
    v_mul_f32 v234, v234, v90
    v_mul_f32 v235, v235, v91
    v_mul_f32 v236, v236, v92
    v_mul_f32 v237, v237, v93
    v_mul_f32 v238, v238, v94
    v_mul_f32 v239, v239, v95
    v_exp_f32 v232, v232
    v_exp_f32 v233, v233
    v_exp_f32 v234, v234
    v_exp_f32 v235, v235
    v_exp_f32 v236, v236
    v_exp_f32 v237, v237
    v_exp_f32 v238, v238
    v_exp_f32 v239, v239
    v_add_f32 v232, 1.0, v232
    v_add_f32 v233, 1.0, v233
    v_add_f32 v234, 1.0, v234
    v_add_f32 v235, 1.0, v235
    v_add_f32 v236, 1.0, v236
    v_add_f32 v237, 1.0, v237
    v_add_f32 v238, 1.0, v238
    v_add_f32 v239, 1.0, v239
    v_rcp_f32 v232, v232
    v_rcp_f32 v233, v233
    v_rcp_f32 v234, v234
    v_rcp_f32 v235, v235
    v_rcp_f32 v236, v236
    v_rcp_f32 v237, v237
    v_rcp_f32 v238, v238
    v_rcp_f32 v239, v239
    v_mul_f32 v88, v88, v232
    v_mul_f32 v89, v89, v233
    v_mul_f32 v90, v90, v234
    v_mul_f32 v91, v91, v235
    v_mul_f32 v92, v92, v236
    v_mul_f32 v93, v93, v237
    v_mul_f32 v94, v94, v238
    v_mul_f32 v95, v95, v239
    v_add_f32 v248, v248, v88
    v_fmac_f32 v249, v88, v88
    v_add_f32 v248, v248, v89
    v_fmac_f32 v249, v89, v89
    v_add_f32 v248, v248, v90
    v_fmac_f32 v249, v90, v90
    v_add_f32 v248, v248, v91
    v_fmac_f32 v249, v91, v91
    v_add_f32 v250, v250, v92
    v_fmac_f32 v251, v92, v92
    v_add_f32 v250, v250, v93
    v_fmac_f32 v251, v93, v93
    v_add_f32 v250, v250, v94
    v_fmac_f32 v251, v94, v94
    v_add_f32 v250, v250, v95
    v_fmac_f32 v251, v95, v95
    v_mul_f32 v240, v96, v96
    v_mul_f32 v241, v97, v97
    v_mul_f32 v242, v98, v98
    v_mul_f32 v243, v99, v99
    v_mul_f32 v244, v100, v100
    v_mul_f32 v245, v101, v101
    v_mul_f32 v246, v102, v102
    v_mul_f32 v247, v103, v103
    v_fma_f32 v240, v240, v10, s40
    v_fma_f32 v241, v241, v10, s40
    v_fma_f32 v242, v242, v10, s40
    v_fma_f32 v243, v243, v10, s40
    v_fma_f32 v244, v244, v10, s40
    v_fma_f32 v245, v245, v10, s40
    v_fma_f32 v246, v246, v10, s40
    v_fma_f32 v247, v247, v10, s40
    v_mul_f32 v240, v240, v96
    v_mul_f32 v241, v241, v97
    v_mul_f32 v242, v242, v98
    v_mul_f32 v243, v243, v99
    v_mul_f32 v244, v244, v100
    v_mul_f32 v245, v245, v101
    v_mul_f32 v246, v246, v102
    v_mul_f32 v247, v247, v103
    v_exp_f32 v240, v240
    v_exp_f32 v241, v241
    v_exp_f32 v242, v242
    v_exp_f32 v243, v243
    v_exp_f32 v244, v244
    v_exp_f32 v245, v245
    v_exp_f32 v246, v246
    v_exp_f32 v247, v247
    v_add_f32 v240, 1.0, v240
    v_add_f32 v241, 1.0, v241
    v_add_f32 v242, 1.0, v242
    v_add_f32 v243, 1.0, v243
    v_add_f32 v244, 1.0, v244
    v_add_f32 v245, 1.0, v245
    v_add_f32 v246, 1.0, v246
    v_add_f32 v247, 1.0, v247
    v_rcp_f32 v240, v240
    v_rcp_f32 v241, v241
    v_rcp_f32 v242, v242
    v_rcp_f32 v243, v243
    v_rcp_f32 v244, v244
    v_rcp_f32 v245, v245
    v_rcp_f32 v246, v246
    v_rcp_f32 v247, v247
    v_mul_f32 v96, v96, v240
    v_mul_f32 v97, v97, v241
    v_mul_f32 v98, v98, v242
    v_mul_f32 v99, v99, v243
    v_mul_f32 v100, v100, v244
    v_mul_f32 v101, v101, v245
    v_mul_f32 v102, v102, v246
    v_mul_f32 v103, v103, v247
    v_add_f32 v248, v248, v96
    v_fmac_f32 v249, v96, v96
    v_add_f32 v248, v248, v97
    v_fmac_f32 v249, v97, v97
    v_add_f32 v248, v248, v98
    v_fmac_f32 v249, v98, v98
    v_add_f32 v248, v248, v99
    v_fmac_f32 v249, v99, v99
    v_add_f32 v250, v250, v100
    v_fmac_f32 v251, v100, v100
    v_add_f32 v250, v250, v101
    v_fmac_f32 v251, v101, v101
    v_add_f32 v250, v250, v102
    v_fmac_f32 v251, v102, v102
    v_add_f32 v250, v250, v103
    v_fmac_f32 v251, v103, v103
    v_mul_f32 v232, v104, v104
    v_mul_f32 v233, v105, v105
    v_mul_f32 v234, v106, v106
    v_mul_f32 v235, v107, v107
    v_mul_f32 v236, v108, v108
    v_mul_f32 v237, v109, v109
    v_mul_f32 v238, v110, v110
    v_mul_f32 v239, v111, v111
    v_fma_f32 v232, v232, v10, s40
    v_fma_f32 v233, v233, v10, s40
    v_fma_f32 v234, v234, v10, s40
    v_fma_f32 v235, v235, v10, s40
    v_fma_f32 v236, v236, v10, s40
    v_fma_f32 v237, v237, v10, s40
    v_fma_f32 v238, v238, v10, s40
    v_fma_f32 v239, v239, v10, s40
    v_mul_f32 v232, v232, v104
    v_mul_f32 v233, v233, v105
    v_mul_f32 v234, v234, v106
    v_mul_f32 v235, v235, v107
    v_mul_f32 v236, v236, v108
    v_mul_f32 v237, v237, v109
    v_mul_f32 v238, v238, v110
    v_mul_f32 v239, v239, v111
    v_exp_f32 v232, v232
    v_exp_f32 v233, v233
    v_exp_f32 v234, v234
    v_exp_f32 v235, v235
    v_exp_f32 v236, v236
    v_exp_f32 v237, v237
    v_exp_f32 v238, v238
    v_exp_f32 v239, v239
    v_add_f32 v232, 1.0, v232
    v_add_f32 v233, 1.0, v233
    v_add_f32 v234, 1.0, v234
    v_add_f32 v235, 1.0, v235
    v_add_f32 v236, 1.0, v236
    v_add_f32 v237, 1.0, v237
    v_add_f32 v238, 1.0, v238
    v_add_f32 v239, 1.0, v239
    v_rcp_f32 v232, v232
    v_rcp_f32 v233, v233
    v_rcp_f32 v234, v234
    v_rcp_f32 v235, v235
    v_rcp_f32 v236, v236
    v_rcp_f32 v237, v237
    v_rcp_f32 v238, v238
    v_rcp_f32 v239, v239
    v_mul_f32 v104, v104, v232
    v_mul_f32 v105, v105, v233
    v_mul_f32 v106, v106, v234
    v_mul_f32 v107, v107, v235
    v_mul_f32 v108, v108, v236
    v_mul_f32 v109, v109, v237
    v_mul_f32 v110, v110, v238
    v_mul_f32 v111, v111, v239
    v_add_f32 v248, v248, v104
    v_fmac_f32 v249, v104, v104
    v_add_f32 v248, v248, v105
    v_fmac_f32 v249, v105, v105
    v_add_f32 v248, v248, v106
    v_fmac_f32 v249, v106, v106
    v_add_f32 v248, v248, v107
    v_fmac_f32 v249, v107, v107
    v_add_f32 v250, v250, v108
    v_fmac_f32 v251, v108, v108
    v_add_f32 v250, v250, v109
    v_fmac_f32 v251, v109, v109
    v_add_f32 v250, v250, v110
    v_fmac_f32 v251, v110, v110
    v_add_f32 v250, v250, v111
    v_fmac_f32 v251, v111, v111
    v_mul_f32 v240, v112, v112
    v_mul_f32 v241, v113, v113
    v_mul_f32 v242, v114, v114
    v_mul_f32 v243, v115, v115
    v_mul_f32 v244, v116, v116
    v_mul_f32 v245, v117, v117
    v_mul_f32 v246, v118, v118
    v_mul_f32 v247, v119, v119
    v_fma_f32 v240, v240, v10, s40
    v_fma_f32 v241, v241, v10, s40
    v_fma_f32 v242, v242, v10, s40
    v_fma_f32 v243, v243, v10, s40
    v_fma_f32 v244, v244, v10, s40
    v_fma_f32 v245, v245, v10, s40
    v_fma_f32 v246, v246, v10, s40
    v_fma_f32 v247, v247, v10, s40
    v_mul_f32 v240, v240, v112
    v_mul_f32 v241, v241, v113
    v_mul_f32 v242, v242, v114
    v_mul_f32 v243, v243, v115
    v_mul_f32 v244, v244, v116
    v_mul_f32 v245, v245, v117
    v_mul_f32 v246, v246, v118
    v_mul_f32 v247, v247, v119
    v_exp_f32 v240, v240
    v_exp_f32 v241, v241
    v_exp_f32 v242, v242
    v_exp_f32 v243, v243
    v_exp_f32 v244, v244
    v_exp_f32 v245, v245
    v_exp_f32 v246, v246
    v_exp_f32 v247, v247
    v_add_f32 v240, 1.0, v240
    v_add_f32 v241, 1.0, v241
    v_add_f32 v242, 1.0, v242
    v_add_f32 v243, 1.0, v243
    v_add_f32 v244, 1.0, v244
    v_add_f32 v245, 1.0, v245
    v_add_f32 v246, 1.0, v246
    v_add_f32 v247, 1.0, v247
    v_rcp_f32 v240, v240
    v_rcp_f32 v241, v241
    v_rcp_f32 v242, v242
    v_rcp_f32 v243, v243
    v_rcp_f32 v244, v244
    v_rcp_f32 v245, v245
    v_rcp_f32 v246, v246
    v_rcp_f32 v247, v247
    v_mul_f32 v112, v112, v240
    v_mul_f32 v113, v113, v241
    v_mul_f32 v114, v114, v242
    v_mul_f32 v115, v115, v243
    v_mul_f32 v116, v116, v244
    v_mul_f32 v117, v117, v245
    v_mul_f32 v118, v118, v246
    v_mul_f32 v119, v119, v247
    v_add_f32 v248, v248, v112
    v_fmac_f32 v249, v112, v112
    v_add_f32 v248, v248, v113
    v_fmac_f32 v249, v113, v113
    v_add_f32 v248, v248, v114
    v_fmac_f32 v249, v114, v114
    v_add_f32 v248, v248, v115
    v_fmac_f32 v249, v115, v115
    v_add_f32 v250, v250, v116
    v_fmac_f32 v251, v116, v116
    v_add_f32 v250, v250, v117
    v_fmac_f32 v251, v117, v117
    v_add_f32 v250, v250, v118
    v_fmac_f32 v251, v118, v118
    v_add_f32 v250, v250, v119
    v_fmac_f32 v251, v119, v119
    v_mul_f32 v232, v120, v120
    v_mul_f32 v233, v121, v121
    v_mul_f32 v234, v122, v122
    v_mul_f32 v235, v123, v123
    v_mul_f32 v236, v124, v124
    v_mul_f32 v237, v125, v125
    v_mul_f32 v238, v126, v126
    v_mul_f32 v239, v127, v127
    v_fma_f32 v232, v232, v10, s40
    v_fma_f32 v233, v233, v10, s40
    v_fma_f32 v234, v234, v10, s40
    v_fma_f32 v235, v235, v10, s40
    v_fma_f32 v236, v236, v10, s40
    v_fma_f32 v237, v237, v10, s40
    v_fma_f32 v238, v238, v10, s40
    v_fma_f32 v239, v239, v10, s40
    v_mul_f32 v232, v232, v120
    v_mul_f32 v233, v233, v121
    v_mul_f32 v234, v234, v122
    v_mul_f32 v235, v235, v123
    v_mul_f32 v236, v236, v124
    v_mul_f32 v237, v237, v125
    v_mul_f32 v238, v238, v126
    v_mul_f32 v239, v239, v127
    v_exp_f32 v232, v232
    v_exp_f32 v233, v233
    v_exp_f32 v234, v234
    v_exp_f32 v235, v235
    v_exp_f32 v236, v236
    v_exp_f32 v237, v237
    v_exp_f32 v238, v238
    v_exp_f32 v239, v239
    v_add_f32 v232, 1.0, v232
    v_add_f32 v233, 1.0, v233
    v_add_f32 v234, 1.0, v234
    v_add_f32 v235, 1.0, v235
    v_add_f32 v236, 1.0, v236
    v_add_f32 v237, 1.0, v237
    v_add_f32 v238, 1.0, v238
    v_add_f32 v239, 1.0, v239
    v_rcp_f32 v232, v232
    v_rcp_f32 v233, v233
    v_rcp_f32 v234, v234
    v_rcp_f32 v235, v235
    v_rcp_f32 v236, v236
    v_rcp_f32 v237, v237
    v_rcp_f32 v238, v238
    v_rcp_f32 v239, v239
    v_mul_f32 v120, v120, v232
    v_mul_f32 v121, v121, v233
    v_mul_f32 v122, v122, v234
    v_mul_f32 v123, v123, v235
    v_mul_f32 v124, v124, v236
    v_mul_f32 v125, v125, v237
    v_mul_f32 v126, v126, v238
    v_mul_f32 v127, v127, v239
    v_add_f32 v248, v248, v120
    v_fmac_f32 v249, v120, v120
    v_add_f32 v248, v248, v121
    v_fmac_f32 v249, v121, v121
    v_add_f32 v248, v248, v122
    v_fmac_f32 v249, v122, v122
    v_add_f32 v248, v248, v123
    v_fmac_f32 v249, v123, v123
    v_add_f32 v250, v250, v124
    v_fmac_f32 v251, v124, v124
    v_add_f32 v250, v250, v125
    v_fmac_f32 v251, v125, v125
    v_add_f32 v250, v250, v126
    v_fmac_f32 v251, v126, v126
    v_add_f32 v250, v250, v127
    v_fmac_f32 v251, v127, v127
    v_mul_f32 v240, v128, v128
    v_mul_f32 v241, v129, v129
    v_mul_f32 v242, v130, v130
    v_mul_f32 v243, v131, v131
    v_mul_f32 v244, v132, v132
    v_mul_f32 v245, v133, v133
    v_mul_f32 v246, v134, v134
    v_mul_f32 v247, v135, v135
    v_fma_f32 v240, v240, v10, s40
    v_fma_f32 v241, v241, v10, s40
    v_fma_f32 v242, v242, v10, s40
    v_fma_f32 v243, v243, v10, s40
    v_fma_f32 v244, v244, v10, s40
    v_fma_f32 v245, v245, v10, s40
    v_fma_f32 v246, v246, v10, s40
    v_fma_f32 v247, v247, v10, s40
    v_mul_f32 v240, v240, v128
    v_mul_f32 v241, v241, v129
    v_mul_f32 v242, v242, v130
    v_mul_f32 v243, v243, v131
    v_mul_f32 v244, v244, v132
    v_mul_f32 v245, v245, v133
    v_mul_f32 v246, v246, v134
    v_mul_f32 v247, v247, v135
    v_exp_f32 v240, v240
    v_exp_f32 v241, v241
    v_exp_f32 v242, v242
    v_exp_f32 v243, v243
    v_exp_f32 v244, v244
    v_exp_f32 v245, v245
    v_exp_f32 v246, v246
    v_exp_f32 v247, v247
    v_add_f32 v240, 1.0, v240
    v_add_f32 v241, 1.0, v241
    v_add_f32 v242, 1.0, v242
    v_add_f32 v243, 1.0, v243
    v_add_f32 v244, 1.0, v244
    v_add_f32 v245, 1.0, v245
    v_add_f32 v246, 1.0, v246
    v_add_f32 v247, 1.0, v247
    v_rcp_f32 v240, v240
    v_rcp_f32 v241, v241
    v_rcp_f32 v242, v242
    v_rcp_f32 v243, v243
    v_rcp_f32 v244, v244
    v_rcp_f32 v245, v245
    v_rcp_f32 v246, v246
    v_rcp_f32 v247, v247
    v_mul_f32 v128, v128, v240
    v_mul_f32 v129, v129, v241
    v_mul_f32 v130, v130, v242
    v_mul_f32 v131, v131, v243
    v_mul_f32 v132, v132, v244
    v_mul_f32 v133, v133, v245
    v_mul_f32 v134, v134, v246
    v_mul_f32 v135, v135, v247
    v_add_f32 v248, v248, v128
    v_fmac_f32 v249, v128, v128
    v_add_f32 v248, v248, v129
    v_fmac_f32 v249, v129, v129
    v_add_f32 v248, v248, v130
    v_fmac_f32 v249, v130, v130
    v_add_f32 v248, v248, v131
    v_fmac_f32 v249, v131, v131
    v_add_f32 v250, v250, v132
    v_fmac_f32 v251, v132, v132
    v_add_f32 v250, v250, v133
    v_fmac_f32 v251, v133, v133
    v_add_f32 v250, v250, v134
    v_fmac_f32 v251, v134, v134
    v_add_f32 v250, v250, v135
    v_fmac_f32 v251, v135, v135
    v_mul_f32 v232, v136, v136
    v_mul_f32 v233, v137, v137
    v_mul_f32 v234, v138, v138
    v_mul_f32 v235, v139, v139
    v_mul_f32 v236, v140, v140
    v_mul_f32 v237, v141, v141
    v_mul_f32 v238, v142, v142
    v_mul_f32 v239, v143, v143
    v_fma_f32 v232, v232, v10, s40
    v_fma_f32 v233, v233, v10, s40
    v_fma_f32 v234, v234, v10, s40
    v_fma_f32 v235, v235, v10, s40
    v_fma_f32 v236, v236, v10, s40
    v_fma_f32 v237, v237, v10, s40
    v_fma_f32 v238, v238, v10, s40
    v_fma_f32 v239, v239, v10, s40
    v_mul_f32 v232, v232, v136
    v_mul_f32 v233, v233, v137
    v_mul_f32 v234, v234, v138
    v_mul_f32 v235, v235, v139
    v_mul_f32 v236, v236, v140
    v_mul_f32 v237, v237, v141
    v_mul_f32 v238, v238, v142
    v_mul_f32 v239, v239, v143
    v_exp_f32 v232, v232
    v_exp_f32 v233, v233
    v_exp_f32 v234, v234
    v_exp_f32 v235, v235
    v_exp_f32 v236, v236
    v_exp_f32 v237, v237
    v_exp_f32 v238, v238
    v_exp_f32 v239, v239
    v_add_f32 v232, 1.0, v232
    v_add_f32 v233, 1.0, v233
    v_add_f32 v234, 1.0, v234
    v_add_f32 v235, 1.0, v235
    v_add_f32 v236, 1.0, v236
    v_add_f32 v237, 1.0, v237
    v_add_f32 v238, 1.0, v238
    v_add_f32 v239, 1.0, v239
    v_rcp_f32 v232, v232
    v_rcp_f32 v233, v233
    v_rcp_f32 v234, v234
    v_rcp_f32 v235, v235
    v_rcp_f32 v236, v236
    v_rcp_f32 v237, v237
    v_rcp_f32 v238, v238
    v_rcp_f32 v239, v239
    v_mul_f32 v136, v136, v232
    v_mul_f32 v137, v137, v233
    v_mul_f32 v138, v138, v234
    v_mul_f32 v139, v139, v235
    v_mul_f32 v140, v140, v236
    v_mul_f32 v141, v141, v237
    v_mul_f32 v142, v142, v238
    v_mul_f32 v143, v143, v239
    v_add_f32 v248, v248, v136
    v_fmac_f32 v249, v136, v136
    v_add_f32 v248, v248, v137
    v_fmac_f32 v249, v137, v137
    v_add_f32 v248, v248, v138
    v_fmac_f32 v249, v138, v138
    v_add_f32 v248, v248, v139
    v_fmac_f32 v249, v139, v139
    v_add_f32 v250, v250, v140
    v_fmac_f32 v251, v140, v140
    v_add_f32 v250, v250, v141
    v_fmac_f32 v251, v141, v141
    v_add_f32 v250, v250, v142
    v_fmac_f32 v251, v142, v142
    v_add_f32 v250, v250, v143
    v_fmac_f32 v251, v143, v143
    v_mul_f32 v240, v144, v144
    v_mul_f32 v241, v145, v145
    v_mul_f32 v242, v146, v146
    v_mul_f32 v243, v147, v147
    v_mul_f32 v244, v148, v148
    v_mul_f32 v245, v149, v149
    v_mul_f32 v246, v150, v150
    v_mul_f32 v247, v151, v151
    v_fma_f32 v240, v240, v10, s40
    v_fma_f32 v241, v241, v10, s40
    v_fma_f32 v242, v242, v10, s40
    v_fma_f32 v243, v243, v10, s40
    v_fma_f32 v244, v244, v10, s40
    v_fma_f32 v245, v245, v10, s40
    v_fma_f32 v246, v246, v10, s40
    v_fma_f32 v247, v247, v10, s40
    v_mul_f32 v240, v240, v144
    v_mul_f32 v241, v241, v145
    v_mul_f32 v242, v242, v146
    v_mul_f32 v243, v243, v147
    v_mul_f32 v244, v244, v148
    v_mul_f32 v245, v245, v149
    v_mul_f32 v246, v246, v150
    v_mul_f32 v247, v247, v151
    v_exp_f32 v240, v240
    v_exp_f32 v241, v241
    v_exp_f32 v242, v242
    v_exp_f32 v243, v243
    v_exp_f32 v244, v244
    v_exp_f32 v245, v245
    v_exp_f32 v246, v246
    v_exp_f32 v247, v247
    v_add_f32 v240, 1.0, v240
    v_add_f32 v241, 1.0, v241
    v_add_f32 v242, 1.0, v242
    v_add_f32 v243, 1.0, v243
    v_add_f32 v244, 1.0, v244
    v_add_f32 v245, 1.0, v245
    v_add_f32 v246, 1.0, v246
    v_add_f32 v247, 1.0, v247
    v_rcp_f32 v240, v240
    v_rcp_f32 v241, v241
    v_rcp_f32 v242, v242
    v_rcp_f32 v243, v243
    v_rcp_f32 v244, v244
    v_rcp_f32 v245, v245
    v_rcp_f32 v246, v246
    v_rcp_f32 v247, v247
    v_mul_f32 v144, v144, v240
    v_mul_f32 v145, v145, v241
    v_mul_f32 v146, v146, v242
    v_mul_f32 v147, v147, v243
    v_mul_f32 v148, v148, v244
    v_mul_f32 v149, v149, v245
    v_mul_f32 v150, v150, v246
    v_mul_f32 v151, v151, v247
    v_add_f32 v248, v248, v144
    v_fmac_f32 v249, v144, v144
    v_add_f32 v248, v248, v145
    v_fmac_f32 v249, v145, v145
    v_add_f32 v248, v248, v146
    v_fmac_f32 v249, v146, v146
    v_add_f32 v248, v248, v147
    v_fmac_f32 v249, v147, v147
    v_add_f32 v250, v250, v148
    v_fmac_f32 v251, v148, v148
    v_add_f32 v250, v250, v149
    v_fmac_f32 v251, v149, v149
    v_add_f32 v250, v250, v150
    v_fmac_f32 v251, v150, v150
    v_add_f32 v250, v250, v151
    v_fmac_f32 v251, v151, v151
    v_mul_f32 v232, v152, v152
    v_mul_f32 v233, v153, v153
    v_mul_f32 v234, v154, v154
    v_mul_f32 v235, v155, v155
    v_mul_f32 v236, v156, v156
    v_mul_f32 v237, v157, v157
    v_mul_f32 v238, v158, v158
    v_mul_f32 v239, v159, v159
    v_fma_f32 v232, v232, v10, s40
    v_fma_f32 v233, v233, v10, s40
    v_fma_f32 v234, v234, v10, s40
    v_fma_f32 v235, v235, v10, s40
    v_fma_f32 v236, v236, v10, s40
    v_fma_f32 v237, v237, v10, s40
    v_fma_f32 v238, v238, v10, s40
    v_fma_f32 v239, v239, v10, s40
    v_mul_f32 v232, v232, v152
    v_mul_f32 v233, v233, v153
    v_mul_f32 v234, v234, v154
    v_mul_f32 v235, v235, v155
    v_mul_f32 v236, v236, v156
    v_mul_f32 v237, v237, v157
    v_mul_f32 v238, v238, v158
    v_mul_f32 v239, v239, v159
    v_exp_f32 v232, v232
    v_exp_f32 v233, v233
    v_exp_f32 v234, v234
    v_exp_f32 v235, v235
    v_exp_f32 v236, v236
    v_exp_f32 v237, v237
    v_exp_f32 v238, v238
    v_exp_f32 v239, v239
    v_add_f32 v232, 1.0, v232
    v_add_f32 v233, 1.0, v233
    v_add_f32 v234, 1.0, v234
    v_add_f32 v235, 1.0, v235
    v_add_f32 v236, 1.0, v236
    v_add_f32 v237, 1.0, v237
    v_add_f32 v238, 1.0, v238
    v_add_f32 v239, 1.0, v239
    v_rcp_f32 v232, v232
    v_rcp_f32 v233, v233
    v_rcp_f32 v234, v234
    v_rcp_f32 v235, v235
    v_rcp_f32 v236, v236
    v_rcp_f32 v237, v237
    v_rcp_f32 v238, v238
    v_rcp_f32 v239, v239
    v_mul_f32 v152, v152, v232
    v_mul_f32 v153, v153, v233
    v_mul_f32 v154, v154, v234
    v_mul_f32 v155, v155, v235
    v_mul_f32 v156, v156, v236
    v_mul_f32 v157, v157, v237
    v_mul_f32 v158, v158, v238
    v_mul_f32 v159, v159, v239
    v_add_f32 v248, v248, v152
    v_fmac_f32 v249, v152, v152
    v_add_f32 v248, v248, v153
    v_fmac_f32 v249, v153, v153
    v_add_f32 v248, v248, v154
    v_fmac_f32 v249, v154, v154
    v_add_f32 v248, v248, v155
    v_fmac_f32 v249, v155, v155
    v_add_f32 v250, v250, v156
    v_fmac_f32 v251, v156, v156
    v_add_f32 v250, v250, v157
    v_fmac_f32 v251, v157, v157
    v_add_f32 v250, v250, v158
    v_fmac_f32 v251, v158, v158
    v_add_f32 v250, v250, v159
    v_fmac_f32 v251, v159, v159
    v_mov_b32 v252, v248
    v_mov_b32 v253, v249
    v_mov_b32 v254, v250
    v_mov_b32 v255, v251
    v_permlane16_swap_b32 v248, v252
    v_permlane16_swap_b32 v249, v253
    v_permlane16_swap_b32 v250, v254
    v_permlane16_swap_b32 v251, v255
    v_add_f32 v248, v248, v252
    v_add_f32 v249, v249, v253
    v_add_f32 v250, v250, v254
    v_add_f32 v251, v251, v255
    v_cndmask_b32 v248, v248, v250, s[52:53]
    v_cndmask_b32 v249, v249, v251, s[52:53]
    v_mov_b32 v250, v248
    v_mov_b32 v251, v249
    s_nop 0
    v_permlane32_swap_b32 v248, v250
    v_permlane32_swap_b32 v249, v251
    v_add_f32 v248, v248, v250
    v_add_f32 v249, v249, v251
    s_mov_b32 exec_hi, 0
    buffer_store_dwordx2 v[248:249], v6, s[20:23], s46 offen sc1
    s_mov_b32 exec_hi, -1
    s_mov_b32 s47, 0
    s_waitcnt vmcnt(0)
ZG_POLL:
    buffer_load_dwordx2 v[232:233], v7, s[20:23], s45 offen offset:0 sc1
    buffer_load_dwordx2 v[234:235], v7, s[20:23], s45 offen offset:256 sc1
    buffer_load_dwordx2 v[236:237], v7, s[20:23], s45 offen offset:512 sc1
    buffer_load_dwordx2 v[238:239], v7, s[20:23], s45 offen offset:768 sc1
    buffer_load_dwordx2 v[240:241], v7, s[20:23], s45 offen offset:128 sc1
    buffer_load_dwordx2 v[242:243], v7, s[20:23], s45 offen offset:384 sc1
    buffer_load_dwordx2 v[244:245], v7, s[20:23], s45 offen offset:640 sc1
    buffer_load_dwordx2 v[246:247], v7, s[20:23], s45 offen offset:896 sc1
    s_waitcnt vmcnt(0)
    v_min3_f32 v250, v233, v235, v237
    v_min3_f32 v250, v250, v239, v241
    v_min3_f32 v250, v250, v243, v245
    v_min_f32 v250, v250, v247
    v_cmp_gt_f32 vcc, 0, v250
    s_nop 1
    s_cmp_eq_u64 vcc, 0
    s_cbranch_scc1 ZG_GOT
    s_add_u32 s47, s47, 1
    s_cmp_ge_u32 s47, 0x40000
    s_cbranch_scc1 ZG_GOT
    s_sleep 6
    s_branch ZG_POLL
ZG_GOT:
    v_add_f32 v232, v232, v234
    v_add_f32 v233, v233, v235
    v_add_f32 v240, v240, v242
    v_add_f32 v241, v241, v243
    v_add_f32 v232, v232, v236
    v_add_f32 v233, v233, v237
    v_add_f32 v240, v240, v244
    v_add_f32 v241, v241, v245
    v_add_f32 v232, v232, v238
    v_add_f32 v233, v233, v239
    v_add_f32 v240, v240, v246
    v_add_f32 v241, v241, v247
    v_mov_b32 v234, v232
    v_mov_b32 v235, v233
    v_mov_b32 v242, v240
    v_mov_b32 v243, v241
    v_permlane16_swap_b32 v232, v234
    v_permlane16_swap_b32 v233, v235
    v_permlane16_swap_b32 v240, v242
    v_permlane16_swap_b32 v241, v243
    v_add_f32 v232, v232, v234
    v_add_f32 v233, v233, v235
    v_add_f32 v240, v240, v242
    v_add_f32 v241, v241, v243
    v_mov_b32 v234, v232
    v_mov_b32 v235, v233
    v_mov_b32 v242, v240
    v_mov_b32 v243, v241
    v_permlane32_swap_b32 v232, v234
    v_permlane32_swap_b32 v233, v235
    v_permlane32_swap_b32 v240, v242
    v_permlane32_swap_b32 v241, v243
    v_add_f32 v232, v232, v234
    v_add_f32 v233, v233, v235
    v_add_f32 v240, v240, v242
    v_add_f32 v241, v241, v243
    v_mul_f32 v232, 0x39e38e39, v232
    v_mul_f32 v240, 0x39e38e39, v240
    v_mul_f32 v233, 0x39e38e39, v233
    v_mul_f32 v241, 0x39e38e39, v241
    v_fma_f32 v233, -v232, v232, v233
    v_fma_f32 v241, -v240, v240, v241
    v_max_f32 v233, 0, v233
    v_max_f32 v241, 0, v241
    v_cvt_pk_bf16_f32 v232, v232, v232
    v_cvt_pk_bf16_f32 v240, v240, v240
    v_cvt_pk_bf16_f32 v233, v233, v233
    v_cvt_pk_bf16_f32 v241, v241, v241
    v_lshlrev_b32 v232, 16, v232
    v_lshlrev_b32 v240, 16, v240
    v_lshlrev_b32 v233, 16, v233
    v_lshlrev_b32 v241, 16, v241
    v_add_f32 v233, 0x3727c5ac, v233
    v_add_f32 v241, 0x3727c5ac, v241
    v_cvt_pk_bf16_f32 v233, v233, v233
    v_cvt_pk_bf16_f32 v241, v241, v241
    v_lshlrev_b32 v233, 16, v233
    v_lshlrev_b32 v241, 16, v241
    v_sqrt_f32 v233, v233
    v_sqrt_f32 v241, v241
    v_cvt_pk_bf16_f32 v233, v233, v233
    v_cvt_pk_bf16_f32 v241, v241, v241
    v_lshlrev_b32 v233, 16, v233
    v_lshlrev_b32 v241, 16, v241
    v_rcp_f32 v233, v233
    v_rcp_f32 v241, v241
    v_mul_f32 v232, -v232, v233
    v_mul_f32 v240, -v240, v241
    v_fma_f32 v88, v88, v233, v232
    v_fma_f32 v89, v89, v233, v232
    v_fma_f32 v90, v90, v233, v232
    v_fma_f32 v91, v91, v233, v232
    v_fma_f32 v96, v96, v233, v232
    v_fma_f32 v97, v97, v233, v232
    v_fma_f32 v98, v98, v233, v232
    v_fma_f32 v99, v99, v233, v232
    v_cvt_pk_bf16_f32 v88, v88, v89
    v_cvt_pk_bf16_f32 v89, v90, v91
    v_cvt_pk_bf16_f32 v90, v96, v97
    v_cvt_pk_bf16_f32 v91, v98, v99
    buffer_store_dwordx4 v[88:91], v8, s[20:23], s48 offen offset:0 sc1
    v_fma_f32 v92, v92, v241, v240
    v_fma_f32 v93, v93, v241, v240
    v_fma_f32 v94, v94, v241, v240
    v_fma_f32 v95, v95, v241, v240
    v_fma_f32 v100, v100, v241, v240
    v_fma_f32 v101, v101, v241, v240
    v_fma_f32 v102, v102, v241, v240
    v_fma_f32 v103, v103, v241, v240
    v_cvt_pk_bf16_f32 v92, v92, v93
    v_cvt_pk_bf16_f32 v93, v94, v95
    v_cvt_pk_bf16_f32 v94, v100, v101
    v_cvt_pk_bf16_f32 v95, v102, v103
    buffer_store_dwordx4 v[92:95], v8, s[20:23], s48 offen offset:256 sc1
    v_fma_f32 v104, v104, v233, v232
    v_fma_f32 v105, v105, v233, v232
    v_fma_f32 v106, v106, v233, v232
    v_fma_f32 v107, v107, v233, v232
    v_fma_f32 v112, v112, v233, v232
    v_fma_f32 v113, v113, v233, v232
    v_fma_f32 v114, v114, v233, v232
    v_fma_f32 v115, v115, v233, v232
    v_cvt_pk_bf16_f32 v104, v104, v105
    v_cvt_pk_bf16_f32 v105, v106, v107
    v_cvt_pk_bf16_f32 v106, v112, v113
    v_cvt_pk_bf16_f32 v107, v114, v115
    buffer_store_dwordx4 v[104:107], v8, s[20:23], s48 offen offset:2048 sc1
    v_fma_f32 v108, v108, v241, v240
    v_fma_f32 v109, v109, v241, v240
    v_fma_f32 v110, v110, v241, v240
    v_fma_f32 v111, v111, v241, v240
    v_fma_f32 v116, v116, v241, v240
    v_fma_f32 v117, v117, v241, v240
    v_fma_f32 v118, v118, v241, v240
    v_fma_f32 v119, v119, v241, v240
    v_cvt_pk_bf16_f32 v108, v108, v109
    v_cvt_pk_bf16_f32 v109, v110, v111
    v_cvt_pk_bf16_f32 v110, v116, v117
    v_cvt_pk_bf16_f32 v111, v118, v119
    buffer_store_dwordx4 v[108:111], v8, s[20:23], s48 offen offset:2304 sc1
    v_fma_f32 v120, v120, v233, v232
    v_fma_f32 v121, v121, v233, v232
    v_fma_f32 v122, v122, v233, v232
    v_fma_f32 v123, v123, v233, v232
    v_fma_f32 v128, v128, v233, v232
    v_fma_f32 v129, v129, v233, v232
    v_fma_f32 v130, v130, v233, v232
    v_fma_f32 v131, v131, v233, v232
    v_cvt_pk_bf16_f32 v120, v120, v121
    v_cvt_pk_bf16_f32 v121, v122, v123
    v_cvt_pk_bf16_f32 v122, v128, v129
    v_cvt_pk_bf16_f32 v123, v130, v131
    buffer_store_dwordx4 v[120:123], v8, s[20:23], s49 offen offset:0 sc1
    v_fma_f32 v124, v124, v241, v240
    v_fma_f32 v125, v125, v241, v240
    v_fma_f32 v126, v126, v241, v240
    v_fma_f32 v127, v127, v241, v240
    v_fma_f32 v132, v132, v241, v240
    v_fma_f32 v133, v133, v241, v240
    v_fma_f32 v134, v134, v241, v240
    v_fma_f32 v135, v135, v241, v240
    v_cvt_pk_bf16_f32 v124, v124, v125
    v_cvt_pk_bf16_f32 v125, v126, v127
    v_cvt_pk_bf16_f32 v126, v132, v133
    v_cvt_pk_bf16_f32 v127, v134, v135
    buffer_store_dwordx4 v[124:127], v8, s[20:23], s49 offen offset:256 sc1
    v_fma_f32 v136, v136, v233, v232
    v_fma_f32 v137, v137, v233, v232
    v_fma_f32 v138, v138, v233, v232
    v_fma_f32 v139, v139, v233, v232
    v_fma_f32 v144, v144, v233, v232
    v_fma_f32 v145, v145, v233, v232
    v_fma_f32 v146, v146, v233, v232
    v_fma_f32 v147, v147, v233, v232
    v_cvt_pk_bf16_f32 v136, v136, v137
    v_cvt_pk_bf16_f32 v137, v138, v139
    v_cvt_pk_bf16_f32 v138, v144, v145
    v_cvt_pk_bf16_f32 v139, v146, v147
    buffer_store_dwordx4 v[136:139], v8, s[20:23], s49 offen offset:2048 sc1
    v_fma_f32 v140, v140, v241, v240
    v_fma_f32 v141, v141, v241, v240
    v_fma_f32 v142, v142, v241, v240
    v_fma_f32 v143, v143, v241, v240
    v_fma_f32 v148, v148, v241, v240
    v_fma_f32 v149, v149, v241, v240
    v_fma_f32 v150, v150, v241, v240
    v_fma_f32 v151, v151, v241, v240
    v_cvt_pk_bf16_f32 v140, v140, v141
    v_cvt_pk_bf16_f32 v141, v142, v143
    v_cvt_pk_bf16_f32 v142, v148, v149
    v_cvt_pk_bf16_f32 v143, v150, v151
    buffer_store_dwordx4 v[140:143], v8, s[20:23], s49 offen offset:2304 sc1
    v_fma_f32 v152, v152, v233, v232
    v_fma_f32 v153, v153, v233, v232
    v_fma_f32 v154, v154, v233, v232
    v_fma_f32 v155, v155, v233, v232
    v_cvt_pk_bf16_f32 v152, v152, v153
    v_cvt_pk_bf16_f32 v153, v154, v155
    buffer_store_dwordx2 v[152:153], v9, s[20:23], s50 offen offset:0 sc1
    v_fma_f32 v156, v156, v241, v240
    v_fma_f32 v157, v157, v241, v240
    v_fma_f32 v158, v158, v241, v240
    v_fma_f32 v159, v159, v241, v240
    v_cvt_pk_bf16_f32 v156, v156, v157
    v_cvt_pk_bf16_f32 v157, v158, v159
    buffer_store_dwordx2 v[156:157], v9, s[20:23], s50 offen offset:256 sc1
    v_and_b32 v1, 63, v0
    v_lshrrev_b32 v228, 6, v0
    s_and_b32 s28, s3, 7
    s_lshr_b32 s29, s3, 3
    s_and_b32 s30, s28, 1
    s_lshl_b32 s30, s30, 3
    s_and_b32 s31, s29, 7
    s_add_u32 s30, s30, s31
    s_lshr_b32 s31, s28, 1
    s_lshl_b32 s31, s31, 2
    s_lshr_b32 s32, s29, 3
    s_add_u32 s31, s31, s32
    v_readfirstlane_b32 s32, v228
    v_lshlrev_b32 v2, 4, v1
    v_lshrrev_b32 v229, 3, v1
    v_lshrrev_b32 v231, 4, v1
    v_and_b32 v230, 7, v1
    v_xor_b32 v230, v230, v231
    s_lshl_b32 s39, s32, 11
    s_lshl_b32 s38, s32, 13
    s_add_u32 s38, s38, 36864
    s_lshl_b32 s40, s32, 8
    s_add_u32 s40, s40, 8192
    s_lshl_b32 s44, s30, 7
    s_lshl_b32 s45, s32, 5
    s_add_u32 s44, s44, s45
    v_add_u32 v229, s44, v229
    v_lshlrev_b32 v10, 12, v229
    v_lshl_add_u32 v10, v230, 4, v10
    v_xor_b32 v11, 64, v10
    v_add_u32 v11, 31744, v11
    s_mov_b32 s41, 63488
    s_mul_i32 s43, s31, 589824
    s_add_u32 s43, s43, 20447232
    s_add_u32 s46, s43, s40
    s_add_u32 s43, s43, s39
    s_mov_b32 s42, 0
    v_and_b32 v229, 15, v1
    v_lshrrev_b32 v230, 4, v1
    v_lshrrev_b32 v231, 1, v229
    v_xor_b32 v231, v231, v230
    v_lshlrev_b32 v231, 4, v231
    v_lshl_add_u32 v3, v229, 7, v231
    v_add_u32 v3, s38, v3
    v_xor_b32 v14, 64, v3
    v_lshlrev_b32 v12, 9, v230
    v_lshl_add_u32 v12, v229, 4, v12
    v_lshrrev_b32 v231, 1, v230
    v_lshlrev_b32 v13, 9, v231
    v_lshl_add_u32 v13, v229, 4, v13
    v_and_b32 v231, 1, v230
    v_lshl_add_u32 v13, v231, 3, v13
    v_bfe_u32 v231, v1, 2, 2
    v_lshl_add_u32 v231, v230, 3, v231
    v_and_b32 v232, 1, v1
    v_lshlrev_b32 v233, 2, v232
    v_xor_b32 v233, v233, v231
    v_lshlrev_b32 v233, 4, v233
    v_and_b32 v234, 3, v1
    v_lshl_add_u32 v233, v234, 9, v233
    v_bfe_u32 v234, v1, 1, 1
    v_lshl_add_u32 v233, v234, 3, v233
    v_mov_b32 v4, v233
    v_xor_b32 v5, 64, v4
    v_xor_b32 v6, 8, v4
    v_xor_b32 v7, 8, v5
    v_lshlrev_b32 v233, 2, v234
    v_xor_b32 v233, v233, v231
    v_lshlrev_b32 v233, 4, v233
    v_lshl_add_u32 v233, v234, 9, v233
    v_lshl_add_u32 v233, v232, 3, v233
    v_add_u32 v8, 8192, v233
    v_xor_b32 v9, 64, v8
    s_lshl_b32 s48, s30, 2
    s_add_u32 s48, s48, s32
    s_mul_i32 s48, s48, 144
    s_mul_i32 s49, s31, 9
    s_add_u32 s48, s48, s49
    s_lshl_b32 s48, s48, 10
    s_add_u32 s48, s48, 30408704
    s_add_u32 s49, s48, 4096
    s_add_u32 s50, s48, 8192
    s_lshl_b32 s44, s44, 1
    v_lshlrev_b32 v249, 1, v229
    v_mov_b32 v16, 0
    v_mov_b32 v17, 0
    v_mov_b32 v18, 0
    v_mov_b32 v19, 0
    v_mov_b32 v20, 0
    v_mov_b32 v21, 0
    v_mov_b32 v22, 0
    v_mov_b32 v23, 0
    v_mov_b32 v24, 0
    v_mov_b32 v25, 0
    v_mov_b32 v26, 0
    v_mov_b32 v27, 0
    v_mov_b32 v28, 0
    v_mov_b32 v29, 0
    v_mov_b32 v30, 0
    v_mov_b32 v31, 0
    v_mov_b32 v32, 0
    v_mov_b32 v33, 0
    v_mov_b32 v34, 0
    v_mov_b32 v35, 0
    v_mov_b32 v36, 0
    v_mov_b32 v37, 0
    v_mov_b32 v38, 0
    v_mov_b32 v39, 0
    v_mov_b32 v40, 0
    v_mov_b32 v41, 0
    v_mov_b32 v42, 0
    v_mov_b32 v43, 0
    v_mov_b32 v44, 0
    v_mov_b32 v45, 0
    v_mov_b32 v46, 0
    v_mov_b32 v47, 0
    v_mov_b32 v48, 0
    v_mov_b32 v49, 0
    v_mov_b32 v50, 0
    v_mov_b32 v51, 0
    v_mov_b32 v52, 0
    v_mov_b32 v53, 0
    v_mov_b32 v54, 0
    v_mov_b32 v55, 0
    v_mov_b32 v56, 0
    v_mov_b32 v57, 0
    v_mov_b32 v58, 0
    v_mov_b32 v59, 0
    v_mov_b32 v60, 0
    v_mov_b32 v61, 0
    v_mov_b32 v62, 0
    v_mov_b32 v63, 0
    v_mov_b32 v64, 0
    v_mov_b32 v65, 0
    v_mov_b32 v66, 0
    v_mov_b32 v67, 0
    v_mov_b32 v68, 0
    v_mov_b32 v69, 0
    v_mov_b32 v70, 0
    v_mov_b32 v71, 0
    v_mov_b32 v72, 0
    v_mov_b32 v73, 0
    v_mov_b32 v74, 0
    v_mov_b32 v75, 0
    v_mov_b32 v76, 0
    v_mov_b32 v77, 0
    v_mov_b32 v78, 0
    v_mov_b32 v79, 0
    v_mov_b32 v80, 0
    v_mov_b32 v81, 0
    v_mov_b32 v82, 0
    v_mov_b32 v83, 0
    v_mov_b32 v84, 0
    v_mov_b32 v85, 0
    v_mov_b32 v86, 0
    v_mov_b32 v87, 0
    s_lshl_b32 s51, s31, 7
    s_add_u32 s51, s51, 12605440
    s_lshl_b32 s52, s30, 2
    s_add_u32 s52, s52, s51
    s_lshl_b32 s53, s30, 7
    s_lshl_b32 s54, s31, 2
    s_add_u32 s53, s53, s54
    s_add_u32 s53, s53, 12599360
    v_mov_b32 v238, 0
    s_waitcnt vmcnt(0)
    s_barrier
    s_cmp_lg_u32 s32, 0
    s_cbranch_scc1 G2_NOSIG
    v_mov_b32 v236, 0
    v_mov_b32 v237, 1
    s_mov_b64 exec, 1
    buffer_store_dword v237, v236, s[20:23], s52 offen sc1
    s_mov_b64 exec, -1
G2_NOSIG:
    s_add_u32 m0, s38, 0
    s_nop 0
    buffer_load_dwordx4 v10, s[12:15], s42 offen lds
    buffer_load_dwordx4 v11, s[12:15], s42 offen offset:1024 lds
    s_add_u32 s42, s42, 128
    s_add_u32 m0, s38, 0
    s_nop 0
    buffer_load_dwordx4 v10, s[12:15], s41 offen offset:2048 lds
    buffer_load_dwordx4 v11, s[12:15], s41 offen offset:3072 lds
    s_add_u32 s41, s41, 128
    s_add_u32 m0, s38, 4096
    s_nop 0
    buffer_load_dwordx4 v10, s[12:15], s42 offen lds
    buffer_load_dwordx4 v11, s[12:15], s42 offen offset:1024 lds
    s_add_u32 s42, s42, 128
    s_add_u32 m0, s38, 4096
    s_nop 0
    buffer_load_dwordx4 v10, s[12:15], s41 offen offset:2048 lds
    buffer_load_dwordx4 v11, s[12:15], s41 offen offset:3072 lds
    s_add_u32 s41, s41, 128
    s_cmp_lg_u32 s32, 0
    s_cbranch_scc1 G2Z_OK
    v_lshlrev_b32 v236, 2, v229
    s_mov_b32 s47, 0
    buffer_load_dword v237, v236, s[20:23], s51 offen sc1
G2Z_P:
    s_waitcnt vmcnt(0)
    v_cmp_eq_u32 vcc, 0, v237
    s_nop 1
    s_cmp_eq_u64 vcc, 0
    s_cbranch_scc1 G2Z_OK
    s_add_u32 s47, s47, 1
    s_cmp_ge_u32 s47, 0x40000
    s_cbranch_scc1 G2Z_OK
    s_sleep 6
    buffer_load_dword v237, v236, s[20:23], s51 offen sc1
    s_branch G2Z_P
G2Z_OK:
    s_barrier
    s_add_u32 m0, s39, 0
    s_nop 0
    buffer_load_dwordx4 v2, s[20:23], s43 offen sc1 lds
    buffer_load_dwordx4 v2, s[20:23], s43 offen offset:1024 sc1 lds
    s_add_u32 s43, s43, 9216
    s_add_u32 m0, s40, 0
    s_mov_b64 exec, 0xffff
    buffer_load_dwordx4 v2, s[20:23], s46 offen sc1 lds
    s_mov_b64 exec, -1
    s_add_u32 s46, s46, 9216
    s_add_u32 m0, s39, 9216
    s_nop 0
    buffer_load_dwordx4 v2, s[20:23], s43 offen sc1 lds
    buffer_load_dwordx4 v2, s[20:23], s43 offen offset:1024 sc1 lds
    s_add_u32 s43, s43, 9216
    s_add_u32 m0, s40, 9216
    s_mov_b64 exec, 0xffff
    buffer_load_dwordx4 v2, s[20:23], s46 offen sc1 lds
    s_mov_b64 exec, -1
    s_add_u32 s46, s46, 9216
    s_add_u32 m0, s39, 18432
    s_nop 0
    buffer_load_dwordx4 v2, s[20:23], s43 offen sc1 lds
    buffer_load_dwordx4 v2, s[20:23], s43 offen offset:1024 sc1 lds
    s_add_u32 s43, s43, 9216
    s_add_u32 m0, s40, 18432
    s_mov_b64 exec, 0xffff
    buffer_load_dwordx4 v2, s[20:23], s46 offen sc1 lds
    s_mov_b64 exec, -1
    s_add_u32 s46, s46, 9216
    s_add_u32 m0, s39, 27648
    s_nop 0
    buffer_load_dwordx4 v2, s[20:23], s43 offen sc1 lds
    buffer_load_dwordx4 v2, s[20:23], s43 offen offset:1024 sc1 lds
    s_add_u32 s43, s43, 9216
    s_add_u32 m0, s40, 27648
    s_mov_b64 exec, 0xffff
    buffer_load_dwordx4 v2, s[20:23], s46 offen sc1 lds
    s_mov_b64 exec, -1
    s_add_u32 s46, s46, 9216
    s_waitcnt vmcnt(3)
    s_barrier
    ds_read_b128 v[160:163], v3 offset:0
    ds_read_b128 v[164:167], v3 offset:2048
    ds_read_b128 v[168:171], v14 offset:0
    ds_read_b128 v[172:175], v14 offset:2048
    ds_read_b64_tr_b16 v[88:89], v4 offset:0
    ds_read_b64_tr_b16 v[90:91], v5 offset:0
    ds_read_b64_tr_b16 v[92:93], v6 offset:0
    ds_read_b64_tr_b16 v[94:95], v7 offset:0
    ds_read_b64_tr_b16 v[96:97], v4 offset:2048
    ds_read_b64_tr_b16 v[98:99], v5 offset:2048
    ds_read_b64_tr_b16 v[100:101], v6 offset:2048
    ds_read_b64_tr_b16 v[102:103], v7 offset:2048
    ds_read_b64_tr_b16 v[104:105], v4 offset:4096
    ds_read_b64_tr_b16 v[106:107], v5 offset:4096
    ds_read_b64_tr_b16 v[108:109], v6 offset:4096
    ds_read_b64_tr_b16 v[110:111], v7 offset:4096
    ds_read_b64_tr_b16 v[112:113], v4 offset:6144
    ds_read_b64_tr_b16 v[114:115], v5 offset:6144
    ds_read_b64_tr_b16 v[116:117], v6 offset:6144
    ds_read_b64_tr_b16 v[118:119], v7 offset:6144
    ds_read_b64_tr_b16 v[120:121], v8 offset:0
    ds_read_b64_tr_b16 v[122:123], v9 offset:0
    s_mov_b32 s47, 14
    s_setprio 2
G2_LOOP:
    s_waitcnt vmcnt(10) lgkmcnt(0)
    s_barrier
    ds_read_b64_tr_b16 v[124:125], v4 offset:9216
    ds_read_b64_tr_b16 v[126:127], v5 offset:9216
    ds_read_b64_tr_b16 v[128:129], v6 offset:9216
    ds_read_b64_tr_b16 v[130:131], v7 offset:9216
    v_mfma_f32_16x16x32_bf16 v[16:19], v[88:91], v[160:163], v[16:19]
    ds_read_b64_tr_b16 v[132:133], v4 offset:11264
    ds_read_b64_tr_b16 v[134:135], v5 offset:11264
    v_mfma_f32_16x16x32_bf16 v[20:23], v[88:91], v[164:167], v[20:23]
    s_add_u32 m0, s38, 0
    s_nop 0
    buffer_load_dwordx4 v10, s[12:15], s42 offen lds
    v_mfma_f32_16x16x32_bf16 v[24:27], v[92:95], v[160:163], v[24:27]
    ds_read_b64_tr_b16 v[136:137], v6 offset:11264
    ds_read_b64_tr_b16 v[138:139], v7 offset:11264
    v_mfma_f32_16x16x32_bf16 v[28:31], v[92:95], v[164:167], v[28:31]
    buffer_load_dwordx4 v11, s[12:15], s42 offen offset:1024 lds
    s_add_u32 s42, s42, 128
    v_mfma_f32_16x16x32_bf16 v[32:35], v[96:99], v[160:163], v[32:35]
    ds_read_b64_tr_b16 v[140:141], v4 offset:13312
    ds_read_b64_tr_b16 v[142:143], v5 offset:13312
    v_mfma_f32_16x16x32_bf16 v[36:39], v[96:99], v[164:167], v[36:39]
    ds_read_b64_tr_b16 v[144:145], v6 offset:13312
    ds_read_b64_tr_b16 v[146:147], v7 offset:13312
    v_mfma_f32_16x16x32_bf16 v[40:43], v[100:103], v[160:163], v[40:43]
    s_add_u32 m0, s38, 0
    s_nop 0
    buffer_load_dwordx4 v10, s[12:15], s41 offen offset:2048 lds
    v_mfma_f32_16x16x32_bf16 v[44:47], v[100:103], v[164:167], v[44:47]
    ds_read_b64_tr_b16 v[148:149], v4 offset:15360
    v_mfma_f32_16x16x32_bf16 v[48:51], v[104:107], v[160:163], v[48:51]
    buffer_load_dwordx4 v11, s[12:15], s41 offen offset:3072 lds
    s_add_u32 s41, s41, 128
    v_mfma_f32_16x16x32_bf16 v[52:55], v[104:107], v[164:167], v[52:55]
    ds_read_b64_tr_b16 v[150:151], v5 offset:15360
    v_mfma_f32_16x16x32_bf16 v[56:59], v[108:111], v[160:163], v[56:59]
    ds_read_b64_tr_b16 v[152:153], v6 offset:15360
    v_mfma_f32_16x16x32_bf16 v[60:63], v[108:111], v[164:167], v[60:63]
    s_add_u32 m0, s39, 0
    s_nop 0
    buffer_load_dwordx4 v2, s[20:23], s43 offen sc1 lds
    v_mfma_f32_16x16x32_bf16 v[64:67], v[112:115], v[160:163], v[64:67]
    ds_read_b64_tr_b16 v[154:155], v7 offset:15360
    v_mfma_f32_16x16x32_bf16 v[68:71], v[112:115], v[164:167], v[68:71]
    buffer_load_dwordx4 v2, s[20:23], s43 offen offset:1024 sc1 lds
    s_add_u32 s43, s43, 9216
    v_mfma_f32_16x16x32_bf16 v[72:75], v[116:119], v[160:163], v[72:75]
    ds_read_b64_tr_b16 v[156:157], v8 offset:9216
    v_mfma_f32_16x16x32_bf16 v[76:79], v[116:119], v[164:167], v[76:79]
    ds_read_b64_tr_b16 v[158:159], v9 offset:9216
    v_mfma_f32_16x16x32_bf16 v[80:83], v[120:123], v[160:163], v[80:83]
    s_add_u32 m0, s40, 0
    s_mov_b64 exec, 0xffff
    buffer_load_dwordx4 v2, s[20:23], s46 offen sc1 lds
    s_mov_b64 exec, -1
    s_add_u32 s46, s46, 9216
    v_mfma_f32_16x16x32_bf16 v[84:87], v[120:123], v[164:167], v[84:87]
    s_waitcnt vmcnt(10) lgkmcnt(0)
    s_barrier
    ds_read_b128 v[176:179], v3 offset:4096
    ds_read_b128 v[180:183], v3 offset:6144
    ds_read_b128 v[184:187], v14 offset:4096
    ds_read_b128 v[188:191], v14 offset:6144
    v_mfma_f32_16x16x32_bf16 v[16:19], v[124:127], v[168:171], v[16:19]
    ds_read_b64_tr_b16 v[88:89], v4 offset:18432
    ds_read_b64_tr_b16 v[90:91], v5 offset:18432
    v_mfma_f32_16x16x32_bf16 v[20:23], v[124:127], v[172:175], v[20:23]
    s_add_u32 m0, s39, 9216
    s_nop 0
    buffer_load_dwordx4 v2, s[20:23], s43 offen sc1 lds
    v_mfma_f32_16x16x32_bf16 v[24:27], v[128:131], v[168:171], v[24:27]
    ds_read_b64_tr_b16 v[92:93], v6 offset:18432
    ds_read_b64_tr_b16 v[94:95], v7 offset:18432
    v_mfma_f32_16x16x32_bf16 v[28:31], v[128:131], v[172:175], v[28:31]
    ds_read_b64_tr_b16 v[96:97], v4 offset:20480
    ds_read_b64_tr_b16 v[98:99], v5 offset:20480
    v_mfma_f32_16x16x32_bf16 v[32:35], v[132:135], v[168:171], v[32:35]
    ds_read_b64_tr_b16 v[100:101], v6 offset:20480
    ds_read_b64_tr_b16 v[102:103], v7 offset:20480
    v_mfma_f32_16x16x32_bf16 v[36:39], v[132:135], v[172:175], v[36:39]
    ds_read_b64_tr_b16 v[104:105], v4 offset:22528
    ds_read_b64_tr_b16 v[106:107], v5 offset:22528
    v_mfma_f32_16x16x32_bf16 v[40:43], v[136:139], v[168:171], v[40:43]
    buffer_load_dwordx4 v2, s[20:23], s43 offen offset:1024 sc1 lds
    s_add_u32 s43, s43, 9216
    v_mfma_f32_16x16x32_bf16 v[44:47], v[136:139], v[172:175], v[44:47]
    ds_read_b64_tr_b16 v[108:109], v6 offset:22528
    v_mfma_f32_16x16x32_bf16 v[48:51], v[140:143], v[168:171], v[48:51]
    ds_read_b64_tr_b16 v[110:111], v7 offset:22528
    v_mfma_f32_16x16x32_bf16 v[52:55], v[140:143], v[172:175], v[52:55]
    ds_read_b64_tr_b16 v[112:113], v4 offset:24576
    v_mfma_f32_16x16x32_bf16 v[56:59], v[144:147], v[168:171], v[56:59]
    ds_read_b64_tr_b16 v[114:115], v5 offset:24576
    v_mfma_f32_16x16x32_bf16 v[60:63], v[144:147], v[172:175], v[60:63]
    s_add_u32 m0, s40, 9216
    s_mov_b64 exec, 0xffff
    buffer_load_dwordx4 v2, s[20:23], s46 offen sc1 lds
    s_mov_b64 exec, -1
    s_add_u32 s46, s46, 9216
    v_mfma_f32_16x16x32_bf16 v[64:67], v[148:151], v[168:171], v[64:67]
    ds_read_b64_tr_b16 v[116:117], v6 offset:24576
    v_mfma_f32_16x16x32_bf16 v[68:71], v[148:151], v[172:175], v[68:71]
    ds_read_b64_tr_b16 v[118:119], v7 offset:24576
    v_mfma_f32_16x16x32_bf16 v[72:75], v[152:155], v[168:171], v[72:75]
    ds_read_b64_tr_b16 v[120:121], v8 offset:18432
    v_mfma_f32_16x16x32_bf16 v[76:79], v[152:155], v[172:175], v[76:79]
    ds_read_b64_tr_b16 v[122:123], v9 offset:18432
    v_mfma_f32_16x16x32_bf16 v[80:83], v[156:159], v[168:171], v[80:83]
    v_mfma_f32_16x16x32_bf16 v[84:87], v[156:159], v[172:175], v[84:87]
    s_waitcnt vmcnt(10) lgkmcnt(0)
    s_barrier
    ds_read_b64_tr_b16 v[124:125], v4 offset:27648
    ds_read_b64_tr_b16 v[126:127], v5 offset:27648
    ds_read_b64_tr_b16 v[128:129], v6 offset:27648
    ds_read_b64_tr_b16 v[130:131], v7 offset:27648
    v_mfma_f32_16x16x32_bf16 v[16:19], v[88:91], v[176:179], v[16:19]
    ds_read_b64_tr_b16 v[132:133], v4 offset:29696
    ds_read_b64_tr_b16 v[134:135], v5 offset:29696
    v_mfma_f32_16x16x32_bf16 v[20:23], v[88:91], v[180:183], v[20:23]
    s_add_u32 m0, s38, 4096
    s_nop 0
    buffer_load_dwordx4 v10, s[12:15], s42 offen lds
    v_mfma_f32_16x16x32_bf16 v[24:27], v[92:95], v[176:179], v[24:27]
    ds_read_b64_tr_b16 v[136:137], v6 offset:29696
    ds_read_b64_tr_b16 v[138:139], v7 offset:29696
    v_mfma_f32_16x16x32_bf16 v[28:31], v[92:95], v[180:183], v[28:31]
    buffer_load_dwordx4 v11, s[12:15], s42 offen offset:1024 lds
    s_add_u32 s42, s42, 128
    v_mfma_f32_16x16x32_bf16 v[32:35], v[96:99], v[176:179], v[32:35]
    ds_read_b64_tr_b16 v[140:141], v4 offset:31744
    ds_read_b64_tr_b16 v[142:143], v5 offset:31744
    v_mfma_f32_16x16x32_bf16 v[36:39], v[96:99], v[180:183], v[36:39]
    ds_read_b64_tr_b16 v[144:145], v6 offset:31744
    ds_read_b64_tr_b16 v[146:147], v7 offset:31744
    v_mfma_f32_16x16x32_bf16 v[40:43], v[100:103], v[176:179], v[40:43]
    s_add_u32 m0, s38, 4096
    s_nop 0
    buffer_load_dwordx4 v10, s[12:15], s41 offen offset:2048 lds
    v_mfma_f32_16x16x32_bf16 v[44:47], v[100:103], v[180:183], v[44:47]
    ds_read_b64_tr_b16 v[148:149], v4 offset:33792
    v_mfma_f32_16x16x32_bf16 v[48:51], v[104:107], v[176:179], v[48:51]
    buffer_load_dwordx4 v11, s[12:15], s41 offen offset:3072 lds
    s_add_u32 s41, s41, 128
    v_mfma_f32_16x16x32_bf16 v[52:55], v[104:107], v[180:183], v[52:55]
    ds_read_b64_tr_b16 v[150:151], v5 offset:33792
    v_mfma_f32_16x16x32_bf16 v[56:59], v[108:111], v[176:179], v[56:59]
    ds_read_b64_tr_b16 v[152:153], v6 offset:33792
    v_mfma_f32_16x16x32_bf16 v[60:63], v[108:111], v[180:183], v[60:63]
    s_add_u32 m0, s39, 18432
    s_nop 0
    buffer_load_dwordx4 v2, s[20:23], s43 offen sc1 lds
    v_mfma_f32_16x16x32_bf16 v[64:67], v[112:115], v[176:179], v[64:67]
    ds_read_b64_tr_b16 v[154:155], v7 offset:33792
    v_mfma_f32_16x16x32_bf16 v[68:71], v[112:115], v[180:183], v[68:71]
    buffer_load_dwordx4 v2, s[20:23], s43 offen offset:1024 sc1 lds
    s_add_u32 s43, s43, 9216
    v_mfma_f32_16x16x32_bf16 v[72:75], v[116:119], v[176:179], v[72:75]
    ds_read_b64_tr_b16 v[156:157], v8 offset:27648
    v_mfma_f32_16x16x32_bf16 v[76:79], v[116:119], v[180:183], v[76:79]
    ds_read_b64_tr_b16 v[158:159], v9 offset:27648
    v_mfma_f32_16x16x32_bf16 v[80:83], v[120:123], v[176:179], v[80:83]
    s_add_u32 m0, s40, 18432
    s_mov_b64 exec, 0xffff
    buffer_load_dwordx4 v2, s[20:23], s46 offen sc1 lds
    s_mov_b64 exec, -1
    s_add_u32 s46, s46, 9216
    v_mfma_f32_16x16x32_bf16 v[84:87], v[120:123], v[180:183], v[84:87]
    s_waitcnt vmcnt(10) lgkmcnt(0)
    s_barrier
    ds_read_b128 v[160:163], v3 offset:0
    ds_read_b128 v[164:167], v3 offset:2048
    ds_read_b128 v[168:171], v14 offset:0
    ds_read_b128 v[172:175], v14 offset:2048
    v_mfma_f32_16x16x32_bf16 v[16:19], v[124:127], v[184:187], v[16:19]
    ds_read_b64_tr_b16 v[88:89], v4 offset:0
    ds_read_b64_tr_b16 v[90:91], v5 offset:0
    v_mfma_f32_16x16x32_bf16 v[20:23], v[124:127], v[188:191], v[20:23]
    s_add_u32 m0, s39, 27648
    s_nop 0
    buffer_load_dwordx4 v2, s[20:23], s43 offen sc1 lds
    v_mfma_f32_16x16x32_bf16 v[24:27], v[128:131], v[184:187], v[24:27]
    ds_read_b64_tr_b16 v[92:93], v6 offset:0
    ds_read_b64_tr_b16 v[94:95], v7 offset:0
    v_mfma_f32_16x16x32_bf16 v[28:31], v[128:131], v[188:191], v[28:31]
    ds_read_b64_tr_b16 v[96:97], v4 offset:2048
    ds_read_b64_tr_b16 v[98:99], v5 offset:2048
    v_mfma_f32_16x16x32_bf16 v[32:35], v[132:135], v[184:187], v[32:35]
    ds_read_b64_tr_b16 v[100:101], v6 offset:2048
    ds_read_b64_tr_b16 v[102:103], v7 offset:2048
    v_mfma_f32_16x16x32_bf16 v[36:39], v[132:135], v[188:191], v[36:39]
    ds_read_b64_tr_b16 v[104:105], v4 offset:4096
    ds_read_b64_tr_b16 v[106:107], v5 offset:4096
    v_mfma_f32_16x16x32_bf16 v[40:43], v[136:139], v[184:187], v[40:43]
    buffer_load_dwordx4 v2, s[20:23], s43 offen offset:1024 sc1 lds
    s_add_u32 s43, s43, 9216
    v_mfma_f32_16x16x32_bf16 v[44:47], v[136:139], v[188:191], v[44:47]
    ds_read_b64_tr_b16 v[108:109], v6 offset:4096
    v_mfma_f32_16x16x32_bf16 v[48:51], v[140:143], v[184:187], v[48:51]
    ds_read_b64_tr_b16 v[110:111], v7 offset:4096
    v_mfma_f32_16x16x32_bf16 v[52:55], v[140:143], v[188:191], v[52:55]
    ds_read_b64_tr_b16 v[112:113], v4 offset:6144
    v_mfma_f32_16x16x32_bf16 v[56:59], v[144:147], v[184:187], v[56:59]
    ds_read_b64_tr_b16 v[114:115], v5 offset:6144
    v_mfma_f32_16x16x32_bf16 v[60:63], v[144:147], v[188:191], v[60:63]
    s_add_u32 m0, s40, 27648
    s_mov_b64 exec, 0xffff
    buffer_load_dwordx4 v2, s[20:23], s46 offen sc1 lds
    s_mov_b64 exec, -1
    s_add_u32 s46, s46, 9216
    v_mfma_f32_16x16x32_bf16 v[64:67], v[148:151], v[184:187], v[64:67]
    ds_read_b64_tr_b16 v[116:117], v6 offset:6144
    v_mfma_f32_16x16x32_bf16 v[68:71], v[148:151], v[188:191], v[68:71]
    ds_read_b64_tr_b16 v[118:119], v7 offset:6144
    v_mfma_f32_16x16x32_bf16 v[72:75], v[152:155], v[184:187], v[72:75]
    ds_read_b64_tr_b16 v[120:121], v8 offset:0
    v_mfma_f32_16x16x32_bf16 v[76:79], v[152:155], v[188:191], v[76:79]
    ds_read_b64_tr_b16 v[122:123], v9 offset:0
    v_mfma_f32_16x16x32_bf16 v[80:83], v[156:159], v[184:187], v[80:83]
    v_mfma_f32_16x16x32_bf16 v[84:87], v[156:159], v[188:191], v[84:87]
    s_sub_u32 s47, s47, 1
    s_cmp_lg_u32 s47, 0
    s_cbranch_scc1 G2_LOOP
    s_waitcnt vmcnt(10) lgkmcnt(0)
    s_barrier
    ds_read_b64_tr_b16 v[124:125], v4 offset:9216
    ds_read_b64_tr_b16 v[126:127], v5 offset:9216
    ds_read_b64_tr_b16 v[128:129], v6 offset:9216
    ds_read_b64_tr_b16 v[130:131], v7 offset:9216
    v_mfma_f32_16x16x32_bf16 v[16:19], v[88:91], v[160:163], v[16:19]
    ds_read_b64_tr_b16 v[132:133], v4 offset:11264
    ds_read_b64_tr_b16 v[134:135], v5 offset:11264
    v_mfma_f32_16x16x32_bf16 v[20:23], v[88:91], v[164:167], v[20:23]
    s_add_u32 m0, s38, 0
    s_nop 0
    buffer_load_dwordx4 v10, s[12:15], s42 offen lds
    v_mfma_f32_16x16x32_bf16 v[24:27], v[92:95], v[160:163], v[24:27]
    ds_read_b64_tr_b16 v[136:137], v6 offset:11264
    ds_read_b64_tr_b16 v[138:139], v7 offset:11264
    v_mfma_f32_16x16x32_bf16 v[28:31], v[92:95], v[164:167], v[28:31]
    buffer_load_dwordx4 v11, s[12:15], s42 offen offset:1024 lds
    s_add_u32 s42, s42, 128
    v_mfma_f32_16x16x32_bf16 v[32:35], v[96:99], v[160:163], v[32:35]
    ds_read_b64_tr_b16 v[140:141], v4 offset:13312
    ds_read_b64_tr_b16 v[142:143], v5 offset:13312
    v_mfma_f32_16x16x32_bf16 v[36:39], v[96:99], v[164:167], v[36:39]
    ds_read_b64_tr_b16 v[144:145], v6 offset:13312
    ds_read_b64_tr_b16 v[146:147], v7 offset:13312
    v_mfma_f32_16x16x32_bf16 v[40:43], v[100:103], v[160:163], v[40:43]
    s_add_u32 m0, s38, 0
    s_nop 0
    buffer_load_dwordx4 v10, s[12:15], s41 offen offset:2048 lds
    v_mfma_f32_16x16x32_bf16 v[44:47], v[100:103], v[164:167], v[44:47]
    ds_read_b64_tr_b16 v[148:149], v4 offset:15360
    v_mfma_f32_16x16x32_bf16 v[48:51], v[104:107], v[160:163], v[48:51]
    buffer_load_dwordx4 v11, s[12:15], s41 offen offset:3072 lds
    s_add_u32 s41, s41, 128
    v_mfma_f32_16x16x32_bf16 v[52:55], v[104:107], v[164:167], v[52:55]
    ds_read_b64_tr_b16 v[150:151], v5 offset:15360
    v_mfma_f32_16x16x32_bf16 v[56:59], v[108:111], v[160:163], v[56:59]
    ds_read_b64_tr_b16 v[152:153], v6 offset:15360
    v_mfma_f32_16x16x32_bf16 v[60:63], v[108:111], v[164:167], v[60:63]
    s_add_u32 m0, s39, 0
    s_nop 0
    buffer_load_dwordx4 v2, s[20:23], s43 offen sc1 lds
    v_mfma_f32_16x16x32_bf16 v[64:67], v[112:115], v[160:163], v[64:67]
    ds_read_b64_tr_b16 v[154:155], v7 offset:15360
    v_mfma_f32_16x16x32_bf16 v[68:71], v[112:115], v[164:167], v[68:71]
    buffer_load_dwordx4 v2, s[20:23], s43 offen offset:1024 sc1 lds
    s_add_u32 s43, s43, 9216
    v_mfma_f32_16x16x32_bf16 v[72:75], v[116:119], v[160:163], v[72:75]
    ds_read_b64_tr_b16 v[156:157], v8 offset:9216
    v_mfma_f32_16x16x32_bf16 v[76:79], v[116:119], v[164:167], v[76:79]
    ds_read_b64_tr_b16 v[158:159], v9 offset:9216
    v_mfma_f32_16x16x32_bf16 v[80:83], v[120:123], v[160:163], v[80:83]
    s_add_u32 m0, s40, 0
    s_mov_b64 exec, 0xffff
    buffer_load_dwordx4 v2, s[20:23], s46 offen sc1 lds
    s_mov_b64 exec, -1
    s_add_u32 s46, s46, 9216
    v_mfma_f32_16x16x32_bf16 v[84:87], v[120:123], v[164:167], v[84:87]
    buffer_load_dword v239, v238, s[20:23], s53 offen sc1
    s_waitcnt vmcnt(10) lgkmcnt(0)
    s_barrier
    ds_read_b128 v[176:179], v3 offset:4096
    ds_read_b128 v[180:183], v3 offset:6144
    ds_read_b128 v[184:187], v14 offset:4096
    ds_read_b128 v[188:191], v14 offset:6144
    v_mfma_f32_16x16x32_bf16 v[16:19], v[124:127], v[168:171], v[16:19]
    ds_read_b64_tr_b16 v[88:89], v4 offset:18432
    ds_read_b64_tr_b16 v[90:91], v5 offset:18432
    v_mfma_f32_16x16x32_bf16 v[20:23], v[124:127], v[172:175], v[20:23]
    s_add_u32 m0, s39, 9216
    s_nop 0
    buffer_load_dwordx4 v2, s[20:23], s43 offen sc1 lds
    v_mfma_f32_16x16x32_bf16 v[24:27], v[128:131], v[168:171], v[24:27]
    ds_read_b64_tr_b16 v[92:93], v6 offset:18432
    ds_read_b64_tr_b16 v[94:95], v7 offset:18432
    v_mfma_f32_16x16x32_bf16 v[28:31], v[128:131], v[172:175], v[28:31]
    ds_read_b64_tr_b16 v[96:97], v4 offset:20480
    ds_read_b64_tr_b16 v[98:99], v5 offset:20480
    v_mfma_f32_16x16x32_bf16 v[32:35], v[132:135], v[168:171], v[32:35]
    ds_read_b64_tr_b16 v[100:101], v6 offset:20480
    ds_read_b64_tr_b16 v[102:103], v7 offset:20480
    v_mfma_f32_16x16x32_bf16 v[36:39], v[132:135], v[172:175], v[36:39]
    ds_read_b64_tr_b16 v[104:105], v4 offset:22528
    ds_read_b64_tr_b16 v[106:107], v5 offset:22528
    v_mfma_f32_16x16x32_bf16 v[40:43], v[136:139], v[168:171], v[40:43]
    buffer_load_dwordx4 v2, s[20:23], s43 offen offset:1024 sc1 lds
    s_add_u32 s43, s43, 9216
    v_mfma_f32_16x16x32_bf16 v[44:47], v[136:139], v[172:175], v[44:47]
    ds_read_b64_tr_b16 v[108:109], v6 offset:22528
    v_mfma_f32_16x16x32_bf16 v[48:51], v[140:143], v[168:171], v[48:51]
    ds_read_b64_tr_b16 v[110:111], v7 offset:22528
    v_mfma_f32_16x16x32_bf16 v[52:55], v[140:143], v[172:175], v[52:55]
    ds_read_b64_tr_b16 v[112:113], v4 offset:24576
    v_mfma_f32_16x16x32_bf16 v[56:59], v[144:147], v[168:171], v[56:59]
    ds_read_b64_tr_b16 v[114:115], v5 offset:24576
    v_mfma_f32_16x16x32_bf16 v[60:63], v[144:147], v[172:175], v[60:63]
    s_add_u32 m0, s40, 9216
    s_mov_b64 exec, 0xffff
    buffer_load_dwordx4 v2, s[20:23], s46 offen sc1 lds
    s_mov_b64 exec, -1
    s_add_u32 s46, s46, 9216
    v_mfma_f32_16x16x32_bf16 v[64:67], v[148:151], v[168:171], v[64:67]
    ds_read_b64_tr_b16 v[116:117], v6 offset:24576
    v_mfma_f32_16x16x32_bf16 v[68:71], v[148:151], v[172:175], v[68:71]
    ds_read_b64_tr_b16 v[118:119], v7 offset:24576
    v_mfma_f32_16x16x32_bf16 v[72:75], v[152:155], v[168:171], v[72:75]
    ds_read_b64_tr_b16 v[120:121], v8 offset:18432
    v_mfma_f32_16x16x32_bf16 v[76:79], v[152:155], v[172:175], v[76:79]
    ds_read_b64_tr_b16 v[122:123], v9 offset:18432
    v_mfma_f32_16x16x32_bf16 v[80:83], v[156:159], v[168:171], v[80:83]
    v_mfma_f32_16x16x32_bf16 v[84:87], v[156:159], v[172:175], v[84:87]
    s_waitcnt vmcnt(10) lgkmcnt(0)
    s_barrier
    ds_read_b64_tr_b16 v[124:125], v4 offset:27648
    ds_read_b64_tr_b16 v[126:127], v5 offset:27648
    ds_read_b64_tr_b16 v[128:129], v6 offset:27648
    ds_read_b64_tr_b16 v[130:131], v7 offset:27648
    v_mfma_f32_16x16x32_bf16 v[16:19], v[88:91], v[176:179], v[16:19]
    ds_read_b64_tr_b16 v[132:133], v4 offset:29696
    ds_read_b64_tr_b16 v[134:135], v5 offset:29696
    v_mfma_f32_16x16x32_bf16 v[20:23], v[88:91], v[180:183], v[20:23]
    s_add_u32 m0, s38, 4096
    s_nop 0
    buffer_load_dwordx4 v10, s[12:15], s42 offen lds
    v_mfma_f32_16x16x32_bf16 v[24:27], v[92:95], v[176:179], v[24:27]
    ds_read_b64_tr_b16 v[136:137], v6 offset:29696
    ds_read_b64_tr_b16 v[138:139], v7 offset:29696
    v_mfma_f32_16x16x32_bf16 v[28:31], v[92:95], v[180:183], v[28:31]
    buffer_load_dwordx4 v11, s[12:15], s42 offen offset:1024 lds
    s_add_u32 s42, s42, 128
    v_mfma_f32_16x16x32_bf16 v[32:35], v[96:99], v[176:179], v[32:35]
    ds_read_b64_tr_b16 v[140:141], v4 offset:31744
    ds_read_b64_tr_b16 v[142:143], v5 offset:31744
    v_mfma_f32_16x16x32_bf16 v[36:39], v[96:99], v[180:183], v[36:39]
    ds_read_b64_tr_b16 v[144:145], v6 offset:31744
    ds_read_b64_tr_b16 v[146:147], v7 offset:31744
    v_mfma_f32_16x16x32_bf16 v[40:43], v[100:103], v[176:179], v[40:43]
    s_add_u32 m0, s38, 4096
    s_nop 0
    buffer_load_dwordx4 v10, s[12:15], s41 offen offset:2048 lds
    v_mfma_f32_16x16x32_bf16 v[44:47], v[100:103], v[180:183], v[44:47]
    ds_read_b64_tr_b16 v[148:149], v4 offset:33792
    v_mfma_f32_16x16x32_bf16 v[48:51], v[104:107], v[176:179], v[48:51]
    buffer_load_dwordx4 v11, s[12:15], s41 offen offset:3072 lds
    s_add_u32 s41, s41, 128
    v_mfma_f32_16x16x32_bf16 v[52:55], v[104:107], v[180:183], v[52:55]
    ds_read_b64_tr_b16 v[150:151], v5 offset:33792
    v_mfma_f32_16x16x32_bf16 v[56:59], v[108:111], v[176:179], v[56:59]
    ds_read_b64_tr_b16 v[152:153], v6 offset:33792
    v_mfma_f32_16x16x32_bf16 v[60:63], v[108:111], v[180:183], v[60:63]
    s_add_u32 m0, s39, 18432
    s_nop 0
    buffer_load_dwordx4 v2, s[20:23], s43 offen sc1 lds
    v_mfma_f32_16x16x32_bf16 v[64:67], v[112:115], v[176:179], v[64:67]
    ds_read_b64_tr_b16 v[154:155], v7 offset:33792
    v_mfma_f32_16x16x32_bf16 v[68:71], v[112:115], v[180:183], v[68:71]
    buffer_load_dwordx4 v2, s[20:23], s43 offen offset:1024 sc1 lds
    s_add_u32 s43, s43, 9216
    v_mfma_f32_16x16x32_bf16 v[72:75], v[116:119], v[176:179], v[72:75]
    ds_read_b64_tr_b16 v[156:157], v8 offset:27648
    v_mfma_f32_16x16x32_bf16 v[76:79], v[116:119], v[180:183], v[76:79]
    ds_read_b64_tr_b16 v[158:159], v9 offset:27648
    v_mfma_f32_16x16x32_bf16 v[80:83], v[120:123], v[176:179], v[80:83]
    s_add_u32 m0, s40, 18432
    s_mov_b64 exec, 0xffff
    buffer_load_dwordx4 v2, s[20:23], s46 offen sc1 lds
    s_mov_b64 exec, -1
    s_add_u32 s46, s46, 9216
    v_mfma_f32_16x16x32_bf16 v[84:87], v[120:123], v[180:183], v[84:87]
    s_waitcnt vmcnt(10) lgkmcnt(0)
    s_barrier
    ds_read_b128 v[160:163], v3 offset:0
    ds_read_b128 v[164:167], v3 offset:2048
    ds_read_b128 v[168:171], v14 offset:0
    ds_read_b128 v[172:175], v14 offset:2048
    v_mfma_f32_16x16x32_bf16 v[16:19], v[124:127], v[184:187], v[16:19]
    ds_read_b64_tr_b16 v[88:89], v4 offset:0
    ds_read_b64_tr_b16 v[90:91], v5 offset:0
    v_mfma_f32_16x16x32_bf16 v[20:23], v[124:127], v[188:191], v[20:23]
    s_add_u32 m0, s39, 27648
    s_nop 0
    buffer_load_dwordx4 v2, s[20:23], s43 offen sc1 lds
    v_mfma_f32_16x16x32_bf16 v[24:27], v[128:131], v[184:187], v[24:27]
    ds_read_b64_tr_b16 v[92:93], v6 offset:0
    ds_read_b64_tr_b16 v[94:95], v7 offset:0
    v_mfma_f32_16x16x32_bf16 v[28:31], v[128:131], v[188:191], v[28:31]
    ds_read_b64_tr_b16 v[96:97], v4 offset:2048
    ds_read_b64_tr_b16 v[98:99], v5 offset:2048
    v_mfma_f32_16x16x32_bf16 v[32:35], v[132:135], v[184:187], v[32:35]
    ds_read_b64_tr_b16 v[100:101], v6 offset:2048
    ds_read_b64_tr_b16 v[102:103], v7 offset:2048
    v_mfma_f32_16x16x32_bf16 v[36:39], v[132:135], v[188:191], v[36:39]
    ds_read_b64_tr_b16 v[104:105], v4 offset:4096
    ds_read_b64_tr_b16 v[106:107], v5 offset:4096
    v_mfma_f32_16x16x32_bf16 v[40:43], v[136:139], v[184:187], v[40:43]
    buffer_load_dwordx4 v2, s[20:23], s43 offen offset:1024 sc1 lds
    s_add_u32 s43, s43, 9216
    v_mfma_f32_16x16x32_bf16 v[44:47], v[136:139], v[188:191], v[44:47]
    ds_read_b64_tr_b16 v[108:109], v6 offset:4096
    v_mfma_f32_16x16x32_bf16 v[48:51], v[140:143], v[184:187], v[48:51]
    ds_read_b64_tr_b16 v[110:111], v7 offset:4096
    v_mfma_f32_16x16x32_bf16 v[52:55], v[140:143], v[188:191], v[52:55]
    ds_read_b64_tr_b16 v[112:113], v4 offset:6144
    v_mfma_f32_16x16x32_bf16 v[56:59], v[144:147], v[184:187], v[56:59]
    ds_read_b64_tr_b16 v[114:115], v5 offset:6144
    v_mfma_f32_16x16x32_bf16 v[60:63], v[144:147], v[188:191], v[60:63]
    s_add_u32 m0, s40, 27648
    s_mov_b64 exec, 0xffff
    buffer_load_dwordx4 v2, s[20:23], s46 offen sc1 lds
    s_mov_b64 exec, -1
    s_add_u32 s46, s46, 9216
    v_mfma_f32_16x16x32_bf16 v[64:67], v[148:151], v[184:187], v[64:67]
    ds_read_b64_tr_b16 v[116:117], v6 offset:6144
    v_mfma_f32_16x16x32_bf16 v[68:71], v[148:151], v[188:191], v[68:71]
    ds_read_b64_tr_b16 v[118:119], v7 offset:6144
    v_mfma_f32_16x16x32_bf16 v[72:75], v[152:155], v[184:187], v[72:75]
    ds_read_b64_tr_b16 v[120:121], v8 offset:0
    v_mfma_f32_16x16x32_bf16 v[76:79], v[152:155], v[188:191], v[76:79]
    ds_read_b64_tr_b16 v[122:123], v9 offset:0
    v_mfma_f32_16x16x32_bf16 v[80:83], v[156:159], v[184:187], v[80:83]
    v_mfma_f32_16x16x32_bf16 v[84:87], v[156:159], v[188:191], v[84:87]
    v_readfirstlane_b32 s54, v239
    s_nop 1
    s_cmp_lg_u32 s54, 0
    s_cbranch_scc1 G2Z1_OK
    s_mov_b32 s47, 0
    buffer_load_dword v239, v238, s[20:23], s53 offen sc1
G2Z1_P:
    s_waitcnt vmcnt(0)
    v_cmp_eq_u32 vcc, 0, v239
    s_nop 1
    s_cmp_eq_u64 vcc, 0
    s_cbranch_scc1 G2Z1_OK
    s_add_u32 s47, s47, 1
    s_cmp_ge_u32 s47, 0x40000
    s_cbranch_scc1 G2Z1_OK
    s_sleep 6
    buffer_load_dword v239, v238, s[20:23], s53 offen sc1
    s_branch G2Z1_P
G2Z1_OK:
    s_waitcnt vmcnt(10) lgkmcnt(0)
    s_barrier
    ds_read_b64_tr_b16 v[124:125], v4 offset:9216
    ds_read_b64_tr_b16 v[126:127], v5 offset:9216
    ds_read_b64_tr_b16 v[128:129], v6 offset:9216
    ds_read_b64_tr_b16 v[130:131], v7 offset:9216
    v_mfma_f32_16x16x32_bf16 v[16:19], v[88:91], v[160:163], v[16:19]
    ds_read_b64_tr_b16 v[132:133], v4 offset:11264
    ds_read_b64_tr_b16 v[134:135], v5 offset:11264
    v_mfma_f32_16x16x32_bf16 v[20:23], v[88:91], v[164:167], v[20:23]
    ds_read_b64_tr_b16 v[136:137], v6 offset:11264
    ds_read_b64_tr_b16 v[138:139], v7 offset:11264
    v_mfma_f32_16x16x32_bf16 v[24:27], v[92:95], v[160:163], v[24:27]
    ds_read_b64_tr_b16 v[140:141], v4 offset:13312
    ds_read_b64_tr_b16 v[142:143], v5 offset:13312
    v_mfma_f32_16x16x32_bf16 v[28:31], v[92:95], v[164:167], v[28:31]
    ds_read_b64_tr_b16 v[144:145], v6 offset:13312
    ds_read_b64_tr_b16 v[146:147], v7 offset:13312
    v_mfma_f32_16x16x32_bf16 v[32:35], v[96:99], v[160:163], v[32:35]
    ds_read_b64_tr_b16 v[148:149], v4 offset:15360
    ds_read_b64_tr_b16 v[150:151], v5 offset:15360
    v_mfma_f32_16x16x32_bf16 v[36:39], v[96:99], v[164:167], v[36:39]
    ds_read_b64_tr_b16 v[152:153], v6 offset:15360
    ds_read_b64_tr_b16 v[154:155], v7 offset:15360
    v_mfma_f32_16x16x32_bf16 v[40:43], v[100:103], v[160:163], v[40:43]
    ds_read_b64_tr_b16 v[156:157], v8 offset:9216
    v_mfma_f32_16x16x32_bf16 v[44:47], v[100:103], v[164:167], v[44:47]
    ds_read_b64_tr_b16 v[158:159], v9 offset:9216
    v_mfma_f32_16x16x32_bf16 v[48:51], v[104:107], v[160:163], v[48:51]
    v_mfma_f32_16x16x32_bf16 v[52:55], v[104:107], v[164:167], v[52:55]
    v_mfma_f32_16x16x32_bf16 v[56:59], v[108:111], v[160:163], v[56:59]
    v_mfma_f32_16x16x32_bf16 v[60:63], v[108:111], v[164:167], v[60:63]
    v_mfma_f32_16x16x32_bf16 v[64:67], v[112:115], v[160:163], v[64:67]
    v_mfma_f32_16x16x32_bf16 v[68:71], v[112:115], v[164:167], v[68:71]
    v_mfma_f32_16x16x32_bf16 v[72:75], v[116:119], v[160:163], v[72:75]
    v_mfma_f32_16x16x32_bf16 v[76:79], v[116:119], v[164:167], v[76:79]
    v_mfma_f32_16x16x32_bf16 v[80:83], v[120:123], v[160:163], v[80:83]
    v_mfma_f32_16x16x32_bf16 v[84:87], v[120:123], v[164:167], v[84:87]
    buffer_load_dwordx4 v[192:195], v12, s[20:23], s48 offen offset:0 sc1
    buffer_load_dwordx4 v[196:199], v12, s[20:23], s48 offen offset:256 sc1
    buffer_load_dwordx4 v[200:203], v12, s[20:23], s48 offen offset:2048 sc1
    buffer_load_dwordx4 v[204:207], v12, s[20:23], s48 offen offset:2304 sc1
    buffer_load_dwordx4 v[208:211], v12, s[20:23], s49 offen offset:0 sc1
    buffer_load_dwordx4 v[212:215], v12, s[20:23], s49 offen offset:256 sc1
    buffer_load_dwordx4 v[216:219], v12, s[20:23], s49 offen offset:2048 sc1
    buffer_load_dwordx4 v[220:223], v12, s[20:23], s49 offen offset:2304 sc1
    buffer_load_dwordx2 v[224:225], v13, s[20:23], s50 offen offset:0 sc1
    buffer_load_dwordx2 v[226:227], v13, s[20:23], s50 offen offset:256 sc1
    buffer_load_ushort v246, v249, s[16:19], s44 offen
    buffer_load_ushort v247, v249, s[16:19], s44 offen offset:32
    s_waitcnt vmcnt(15) lgkmcnt(0)
    s_barrier
    ds_read_b128 v[176:179], v3 offset:4096
    ds_read_b128 v[180:183], v3 offset:6144
    ds_read_b128 v[184:187], v14 offset:4096
    ds_read_b128 v[188:191], v14 offset:6144
    v_mfma_f32_16x16x32_bf16 v[16:19], v[124:127], v[168:171], v[16:19]
    ds_read_b64_tr_b16 v[88:89], v4 offset:18432
    ds_read_b64_tr_b16 v[90:91], v5 offset:18432
    v_mfma_f32_16x16x32_bf16 v[20:23], v[124:127], v[172:175], v[20:23]
    ds_read_b64_tr_b16 v[92:93], v6 offset:18432
    ds_read_b64_tr_b16 v[94:95], v7 offset:18432
    v_mfma_f32_16x16x32_bf16 v[24:27], v[128:131], v[168:171], v[24:27]
    ds_read_b64_tr_b16 v[96:97], v4 offset:20480
    ds_read_b64_tr_b16 v[98:99], v5 offset:20480
    v_mfma_f32_16x16x32_bf16 v[28:31], v[128:131], v[172:175], v[28:31]
    ds_read_b64_tr_b16 v[100:101], v6 offset:20480
    ds_read_b64_tr_b16 v[102:103], v7 offset:20480
    v_mfma_f32_16x16x32_bf16 v[32:35], v[132:135], v[168:171], v[32:35]
    ds_read_b64_tr_b16 v[104:105], v4 offset:22528
    ds_read_b64_tr_b16 v[106:107], v5 offset:22528
    v_mfma_f32_16x16x32_bf16 v[36:39], v[132:135], v[172:175], v[36:39]
    ds_read_b64_tr_b16 v[108:109], v6 offset:22528
    ds_read_b64_tr_b16 v[110:111], v7 offset:22528
    v_mfma_f32_16x16x32_bf16 v[40:43], v[136:139], v[168:171], v[40:43]
    ds_read_b64_tr_b16 v[112:113], v4 offset:24576
    v_mfma_f32_16x16x32_bf16 v[44:47], v[136:139], v[172:175], v[44:47]
    ds_read_b64_tr_b16 v[114:115], v5 offset:24576
    v_mfma_f32_16x16x32_bf16 v[48:51], v[140:143], v[168:171], v[48:51]
    ds_read_b64_tr_b16 v[116:117], v6 offset:24576
    v_mfma_f32_16x16x32_bf16 v[52:55], v[140:143], v[172:175], v[52:55]
    ds_read_b64_tr_b16 v[118:119], v7 offset:24576
    v_mfma_f32_16x16x32_bf16 v[56:59], v[144:147], v[168:171], v[56:59]
    ds_read_b64_tr_b16 v[120:121], v8 offset:18432
    v_mfma_f32_16x16x32_bf16 v[60:63], v[144:147], v[172:175], v[60:63]
    ds_read_b64_tr_b16 v[122:123], v9 offset:18432
    v_mfma_f32_16x16x32_bf16 v[64:67], v[148:151], v[168:171], v[64:67]
    v_mfma_f32_16x16x32_bf16 v[68:71], v[148:151], v[172:175], v[68:71]
    v_mfma_f32_16x16x32_bf16 v[72:75], v[152:155], v[168:171], v[72:75]
    v_mfma_f32_16x16x32_bf16 v[76:79], v[152:155], v[172:175], v[76:79]
    v_mfma_f32_16x16x32_bf16 v[80:83], v[156:159], v[168:171], v[80:83]
    v_mfma_f32_16x16x32_bf16 v[84:87], v[156:159], v[172:175], v[84:87]
    s_waitcnt vmcnt(12) lgkmcnt(0)
    s_barrier
    ds_read_b64_tr_b16 v[124:125], v4 offset:27648
    ds_read_b64_tr_b16 v[126:127], v5 offset:27648
    ds_read_b64_tr_b16 v[128:129], v6 offset:27648
    ds_read_b64_tr_b16 v[130:131], v7 offset:27648
    v_mfma_f32_16x16x32_bf16 v[16:19], v[88:91], v[176:179], v[16:19]
    ds_read_b64_tr_b16 v[132:133], v4 offset:29696
    ds_read_b64_tr_b16 v[134:135], v5 offset:29696
    v_mfma_f32_16x16x32_bf16 v[20:23], v[88:91], v[180:183], v[20:23]
    ds_read_b64_tr_b16 v[136:137], v6 offset:29696
    ds_read_b64_tr_b16 v[138:139], v7 offset:29696
    v_mfma_f32_16x16x32_bf16 v[24:27], v[92:95], v[176:179], v[24:27]
    ds_read_b64_tr_b16 v[140:141], v4 offset:31744
    ds_read_b64_tr_b16 v[142:143], v5 offset:31744
    v_mfma_f32_16x16x32_bf16 v[28:31], v[92:95], v[180:183], v[28:31]
    ds_read_b64_tr_b16 v[144:145], v6 offset:31744
    ds_read_b64_tr_b16 v[146:147], v7 offset:31744
    v_mfma_f32_16x16x32_bf16 v[32:35], v[96:99], v[176:179], v[32:35]
    ds_read_b64_tr_b16 v[148:149], v4 offset:33792
    ds_read_b64_tr_b16 v[150:151], v5 offset:33792
    v_mfma_f32_16x16x32_bf16 v[36:39], v[96:99], v[180:183], v[36:39]
    ds_read_b64_tr_b16 v[152:153], v6 offset:33792
    ds_read_b64_tr_b16 v[154:155], v7 offset:33792
    v_mfma_f32_16x16x32_bf16 v[40:43], v[100:103], v[176:179], v[40:43]
    ds_read_b64_tr_b16 v[156:157], v8 offset:27648
    v_mfma_f32_16x16x32_bf16 v[44:47], v[100:103], v[180:183], v[44:47]
    ds_read_b64_tr_b16 v[158:159], v9 offset:27648
    v_mfma_f32_16x16x32_bf16 v[48:51], v[104:107], v[176:179], v[48:51]
    v_mfma_f32_16x16x32_bf16 v[52:55], v[104:107], v[180:183], v[52:55]
    v_mfma_f32_16x16x32_bf16 v[56:59], v[108:111], v[176:179], v[56:59]
    v_mfma_f32_16x16x32_bf16 v[60:63], v[108:111], v[180:183], v[60:63]
    v_mfma_f32_16x16x32_bf16 v[64:67], v[112:115], v[176:179], v[64:67]
    v_mfma_f32_16x16x32_bf16 v[68:71], v[112:115], v[180:183], v[68:71]
    v_mfma_f32_16x16x32_bf16 v[72:75], v[116:119], v[176:179], v[72:75]
    v_mfma_f32_16x16x32_bf16 v[76:79], v[116:119], v[180:183], v[76:79]
    v_mfma_f32_16x16x32_bf16 v[80:83], v[120:123], v[176:179], v[80:83]
    v_mfma_f32_16x16x32_bf16 v[84:87], v[120:123], v[180:183], v[84:87]
    s_waitcnt vmcnt(12) lgkmcnt(0)
    s_barrier
    v_mfma_f32_16x16x32_bf16 v[16:19], v[124:127], v[184:187], v[16:19]
    v_mfma_f32_16x16x32_bf16 v[20:23], v[124:127], v[188:191], v[20:23]
    v_mfma_f32_16x16x32_bf16 v[24:27], v[128:131], v[184:187], v[24:27]
    v_mfma_f32_16x16x32_bf16 v[28:31], v[128:131], v[188:191], v[28:31]
    v_mfma_f32_16x16x32_bf16 v[32:35], v[132:135], v[184:187], v[32:35]
    v_mfma_f32_16x16x32_bf16 v[36:39], v[132:135], v[188:191], v[36:39]
    v_mfma_f32_16x16x32_bf16 v[40:43], v[136:139], v[184:187], v[40:43]
    v_mfma_f32_16x16x32_bf16 v[44:47], v[136:139], v[188:191], v[44:47]
    v_mfma_f32_16x16x32_bf16 v[48:51], v[140:143], v[184:187], v[48:51]
    v_mfma_f32_16x16x32_bf16 v[52:55], v[140:143], v[188:191], v[52:55]
    v_mfma_f32_16x16x32_bf16 v[56:59], v[144:147], v[184:187], v[56:59]
    v_mfma_f32_16x16x32_bf16 v[60:63], v[144:147], v[188:191], v[60:63]
    v_mfma_f32_16x16x32_bf16 v[64:67], v[148:151], v[184:187], v[64:67]
    v_mfma_f32_16x16x32_bf16 v[68:71], v[148:151], v[188:191], v[68:71]
    v_mfma_f32_16x16x32_bf16 v[72:75], v[152:155], v[184:187], v[72:75]
    v_mfma_f32_16x16x32_bf16 v[76:79], v[152:155], v[188:191], v[76:79]
    v_mfma_f32_16x16x32_bf16 v[80:83], v[156:159], v[184:187], v[80:83]
    v_mfma_f32_16x16x32_bf16 v[84:87], v[156:159], v[188:191], v[84:87]
    s_setprio 3
    s_waitcnt vmcnt(0)
    v_lshlrev_b32 v246, 16, v246
    v_lshlrev_b32 v247, 16, v247
    v_add_f32 v16, v16, v246
    v_add_f32 v17, v17, v246
    v_add_f32 v18, v18, v246
    v_add_f32 v19, v19, v246
    v_add_f32 v24, v24, v246
    v_add_f32 v25, v25, v246
    v_add_f32 v26, v26, v246
    v_add_f32 v27, v27, v246
    v_lshlrev_b32 v230, 16, v192
    v_and_b32 v231, 0xffff0000, v192
    v_lshlrev_b32 v232, 16, v193
    v_and_b32 v233, 0xffff0000, v193
    v_lshlrev_b32 v234, 16, v194
    v_and_b32 v235, 0xffff0000, v194
    v_lshlrev_b32 v236, 16, v195
    v_and_b32 v237, 0xffff0000, v195
    v_mul_f32 v16, v16, v230
    v_mul_f32 v17, v17, v231
    v_mul_f32 v18, v18, v232
    v_mul_f32 v19, v19, v233
    v_mul_f32 v24, v24, v234
    v_mul_f32 v25, v25, v235
    v_mul_f32 v26, v26, v236
    v_mul_f32 v27, v27, v237
    v_cvt_pk_bf16_f32 v192, v16, v17
    v_cvt_pk_bf16_f32 v193, v18, v19
    v_cvt_pk_bf16_f32 v194, v24, v25
    v_cvt_pk_bf16_f32 v195, v26, v27
    buffer_store_dwordx4 v[192:195], v12, s[20:23], s48 offen offset:0 sc1
    v_add_f32 v20, v20, v247
    v_add_f32 v21, v21, v247
    v_add_f32 v22, v22, v247
    v_add_f32 v23, v23, v247
    v_add_f32 v28, v28, v247
    v_add_f32 v29, v29, v247
    v_add_f32 v30, v30, v247
    v_add_f32 v31, v31, v247
    v_lshlrev_b32 v230, 16, v196
    v_and_b32 v231, 0xffff0000, v196
    v_lshlrev_b32 v232, 16, v197
    v_and_b32 v233, 0xffff0000, v197
    v_lshlrev_b32 v234, 16, v198
    v_and_b32 v235, 0xffff0000, v198
    v_lshlrev_b32 v236, 16, v199
    v_and_b32 v237, 0xffff0000, v199
    v_mul_f32 v20, v20, v230
    v_mul_f32 v21, v21, v231
    v_mul_f32 v22, v22, v232
    v_mul_f32 v23, v23, v233
    v_mul_f32 v28, v28, v234
    v_mul_f32 v29, v29, v235
    v_mul_f32 v30, v30, v236
    v_mul_f32 v31, v31, v237
    v_cvt_pk_bf16_f32 v196, v20, v21
    v_cvt_pk_bf16_f32 v197, v22, v23
    v_cvt_pk_bf16_f32 v198, v28, v29
    v_cvt_pk_bf16_f32 v199, v30, v31
    buffer_store_dwordx4 v[196:199], v12, s[20:23], s48 offen offset:256 sc1
    v_add_f32 v32, v32, v246
    v_add_f32 v33, v33, v246
    v_add_f32 v34, v34, v246
    v_add_f32 v35, v35, v246
    v_add_f32 v40, v40, v246
    v_add_f32 v41, v41, v246
    v_add_f32 v42, v42, v246
    v_add_f32 v43, v43, v246
    v_lshlrev_b32 v230, 16, v200
    v_and_b32 v231, 0xffff0000, v200
    v_lshlrev_b32 v232, 16, v201
    v_and_b32 v233, 0xffff0000, v201
    v_lshlrev_b32 v234, 16, v202
    v_and_b32 v235, 0xffff0000, v202
    v_lshlrev_b32 v236, 16, v203
    v_and_b32 v237, 0xffff0000, v203
    v_mul_f32 v32, v32, v230
    v_mul_f32 v33, v33, v231
    v_mul_f32 v34, v34, v232
    v_mul_f32 v35, v35, v233
    v_mul_f32 v40, v40, v234
    v_mul_f32 v41, v41, v235
    v_mul_f32 v42, v42, v236
    v_mul_f32 v43, v43, v237
    v_cvt_pk_bf16_f32 v200, v32, v33
    v_cvt_pk_bf16_f32 v201, v34, v35
    v_cvt_pk_bf16_f32 v202, v40, v41
    v_cvt_pk_bf16_f32 v203, v42, v43
    buffer_store_dwordx4 v[200:203], v12, s[20:23], s48 offen offset:2048 sc1
    v_add_f32 v36, v36, v247
    v_add_f32 v37, v37, v247
    v_add_f32 v38, v38, v247
    v_add_f32 v39, v39, v247
    v_add_f32 v44, v44, v247
    v_add_f32 v45, v45, v247
    v_add_f32 v46, v46, v247
    v_add_f32 v47, v47, v247
    v_lshlrev_b32 v230, 16, v204
    v_and_b32 v231, 0xffff0000, v204
    v_lshlrev_b32 v232, 16, v205
    v_and_b32 v233, 0xffff0000, v205
    v_lshlrev_b32 v234, 16, v206
    v_and_b32 v235, 0xffff0000, v206
    v_lshlrev_b32 v236, 16, v207
    v_and_b32 v237, 0xffff0000, v207
    v_mul_f32 v36, v36, v230
    v_mul_f32 v37, v37, v231
    v_mul_f32 v38, v38, v232
    v_mul_f32 v39, v39, v233
    v_mul_f32 v44, v44, v234
    v_mul_f32 v45, v45, v235
    v_mul_f32 v46, v46, v236
    v_mul_f32 v47, v47, v237
    v_cvt_pk_bf16_f32 v204, v36, v37
    v_cvt_pk_bf16_f32 v205, v38, v39
    v_cvt_pk_bf16_f32 v206, v44, v45
    v_cvt_pk_bf16_f32 v207, v46, v47
    buffer_store_dwordx4 v[204:207], v12, s[20:23], s48 offen offset:2304 sc1
    v_add_f32 v48, v48, v246
    v_add_f32 v49, v49, v246
    v_add_f32 v50, v50, v246
    v_add_f32 v51, v51, v246
    v_add_f32 v56, v56, v246
    v_add_f32 v57, v57, v246
    v_add_f32 v58, v58, v246
    v_add_f32 v59, v59, v246
    v_lshlrev_b32 v230, 16, v208
    v_and_b32 v231, 0xffff0000, v208
    v_lshlrev_b32 v232, 16, v209
    v_and_b32 v233, 0xffff0000, v209
    v_lshlrev_b32 v234, 16, v210
    v_and_b32 v235, 0xffff0000, v210
    v_lshlrev_b32 v236, 16, v211
    v_and_b32 v237, 0xffff0000, v211
    v_mul_f32 v48, v48, v230
    v_mul_f32 v49, v49, v231
    v_mul_f32 v50, v50, v232
    v_mul_f32 v51, v51, v233
    v_mul_f32 v56, v56, v234
    v_mul_f32 v57, v57, v235
    v_mul_f32 v58, v58, v236
    v_mul_f32 v59, v59, v237
    v_cvt_pk_bf16_f32 v208, v48, v49
    v_cvt_pk_bf16_f32 v209, v50, v51
    v_cvt_pk_bf16_f32 v210, v56, v57
    v_cvt_pk_bf16_f32 v211, v58, v59
    buffer_store_dwordx4 v[208:211], v12, s[20:23], s49 offen offset:0 sc1
    v_add_f32 v52, v52, v247
    v_add_f32 v53, v53, v247
    v_add_f32 v54, v54, v247
    v_add_f32 v55, v55, v247
    v_add_f32 v60, v60, v247
    v_add_f32 v61, v61, v247
    v_add_f32 v62, v62, v247
    v_add_f32 v63, v63, v247
    v_lshlrev_b32 v230, 16, v212
    v_and_b32 v231, 0xffff0000, v212
    v_lshlrev_b32 v232, 16, v213
    v_and_b32 v233, 0xffff0000, v213
    v_lshlrev_b32 v234, 16, v214
    v_and_b32 v235, 0xffff0000, v214
    v_lshlrev_b32 v236, 16, v215
    v_and_b32 v237, 0xffff0000, v215
    v_mul_f32 v52, v52, v230
    v_mul_f32 v53, v53, v231
    v_mul_f32 v54, v54, v232
    v_mul_f32 v55, v55, v233
    v_mul_f32 v60, v60, v234
    v_mul_f32 v61, v61, v235
    v_mul_f32 v62, v62, v236
    v_mul_f32 v63, v63, v237
    v_cvt_pk_bf16_f32 v212, v52, v53
    v_cvt_pk_bf16_f32 v213, v54, v55
    v_cvt_pk_bf16_f32 v214, v60, v61
    v_cvt_pk_bf16_f32 v215, v62, v63
    buffer_store_dwordx4 v[212:215], v12, s[20:23], s49 offen offset:256 sc1
    v_add_f32 v64, v64, v246
    v_add_f32 v65, v65, v246
    v_add_f32 v66, v66, v246
    v_add_f32 v67, v67, v246
    v_add_f32 v72, v72, v246
    v_add_f32 v73, v73, v246
    v_add_f32 v74, v74, v246
    v_add_f32 v75, v75, v246
    v_lshlrev_b32 v230, 16, v216
    v_and_b32 v231, 0xffff0000, v216
    v_lshlrev_b32 v232, 16, v217
    v_and_b32 v233, 0xffff0000, v217
    v_lshlrev_b32 v234, 16, v218
    v_and_b32 v235, 0xffff0000, v218
    v_lshlrev_b32 v236, 16, v219
    v_and_b32 v237, 0xffff0000, v219
    v_mul_f32 v64, v64, v230
    v_mul_f32 v65, v65, v231
    v_mul_f32 v66, v66, v232
    v_mul_f32 v67, v67, v233
    v_mul_f32 v72, v72, v234
    v_mul_f32 v73, v73, v235
    v_mul_f32 v74, v74, v236
    v_mul_f32 v75, v75, v237
    v_cvt_pk_bf16_f32 v216, v64, v65
    v_cvt_pk_bf16_f32 v217, v66, v67
    v_cvt_pk_bf16_f32 v218, v72, v73
    v_cvt_pk_bf16_f32 v219, v74, v75
    buffer_store_dwordx4 v[216:219], v12, s[20:23], s49 offen offset:2048 sc1
    v_add_f32 v68, v68, v247
    v_add_f32 v69, v69, v247
    v_add_f32 v70, v70, v247
    v_add_f32 v71, v71, v247
    v_add_f32 v76, v76, v247
    v_add_f32 v77, v77, v247
    v_add_f32 v78, v78, v247
    v_add_f32 v79, v79, v247
    v_lshlrev_b32 v230, 16, v220
    v_and_b32 v231, 0xffff0000, v220
    v_lshlrev_b32 v232, 16, v221
    v_and_b32 v233, 0xffff0000, v221
    v_lshlrev_b32 v234, 16, v222
    v_and_b32 v235, 0xffff0000, v222
    v_lshlrev_b32 v236, 16, v223
    v_and_b32 v237, 0xffff0000, v223
    v_mul_f32 v68, v68, v230
    v_mul_f32 v69, v69, v231
    v_mul_f32 v70, v70, v232
    v_mul_f32 v71, v71, v233
    v_mul_f32 v76, v76, v234
    v_mul_f32 v77, v77, v235
    v_mul_f32 v78, v78, v236
    v_mul_f32 v79, v79, v237
    v_cvt_pk_bf16_f32 v220, v68, v69
    v_cvt_pk_bf16_f32 v221, v70, v71
    v_cvt_pk_bf16_f32 v222, v76, v77
    v_cvt_pk_bf16_f32 v223, v78, v79
    buffer_store_dwordx4 v[220:223], v12, s[20:23], s49 offen offset:2304 sc1
    v_add_f32 v80, v80, v246
    v_add_f32 v81, v81, v246
    v_add_f32 v82, v82, v246
    v_add_f32 v83, v83, v246
    v_lshlrev_b32 v230, 16, v224
    v_and_b32 v231, 0xffff0000, v224
    v_lshlrev_b32 v232, 16, v225
    v_and_b32 v233, 0xffff0000, v225
    v_mul_f32 v80, v80, v230
    v_mul_f32 v81, v81, v231
    v_mul_f32 v82, v82, v232
    v_mul_f32 v83, v83, v233
    v_cvt_pk_bf16_f32 v224, v80, v81
    v_cvt_pk_bf16_f32 v225, v82, v83
    buffer_store_dwordx2 v[224:225], v13, s[20:23], s50 offen offset:0 sc1
    v_add_f32 v84, v84, v247
    v_add_f32 v85, v85, v247
    v_add_f32 v86, v86, v247
    v_add_f32 v87, v87, v247
    v_lshlrev_b32 v230, 16, v226
    v_and_b32 v231, 0xffff0000, v226
    v_lshlrev_b32 v232, 16, v227
    v_and_b32 v233, 0xffff0000, v227
    v_mul_f32 v84, v84, v230
    v_mul_f32 v85, v85, v231
    v_mul_f32 v86, v86, v232
    v_mul_f32 v87, v87, v233
    v_cvt_pk_bf16_f32 v226, v84, v85
    v_cvt_pk_bf16_f32 v227, v86, v87
    buffer_store_dwordx2 v[226:227], v13, s[20:23], s50 offen offset:256 sc1
    s_waitcnt vmcnt(0)
    s_barrier
    s_cmp_lg_u32 s32, 0
    s_cbranch_scc1 K2_NOSIG
    s_lshl_b32 s30, s30, 7
    s_lshl_b32 s31, s31, 2
    s_add_u32 s30, s30, s31
    s_add_u32 s30, s30, 12599296
    v_mov_b32 v1, 0
    v_mov_b32 v2, 1
    s_mov_b64 exec, 1
    buffer_store_dword v2, v1, s[20:23], s30 offen sc1
    s_mov_b64 exec, -1
K2_NOSIG:
    s_load_dwordx2 s[4:5], s[0:1], 0
    s_load_dwordx2 s[24:25], s[0:1], 64
    s_load_dwordx2 s[6:7], s[0:1], 16
    s_waitcnt lgkmcnt(0)
    s_mov_b32 s16, s6
    s_and_b32 s17, s7, 0xffff
    s_mov_b32 s18, 663552
    s_mov_b32 s19, 0x00020000
    s_mov_b32 s12, s4
    s_and_b32 s13, s5, 0xffff
    s_mov_b32 s14, 2359296
    s_mov_b32 s15, 0x00020000
    s_mov_b32 s4, s24
    s_and_b32 s5, s25, 0xffff
    s_mov_b32 s6, 2359296
    s_mov_b32 s7, 0x00020000
    s_and_b32 s36, s3, 7
    s_lshr_b32 s37, s3, 3
    s_cmp_ge_u32 s37, 30
    s_cbranch_scc1 K2_END
    s_mul_i32 s36, s36, 30
    s_add_u32 s36, s36, s37
    s_cmp_ge_u32 s36, 234
    s_cbranch_scc1 K2_END
    s_mul_i32 s38, s36, 7282
    s_lshr_b32 s38, s38, 16
    s_mul_i32 s39, s38, 9
    s_sub_u32 s39, s36, s39
    v_and_b32 v1, 63, v0
    v_lshrrev_b32 v244, 6, v0
    s_lshl_b32 s41, s39, 7
    v_lshrrev_b32 v245, 3, v1
    v_readfirstlane_b32 s40, v244
    v_and_b32 v246, 7, v1
    v_and_b32 v247, 2, v245
    v_xor_b32 v246, v246, v247
    v_lshlrev_b32 v246, 4, v246
    v_add_u32 v246, s41, v246
    v_mul_u32_u24 v247, 1152, v245
    v_add_u32 v12, v247, v246
    v_xor_b32 v13, 64, v12
    v_add_u32 v13, 8192, v13
    v_add_u32 v14, 16384, v12
    v_add_u32 v15, 16384, v13
    v_lshrrev_b32 v247, 1, v245
    v_mul_u32_u24 v247, 18, v247
    v_and_b32 v248, 1, v245
    v_add3_u32 v247, v247, v248, 16
    v_mul_u32_u24 v247, 1152, v247
    v_add_u32 v18, v247, v246
    v_xor_b32 v19, 64, v18
    v_add_u32 v19, 81920, v19
    v_and_b32 v246, 7, v1
    v_mul_u32_u24 v7, 1152, v245
    v_lshl_add_u32 v7, v246, 4, v7
    v_lshrrev_b32 v245, 4, v1
    v_and_b32 v246, 15, v1
    v_lshlrev_b32 v6, 9, v245
    v_lshl_add_u32 v6, v246, 4, v6
    v_bfe_u32 v246, v1, 2, 2
    v_lshl_add_u32 v247, v245, 3, v246
    v_lshlrev_b32 v247, 7, v247
    v_and_b32 v248, 3, v1
    v_lshl_add_u32 v247, v248, 3, v247
    v_bfe_u32 v248, v1, 3, 2
    v_lshl_add_u32 v247, v248, 5, v247
    s_mul_i32 s42, s40, 20480
    v_add_u32 v8, s42, v247
    v_xor_b32 v9, 32, v8
    v_xor_b32 v10, 64, v8
    v_xor_b32 v11, 96, v8
    s_mul_i32 s46, s38, 5
    s_mul_i32 s59, s38, 80
    s_mul_i32 s58, s40, 20
    s_add_u32 s59, s59, s58
    s_mul_i32 s59, s59, 1152
    s_add_u32 s59, s59, s41
    s_add_u32 s60, s59, 9216
    s_add_u32 s61, s59, 18432
    s_add_u32 s47, s46, 0
    s_and_b32 s58, s47, 1
    s_lshl_b32 s58, s58, 8
    s_lshr_b32 s47, s47, 1
    s_mul_i32 s48, s47, 147456
    s_add_u32 s48, s48, s58
    s_add_u32 s47, s46, 1
    s_and_b32 s58, s47, 1
    s_lshl_b32 s58, s58, 8
    s_lshr_b32 s47, s47, 1
    s_mul_i32 s49, s47, 147456
    s_add_u32 s49, s49, s58
    s_add_u32 s47, s46, 2
    s_and_b32 s58, s47, 1
    s_lshl_b32 s58, s58, 8
    s_lshr_b32 s47, s47, 1
    s_mul_i32 s50, s47, 147456
    s_add_u32 s50, s50, s58
    s_add_u32 s47, s46, 3
    s_and_b32 s58, s47, 1
    s_lshl_b32 s58, s58, 8
    s_lshr_b32 s47, s47, 1
    s_mul_i32 s51, s47, 147456
    s_add_u32 s51, s51, s58
    s_add_u32 s47, s46, 4
    s_and_b32 s58, s47, 1
    s_lshl_b32 s58, s58, 8
    s_lshr_b32 s47, s47, 1
    s_mul_i32 s52, s47, 147456
    s_add_u32 s52, s52, s58
    s_mul_i32 s43, s40, 663552
    s_mul_i32 s58, s40, 36864
    s_add_u32 s58, s58, 30408704
    v_add_u32 v20, s58, v6
    s_add_u32 m0, s42, 0
    s_nop 0
    buffer_load_dwordx4 v12, s[8:11], s43 offen offset:0 lds
    buffer_load_dwordx4 v13, s[8:11], s43 offen offset:1024 lds
    buffer_load_dwordx4 v14, s[8:11], s43 offen offset:2048 lds
    buffer_load_dwordx4 v15, s[8:11], s43 offen offset:3072 lds
    s_add_u32 s43, s43, 36864
    s_add_u32 m0, s42, 4096
    s_nop 0
    buffer_load_dwordx4 v12, s[8:11], s43 offen offset:0 lds
    buffer_load_dwordx4 v13, s[8:11], s43 offen offset:1024 lds
    buffer_load_dwordx4 v14, s[8:11], s43 offen offset:2048 lds
    buffer_load_dwordx4 v15, s[8:11], s43 offen offset:3072 lds
    s_add_u32 s43, s43, 36864
    s_add_u32 m0, s42, 8192
    s_nop 0
    buffer_load_dwordx4 v12, s[8:11], s43 offen offset:0 lds
    buffer_load_dwordx4 v13, s[8:11], s43 offen offset:1024 lds
    buffer_load_dwordx4 v14, s[8:11], s43 offen offset:2048 lds
    buffer_load_dwordx4 v15, s[8:11], s43 offen offset:3072 lds
    s_add_u32 s43, s43, 36864
    s_add_u32 m0, s42, 12288
    s_nop 0
    buffer_load_dwordx4 v12, s[8:11], s43 offen offset:0 lds
    buffer_load_dwordx4 v13, s[8:11], s43 offen offset:1024 lds
    buffer_load_dwordx4 v14, s[8:11], s43 offen offset:2048 lds
    buffer_load_dwordx4 v15, s[8:11], s43 offen offset:3072 lds
    s_add_u32 s43, s43, 36864
    buffer_load_dwordx4 v[232:235], v7, s[12:15], s59 offen
    buffer_load_dwordx4 v[236:239], v7, s[12:15], s60 offen
    s_mov_b32 exec_hi, 0
    buffer_load_dwordx4 v[240:243], v7, s[12:15], s61 offen
    s_mov_b32 exec_hi, -1
    s_lshl_b32 s56, s36, 7
    s_add_u32 s56, s56, 12607488
    v_mov_b32 v23, 0
    s_add_u32 s53, s59, 41943040
    s_add_u32 s54, s60, 41943040
    s_add_u32 s55, s61, 41943040
    s_cmp_lg_u32 s40, 0
    s_cbranch_scc1 OPU_OK
    s_mul_i32 s44, s38, 80
    s_add_u32 s45, s44, 79
    s_min_u32 s45, s45, 2047
    s_lshr_b32 s44, s44, 7
    s_lshr_b32 s45, s45, 7
    s_sub_u32 s45, s45, s44
    s_lshl_b32 s45, s45, 7
    s_lshl_b32 s44, s44, 7
    s_add_u32 s44, s44, 12599296
    v_and_b32 v21, 15, v1
    v_lshlrev_b32 v21, 2, v21
    v_bfe_u32 v22, v1, 4, 1
    v_mul_lo_u32 v22, v22, s45
    v_add_u32 v21, v21, v22
    s_mov_b32 s47, 0
    buffer_load_dword v22, v21, s[20:23], s44 offen sc1
OPU_P:
    s_waitcnt vmcnt(0)
    v_cmp_eq_u32 vcc, 0, v22
    s_nop 1
    s_cmp_eq_u64 vcc, 0
    s_cbranch_scc1 OPU_OK
    s_add_u32 s47, s47, 1
    s_cmp_ge_u32 s47, 0x40000
    s_cbranch_scc1 OPU_OK
    s_sleep 6
    buffer_load_dword v22, v21, s[20:23], s44 offen sc1
    s_branch OPU_P
OPU_OK:
    s_waitcnt vmcnt(0)
    s_barrier
    s_mul_i32 s44, s38, 80
    s_add_u32 s45, s44, 79
    s_min_u32 s45, s45, 2047
    s_lshr_b32 s56, s44, 8
    s_lshr_b32 s57, s45, 8
    s_sub_u32 s57, s57, s56
    s_lshl_b32 s57, s57, 7
    s_lshl_b32 s56, s56, 7
    s_add_u32 s56, s56, 12601344
    v_and_b32 v23, 31, v1
    v_lshlrev_b32 v23, 2, v23
    v_lshrrev_b32 v22, 5, v1
    v_mul_lo_u32 v22, v22, s57
    v_add_u32 v23, v23, v22
    v_mov_b32 v184, 0
    v_mov_b32 v185, 0
    v_mov_b32 v186, 0
    v_mov_b32 v187, 0
    v_mov_b32 v188, 0
    v_mov_b32 v189, 0
    v_mov_b32 v190, 0
    v_mov_b32 v191, 0
    v_mov_b32 v192, 0
    v_mov_b32 v193, 0
    v_mov_b32 v194, 0
    v_mov_b32 v195, 0
    v_mov_b32 v196, 0
    v_mov_b32 v197, 0
    v_mov_b32 v198, 0
    v_mov_b32 v199, 0
    v_mov_b32 v200, 0
    v_mov_b32 v201, 0
    v_mov_b32 v202, 0
    v_mov_b32 v203, 0
    s_setprio 0
    buffer_load_dwordx4 v[104:107], v20, s[20:23], s48 offen offset:0 sc1
    buffer_load_dwordx4 v[108:111], v20, s[20:23], s49 offen offset:0 sc1
    buffer_load_dwordx4 v[112:115], v20, s[20:23], s50 offen offset:0 sc1
    buffer_load_dwordx4 v[116:119], v20, s[20:23], s51 offen offset:0 sc1
    buffer_load_dwordx4 v[120:123], v20, s[20:23], s52 offen offset:0 sc1
    buffer_load_dwordx4 v[124:127], v20, s[20:23], s48 offen offset:2048 sc1
    buffer_load_dwordx4 v[128:131], v20, s[20:23], s49 offen offset:2048 sc1
    buffer_load_dwordx4 v[132:135], v20, s[20:23], s50 offen offset:2048 sc1
    buffer_load_dwordx4 v[136:139], v20, s[20:23], s51 offen offset:2048 sc1
    buffer_load_dwordx4 v[140:143], v20, s[20:23], s52 offen offset:2048 sc1
    v_add_u32 v20, 4096, v20
    buffer_load_dwordx4 v[144:147], v20, s[20:23], s48 offen offset:0 sc1
    buffer_load_dwordx4 v[148:151], v20, s[20:23], s49 offen offset:0 sc1
    buffer_load_dwordx4 v[152:155], v20, s[20:23], s50 offen offset:0 sc1
    buffer_load_dwordx4 v[156:159], v20, s[20:23], s51 offen offset:0 sc1
    buffer_load_dwordx4 v[160:163], v20, s[20:23], s52 offen offset:0 sc1
    ds_read_b64_tr_b16 v[204:205], v8 offset:0
    ds_read_b64_tr_b16 v[206:207], v8 offset:512
    ds_read_b64_tr_b16 v[208:209], v9 offset:0
    ds_read_b64_tr_b16 v[210:211], v9 offset:512
    ds_read_b64_tr_b16 v[212:213], v10 offset:0
    ds_read_b64_tr_b16 v[214:215], v10 offset:512
    ds_read_b64_tr_b16 v[216:217], v11 offset:0
    ds_read_b64_tr_b16 v[218:219], v11 offset:512
    s_waitcnt vmcnt(10)
    s_waitcnt lgkmcnt(6)
    v_mfma_f32_16x16x32_bf16 v[24:27], v[204:207], v[104:107], 0
    v_mfma_f32_16x16x32_bf16 v[28:31], v[204:207], v[108:111], 0
    buffer_load_dwordx4 v[164:167], v20, s[20:23], s48 offen offset:2048 sc1
    v_mfma_f32_16x16x32_bf16 v[32:35], v[204:207], v[112:115], 0
    v_mfma_f32_16x16x32_bf16 v[36:39], v[204:207], v[116:119], 0
    buffer_load_dwordx4 v[168:171], v20, s[20:23], s49 offen offset:2048 sc1
    v_mfma_f32_16x16x32_bf16 v[40:43], v[204:207], v[120:123], 0
    ds_read_b64_tr_b16 v[204:205], v8 offset:4096
    ds_read_b64_tr_b16 v[206:207], v8 offset:4608
    s_waitcnt lgkmcnt(6)
    v_mfma_f32_16x16x32_bf16 v[44:47], v[208:211], v[104:107], 0
    buffer_load_dwordx4 v[172:175], v20, s[20:23], s50 offen offset:2048 sc1
    v_mfma_f32_16x16x32_bf16 v[48:51], v[208:211], v[108:111], 0
    v_mfma_f32_16x16x32_bf16 v[52:55], v[208:211], v[112:115], 0
    buffer_load_dwordx4 v[176:179], v20, s[20:23], s51 offen offset:2048 sc1
    v_mfma_f32_16x16x32_bf16 v[56:59], v[208:211], v[116:119], 0
    v_mfma_f32_16x16x32_bf16 v[60:63], v[208:211], v[120:123], 0
    buffer_load_dwordx4 v[180:183], v20, s[20:23], s52 offen offset:2048 sc1
    v_add_u32 v20, 4096, v20
    ds_read_b64_tr_b16 v[208:209], v9 offset:4096
    ds_read_b64_tr_b16 v[210:211], v9 offset:4608
    s_waitcnt lgkmcnt(6)
    v_mfma_f32_16x16x32_bf16 v[64:67], v[212:215], v[104:107], 0
    v_mfma_f32_16x16x32_bf16 v[68:71], v[212:215], v[108:111], 0
    s_add_u32 m0, s42, 16384
    s_nop 0
    buffer_load_dwordx4 v12, s[8:11], s43 offen offset:0 lds
    v_mfma_f32_16x16x32_bf16 v[72:75], v[212:215], v[112:115], 0
    v_mfma_f32_16x16x32_bf16 v[76:79], v[212:215], v[116:119], 0
    buffer_load_dwordx4 v13, s[8:11], s43 offen offset:1024 lds
    v_mfma_f32_16x16x32_bf16 v[80:83], v[212:215], v[120:123], 0
    ds_read_b64_tr_b16 v[212:213], v10 offset:4096
    ds_read_b64_tr_b16 v[214:215], v10 offset:4608
    s_waitcnt lgkmcnt(6)
    v_mfma_f32_16x16x32_bf16 v[84:87], v[216:219], v[104:107], 0
    buffer_load_dwordx4 v14, s[8:11], s43 offen offset:2048 lds
    v_mfma_f32_16x16x32_bf16 v[88:91], v[216:219], v[108:111], 0
    v_mfma_f32_16x16x32_bf16 v[92:95], v[216:219], v[112:115], 0
    buffer_load_dwordx4 v15, s[8:11], s43 offen offset:3072 lds
    s_add_u32 s43, s43, 36864
    v_mfma_f32_16x16x32_bf16 v[96:99], v[216:219], v[116:119], 0
    v_mfma_f32_16x16x32_bf16 v[100:103], v[216:219], v[120:123], 0
    ds_read_b64_tr_b16 v[216:217], v11 offset:4096
    ds_read_b64_tr_b16 v[218:219], v11 offset:4608
    s_waitcnt vmcnt(14)
    s_waitcnt lgkmcnt(6)
    v_mfma_f32_16x16x32_bf16 v[24:27], v[204:207], v[124:127], v[24:27]
    v_mfma_f32_16x16x32_bf16 v[28:31], v[204:207], v[128:131], v[28:31]
    buffer_load_dwordx4 v[104:107], v20, s[20:23], s48 offen offset:0 sc1
    v_mfma_f32_16x16x32_bf16 v[32:35], v[204:207], v[132:135], v[32:35]
    v_mfma_f32_16x16x32_bf16 v[36:39], v[204:207], v[136:139], v[36:39]
    buffer_load_dwordx4 v[108:111], v20, s[20:23], s49 offen offset:0 sc1
    v_mfma_f32_16x16x32_bf16 v[40:43], v[204:207], v[140:143], v[40:43]
    ds_read_b64_tr_b16 v[204:205], v8 offset:8192
    ds_read_b64_tr_b16 v[206:207], v8 offset:8704
    s_waitcnt lgkmcnt(6)
    v_mfma_f32_16x16x32_bf16 v[44:47], v[208:211], v[124:127], v[44:47]
    buffer_load_dwordx4 v[112:115], v20, s[20:23], s50 offen offset:0 sc1
    v_mfma_f32_16x16x32_bf16 v[48:51], v[208:211], v[128:131], v[48:51]
    v_mfma_f32_16x16x32_bf16 v[52:55], v[208:211], v[132:135], v[52:55]
    buffer_load_dwordx4 v[116:119], v20, s[20:23], s51 offen offset:0 sc1
    v_mfma_f32_16x16x32_bf16 v[56:59], v[208:211], v[136:139], v[56:59]
    v_mfma_f32_16x16x32_bf16 v[60:63], v[208:211], v[140:143], v[60:63]
    buffer_load_dwordx4 v[120:123], v20, s[20:23], s52 offen offset:0 sc1
    ds_read_b64_tr_b16 v[208:209], v9 offset:8192
    ds_read_b64_tr_b16 v[210:211], v9 offset:8704
    s_waitcnt lgkmcnt(6)
    v_mfma_f32_16x16x32_bf16 v[64:67], v[212:215], v[124:127], v[64:67]
    v_mfma_f32_16x16x32_bf16 v[68:71], v[212:215], v[128:131], v[68:71]
    s_add_u32 m0, s42, 0
    s_nop 0
    buffer_load_dwordx4 v12, s[8:11], s43 offen offset:0 lds
    v_mfma_f32_16x16x32_bf16 v[72:75], v[212:215], v[132:135], v[72:75]
    v_mfma_f32_16x16x32_bf16 v[76:79], v[212:215], v[136:139], v[76:79]
    buffer_load_dwordx4 v13, s[8:11], s43 offen offset:1024 lds
    v_mfma_f32_16x16x32_bf16 v[80:83], v[212:215], v[140:143], v[80:83]
    ds_read_b64_tr_b16 v[212:213], v10 offset:8192
    ds_read_b64_tr_b16 v[214:215], v10 offset:8704
    s_waitcnt lgkmcnt(6)
    v_mfma_f32_16x16x32_bf16 v[84:87], v[216:219], v[124:127], v[84:87]
    buffer_load_dwordx4 v14, s[8:11], s43 offen offset:2048 lds
    v_mfma_f32_16x16x32_bf16 v[88:91], v[216:219], v[128:131], v[88:91]
    v_mfma_f32_16x16x32_bf16 v[92:95], v[216:219], v[132:135], v[92:95]
    buffer_load_dwordx4 v15, s[8:11], s43 offen offset:3072 lds
    s_add_u32 s43, s43, 36864
    v_mfma_f32_16x16x32_bf16 v[96:99], v[216:219], v[136:139], v[96:99]
    v_mfma_f32_16x16x32_bf16 v[100:103], v[216:219], v[140:143], v[100:103]
    ds_read_b64_tr_b16 v[216:217], v11 offset:8192
    ds_read_b64_tr_b16 v[218:219], v11 offset:8704
    s_waitcnt vmcnt(18)
    s_waitcnt lgkmcnt(6)
    v_mfma_f32_16x16x32_bf16 v[24:27], v[204:207], v[144:147], v[24:27]
    v_mfma_f32_16x16x32_bf16 v[28:31], v[204:207], v[148:151], v[28:31]
    buffer_load_dwordx4 v[124:127], v20, s[20:23], s48 offen offset:2048 sc1
    v_mfma_f32_16x16x32_bf16 v[32:35], v[204:207], v[152:155], v[32:35]
    v_mfma_f32_16x16x32_bf16 v[36:39], v[204:207], v[156:159], v[36:39]
    buffer_load_dwordx4 v[128:131], v20, s[20:23], s49 offen offset:2048 sc1
    v_mfma_f32_16x16x32_bf16 v[40:43], v[204:207], v[160:163], v[40:43]
    ds_read_b64_tr_b16 v[204:205], v8 offset:12288
    ds_read_b64_tr_b16 v[206:207], v8 offset:12800
    s_waitcnt lgkmcnt(6)
    v_mfma_f32_16x16x32_bf16 v[44:47], v[208:211], v[144:147], v[44:47]
    buffer_load_dwordx4 v[132:135], v20, s[20:23], s50 offen offset:2048 sc1
    v_mfma_f32_16x16x32_bf16 v[48:51], v[208:211], v[148:151], v[48:51]
    v_mfma_f32_16x16x32_bf16 v[52:55], v[208:211], v[152:155], v[52:55]
    buffer_load_dwordx4 v[136:139], v20, s[20:23], s51 offen offset:2048 sc1
    v_mfma_f32_16x16x32_bf16 v[56:59], v[208:211], v[156:159], v[56:59]
    v_mfma_f32_16x16x32_bf16 v[60:63], v[208:211], v[160:163], v[60:63]
    buffer_load_dwordx4 v[140:143], v20, s[20:23], s52 offen offset:2048 sc1
    v_add_u32 v20, 4096, v20
    ds_read_b64_tr_b16 v[208:209], v9 offset:12288
    ds_read_b64_tr_b16 v[210:211], v9 offset:12800
    s_waitcnt lgkmcnt(6)
    v_mfma_f32_16x16x32_bf16 v[64:67], v[212:215], v[144:147], v[64:67]
    v_mfma_f32_16x16x32_bf16 v[68:71], v[212:215], v[148:151], v[68:71]
    s_add_u32 m0, s42, 4096
    s_nop 0
    buffer_load_dwordx4 v12, s[8:11], s43 offen offset:0 lds
    v_mfma_f32_16x16x32_bf16 v[72:75], v[212:215], v[152:155], v[72:75]
    v_mfma_f32_16x16x32_bf16 v[76:79], v[212:215], v[156:159], v[76:79]
    buffer_load_dwordx4 v13, s[8:11], s43 offen offset:1024 lds
    v_mfma_f32_16x16x32_bf16 v[80:83], v[212:215], v[160:163], v[80:83]
    ds_read_b64_tr_b16 v[212:213], v10 offset:12288
    ds_read_b64_tr_b16 v[214:215], v10 offset:12800
    s_waitcnt lgkmcnt(6)
    v_mfma_f32_16x16x32_bf16 v[84:87], v[216:219], v[144:147], v[84:87]
    buffer_load_dwordx4 v14, s[8:11], s43 offen offset:2048 lds
    v_mfma_f32_16x16x32_bf16 v[88:91], v[216:219], v[148:151], v[88:91]
    v_mfma_f32_16x16x32_bf16 v[92:95], v[216:219], v[152:155], v[92:95]
    buffer_load_dwordx4 v15, s[8:11], s43 offen offset:3072 lds
    s_add_u32 s43, s43, 36864
    v_mfma_f32_16x16x32_bf16 v[96:99], v[216:219], v[156:159], v[96:99]
    v_mfma_f32_16x16x32_bf16 v[100:103], v[216:219], v[160:163], v[100:103]
    ds_read_b64_tr_b16 v[216:217], v11 offset:12288
    ds_read_b64_tr_b16 v[218:219], v11 offset:12800
    s_waitcnt vmcnt(18)
    s_waitcnt lgkmcnt(6)
    v_mfma_f32_16x16x32_bf16 v[24:27], v[204:207], v[164:167], v[24:27]
    v_mfma_f32_16x16x32_bf16 v[28:31], v[204:207], v[168:171], v[28:31]
    buffer_load_dwordx4 v[144:147], v20, s[20:23], s48 offen offset:0 sc1
    v_mfma_f32_16x16x32_bf16 v[32:35], v[204:207], v[172:175], v[32:35]
    v_mfma_f32_16x16x32_bf16 v[36:39], v[204:207], v[176:179], v[36:39]
    buffer_load_dwordx4 v[148:151], v20, s[20:23], s49 offen offset:0 sc1
    v_mfma_f32_16x16x32_bf16 v[40:43], v[204:207], v[180:183], v[40:43]
    ds_read_b64_tr_b16 v[204:205], v8 offset:16384
    ds_read_b64_tr_b16 v[206:207], v8 offset:16896
    s_waitcnt lgkmcnt(6)
    v_mfma_f32_16x16x32_bf16 v[44:47], v[208:211], v[164:167], v[44:47]
    buffer_load_dwordx4 v[152:155], v20, s[20:23], s50 offen offset:0 sc1
    v_mfma_f32_16x16x32_bf16 v[48:51], v[208:211], v[168:171], v[48:51]
    v_mfma_f32_16x16x32_bf16 v[52:55], v[208:211], v[172:175], v[52:55]
    buffer_load_dwordx4 v[156:159], v20, s[20:23], s51 offen offset:0 sc1
    v_mfma_f32_16x16x32_bf16 v[56:59], v[208:211], v[176:179], v[56:59]
    v_mfma_f32_16x16x32_bf16 v[60:63], v[208:211], v[180:183], v[60:63]
    buffer_load_dwordx4 v[160:163], v20, s[20:23], s52 offen offset:0 sc1
    ds_read_b64_tr_b16 v[208:209], v9 offset:16384
    ds_read_b64_tr_b16 v[210:211], v9 offset:16896
    s_waitcnt lgkmcnt(6)
    v_mfma_f32_16x16x32_bf16 v[64:67], v[212:215], v[164:167], v[64:67]
    v_mfma_f32_16x16x32_bf16 v[68:71], v[212:215], v[168:171], v[68:71]
    s_add_u32 m0, s42, 8192
    s_nop 0
    buffer_load_dwordx4 v12, s[8:11], s43 offen offset:0 lds
    v_mfma_f32_16x16x32_bf16 v[72:75], v[212:215], v[172:175], v[72:75]
    v_mfma_f32_16x16x32_bf16 v[76:79], v[212:215], v[176:179], v[76:79]
    buffer_load_dwordx4 v13, s[8:11], s43 offen offset:1024 lds
    v_mfma_f32_16x16x32_bf16 v[80:83], v[212:215], v[180:183], v[80:83]
    ds_read_b64_tr_b16 v[212:213], v10 offset:16384
    ds_read_b64_tr_b16 v[214:215], v10 offset:16896
    s_waitcnt lgkmcnt(6)
    v_mfma_f32_16x16x32_bf16 v[84:87], v[216:219], v[164:167], v[84:87]
    buffer_load_dwordx4 v14, s[8:11], s43 offen offset:2048 lds
    v_mfma_f32_16x16x32_bf16 v[88:91], v[216:219], v[168:171], v[88:91]
    v_mfma_f32_16x16x32_bf16 v[92:95], v[216:219], v[172:175], v[92:95]
    buffer_load_dwordx4 v15, s[8:11], s43 offen offset:3072 lds
    s_add_u32 s43, s43, 36864
    v_mfma_f32_16x16x32_bf16 v[96:99], v[216:219], v[176:179], v[96:99]
    v_mfma_f32_16x16x32_bf16 v[100:103], v[216:219], v[180:183], v[100:103]
    ds_read_b64_tr_b16 v[216:217], v11 offset:16384
    ds_read_b64_tr_b16 v[218:219], v11 offset:16896
    s_waitcnt vmcnt(18)
    s_waitcnt lgkmcnt(6)
    v_mfma_f32_16x16x32_bf16 v[24:27], v[204:207], v[104:107], v[24:27]
    v_mfma_f32_16x16x32_bf16 v[28:31], v[204:207], v[108:111], v[28:31]
    buffer_load_dwordx4 v[164:167], v20, s[20:23], s48 offen offset:2048 sc1
    v_mfma_f32_16x16x32_bf16 v[32:35], v[204:207], v[112:115], v[32:35]
    v_mfma_f32_16x16x32_bf16 v[36:39], v[204:207], v[116:119], v[36:39]
    buffer_load_dwordx4 v[168:171], v20, s[20:23], s49 offen offset:2048 sc1
    v_mfma_f32_16x16x32_bf16 v[40:43], v[204:207], v[120:123], v[40:43]
    ds_read_b64_tr_b16 v[204:205], v8 offset:0
    ds_read_b64_tr_b16 v[206:207], v8 offset:512
    s_waitcnt lgkmcnt(6)
    v_mfma_f32_16x16x32_bf16 v[44:47], v[208:211], v[104:107], v[44:47]
    buffer_load_dwordx4 v[172:175], v20, s[20:23], s50 offen offset:2048 sc1
    v_mfma_f32_16x16x32_bf16 v[48:51], v[208:211], v[108:111], v[48:51]
    v_mfma_f32_16x16x32_bf16 v[52:55], v[208:211], v[112:115], v[52:55]
    buffer_load_dwordx4 v[176:179], v20, s[20:23], s51 offen offset:2048 sc1
    v_mfma_f32_16x16x32_bf16 v[56:59], v[208:211], v[116:119], v[56:59]
    v_mfma_f32_16x16x32_bf16 v[60:63], v[208:211], v[120:123], v[60:63]
    buffer_load_dwordx4 v[180:183], v20, s[20:23], s52 offen offset:2048 sc1
    v_add_u32 v20, 4096, v20
    ds_read_b64_tr_b16 v[208:209], v9 offset:0
    ds_read_b64_tr_b16 v[210:211], v9 offset:512
    s_waitcnt lgkmcnt(6)
    v_mfma_f32_16x16x32_bf16 v[64:67], v[212:215], v[104:107], v[64:67]
    v_mfma_f32_16x16x32_bf16 v[68:71], v[212:215], v[108:111], v[68:71]
    s_add_u32 m0, s42, 12288
    s_nop 0
    buffer_load_dwordx4 v12, s[8:11], s43 offen offset:0 lds
    v_mfma_f32_16x16x32_bf16 v[72:75], v[212:215], v[112:115], v[72:75]
    v_mfma_f32_16x16x32_bf16 v[76:79], v[212:215], v[116:119], v[76:79]
    buffer_load_dwordx4 v13, s[8:11], s43 offen offset:1024 lds
    v_mfma_f32_16x16x32_bf16 v[80:83], v[212:215], v[120:123], v[80:83]
    ds_read_b64_tr_b16 v[212:213], v10 offset:0
    ds_read_b64_tr_b16 v[214:215], v10 offset:512
    s_waitcnt lgkmcnt(6)
    v_mfma_f32_16x16x32_bf16 v[84:87], v[216:219], v[104:107], v[84:87]
    buffer_load_dwordx4 v14, s[8:11], s43 offen offset:2048 lds
    v_mfma_f32_16x16x32_bf16 v[88:91], v[216:219], v[108:111], v[88:91]
    v_mfma_f32_16x16x32_bf16 v[92:95], v[216:219], v[112:115], v[92:95]
    buffer_load_dwordx4 v15, s[8:11], s43 offen offset:3072 lds
    s_add_u32 s43, s43, 36864
    v_mfma_f32_16x16x32_bf16 v[96:99], v[216:219], v[116:119], v[96:99]
    v_mfma_f32_16x16x32_bf16 v[100:103], v[216:219], v[120:123], v[100:103]
    ds_read_b64_tr_b16 v[216:217], v11 offset:0
    ds_read_b64_tr_b16 v[218:219], v11 offset:512
    s_waitcnt vmcnt(18)
    s_waitcnt lgkmcnt(6)
    v_mfma_f32_16x16x32_bf16 v[24:27], v[204:207], v[124:127], v[24:27]
    v_mfma_f32_16x16x32_bf16 v[28:31], v[204:207], v[128:131], v[28:31]
    buffer_load_dwordx4 v[104:107], v20, s[20:23], s48 offen offset:0 sc1
    v_mfma_f32_16x16x32_bf16 v[32:35], v[204:207], v[132:135], v[32:35]
    v_mfma_f32_16x16x32_bf16 v[36:39], v[204:207], v[136:139], v[36:39]
    buffer_load_dwordx4 v[108:111], v20, s[20:23], s49 offen offset:0 sc1
    v_mfma_f32_16x16x32_bf16 v[40:43], v[204:207], v[140:143], v[40:43]
    ds_read_b64_tr_b16 v[204:205], v8 offset:4096
    ds_read_b64_tr_b16 v[206:207], v8 offset:4608
    s_waitcnt lgkmcnt(6)
    v_mfma_f32_16x16x32_bf16 v[44:47], v[208:211], v[124:127], v[44:47]
    buffer_load_dwordx4 v[112:115], v20, s[20:23], s50 offen offset:0 sc1
    v_mfma_f32_16x16x32_bf16 v[48:51], v[208:211], v[128:131], v[48:51]
    v_mfma_f32_16x16x32_bf16 v[52:55], v[208:211], v[132:135], v[52:55]
    buffer_load_dwordx4 v[116:119], v20, s[20:23], s51 offen offset:0 sc1
    v_mfma_f32_16x16x32_bf16 v[56:59], v[208:211], v[136:139], v[56:59]
    v_mfma_f32_16x16x32_bf16 v[60:63], v[208:211], v[140:143], v[60:63]
    buffer_load_dwordx4 v[120:123], v20, s[20:23], s52 offen offset:0 sc1
    ds_read_b64_tr_b16 v[208:209], v9 offset:4096
    ds_read_b64_tr_b16 v[210:211], v9 offset:4608
    s_waitcnt lgkmcnt(6)
    v_mfma_f32_16x16x32_bf16 v[64:67], v[212:215], v[124:127], v[64:67]
    v_mfma_f32_16x16x32_bf16 v[68:71], v[212:215], v[128:131], v[68:71]
    s_add_u32 m0, s42, 16384
    s_nop 0
    buffer_load_dwordx4 v12, s[8:11], s43 offen offset:0 lds
    v_mfma_f32_16x16x32_bf16 v[72:75], v[212:215], v[132:135], v[72:75]
    v_mfma_f32_16x16x32_bf16 v[76:79], v[212:215], v[136:139], v[76:79]
    buffer_load_dwordx4 v13, s[8:11], s43 offen offset:1024 lds
    v_mfma_f32_16x16x32_bf16 v[80:83], v[212:215], v[140:143], v[80:83]
    ds_read_b64_tr_b16 v[212:213], v10 offset:4096
    ds_read_b64_tr_b16 v[214:215], v10 offset:4608
    s_waitcnt lgkmcnt(6)
    v_mfma_f32_16x16x32_bf16 v[84:87], v[216:219], v[124:127], v[84:87]
    buffer_load_dwordx4 v14, s[8:11], s43 offen offset:2048 lds
    v_mfma_f32_16x16x32_bf16 v[88:91], v[216:219], v[128:131], v[88:91]
    v_mfma_f32_16x16x32_bf16 v[92:95], v[216:219], v[132:135], v[92:95]
    buffer_load_dwordx4 v15, s[8:11], s43 offen offset:3072 lds
    s_add_u32 s43, s43, 36864
    v_mfma_f32_16x16x32_bf16 v[96:99], v[216:219], v[136:139], v[96:99]
    v_mfma_f32_16x16x32_bf16 v[100:103], v[216:219], v[140:143], v[100:103]
    ds_read_b64_tr_b16 v[216:217], v11 offset:4096
    ds_read_b64_tr_b16 v[218:219], v11 offset:4608
    s_waitcnt vmcnt(18)
    s_waitcnt lgkmcnt(6)
    v_mfma_f32_16x16x32_bf16 v[24:27], v[204:207], v[144:147], v[24:27]
    v_mfma_f32_16x16x32_bf16 v[28:31], v[204:207], v[148:151], v[28:31]
    buffer_load_dwordx4 v[124:127], v20, s[20:23], s48 offen offset:2048 sc1
    v_mfma_f32_16x16x32_bf16 v[32:35], v[204:207], v[152:155], v[32:35]
    v_mfma_f32_16x16x32_bf16 v[36:39], v[204:207], v[156:159], v[36:39]
    buffer_load_dwordx4 v[128:131], v20, s[20:23], s49 offen offset:2048 sc1
    v_mfma_f32_16x16x32_bf16 v[40:43], v[204:207], v[160:163], v[40:43]
    ds_read_b64_tr_b16 v[204:205], v8 offset:8192
    ds_read_b64_tr_b16 v[206:207], v8 offset:8704
    s_waitcnt lgkmcnt(6)
    v_mfma_f32_16x16x32_bf16 v[44:47], v[208:211], v[144:147], v[44:47]
    buffer_load_dwordx4 v[132:135], v20, s[20:23], s50 offen offset:2048 sc1
    v_mfma_f32_16x16x32_bf16 v[48:51], v[208:211], v[148:151], v[48:51]
    v_mfma_f32_16x16x32_bf16 v[52:55], v[208:211], v[152:155], v[52:55]
    buffer_load_dwordx4 v[136:139], v20, s[20:23], s51 offen offset:2048 sc1
    v_mfma_f32_16x16x32_bf16 v[56:59], v[208:211], v[156:159], v[56:59]
    v_mfma_f32_16x16x32_bf16 v[60:63], v[208:211], v[160:163], v[60:63]
    buffer_load_dwordx4 v[140:143], v20, s[20:23], s52 offen offset:2048 sc1
    v_add_u32 v20, 4096, v20
    ds_read_b64_tr_b16 v[208:209], v9 offset:8192
    ds_read_b64_tr_b16 v[210:211], v9 offset:8704
    s_waitcnt lgkmcnt(6)
    v_mfma_f32_16x16x32_bf16 v[64:67], v[212:215], v[144:147], v[64:67]
    v_mfma_f32_16x16x32_bf16 v[68:71], v[212:215], v[148:151], v[68:71]
    s_add_u32 m0, s42, 0
    s_nop 0
    buffer_load_dwordx4 v12, s[8:11], s43 offen offset:0 lds
    v_mfma_f32_16x16x32_bf16 v[72:75], v[212:215], v[152:155], v[72:75]
    v_mfma_f32_16x16x32_bf16 v[76:79], v[212:215], v[156:159], v[76:79]
    buffer_load_dwordx4 v13, s[8:11], s43 offen offset:1024 lds
    v_mfma_f32_16x16x32_bf16 v[80:83], v[212:215], v[160:163], v[80:83]
    ds_read_b64_tr_b16 v[212:213], v10 offset:8192
    ds_read_b64_tr_b16 v[214:215], v10 offset:8704
    s_waitcnt lgkmcnt(6)
    v_mfma_f32_16x16x32_bf16 v[84:87], v[216:219], v[144:147], v[84:87]
    buffer_load_dwordx4 v14, s[8:11], s43 offen offset:2048 lds
    v_mfma_f32_16x16x32_bf16 v[88:91], v[216:219], v[148:151], v[88:91]
    v_mfma_f32_16x16x32_bf16 v[92:95], v[216:219], v[152:155], v[92:95]
    buffer_load_dwordx4 v15, s[8:11], s43 offen offset:3072 lds
    s_add_u32 s43, s43, 36864
    v_mfma_f32_16x16x32_bf16 v[96:99], v[216:219], v[156:159], v[96:99]
    v_mfma_f32_16x16x32_bf16 v[100:103], v[216:219], v[160:163], v[100:103]
    ds_read_b64_tr_b16 v[216:217], v11 offset:8192
    ds_read_b64_tr_b16 v[218:219], v11 offset:8704
    s_waitcnt vmcnt(18)
    s_waitcnt lgkmcnt(6)
    v_mfma_f32_16x16x32_bf16 v[24:27], v[204:207], v[164:167], v[24:27]
    v_mfma_f32_16x16x32_bf16 v[28:31], v[204:207], v[168:171], v[28:31]
    buffer_load_dwordx4 v[144:147], v20, s[20:23], s48 offen offset:0 sc1
    v_mfma_f32_16x16x32_bf16 v[32:35], v[204:207], v[172:175], v[32:35]
    v_mfma_f32_16x16x32_bf16 v[36:39], v[204:207], v[176:179], v[36:39]
    buffer_load_dwordx4 v[148:151], v20, s[20:23], s49 offen offset:0 sc1
    v_mfma_f32_16x16x32_bf16 v[40:43], v[204:207], v[180:183], v[40:43]
    ds_read_b64_tr_b16 v[204:205], v8 offset:12288
    ds_read_b64_tr_b16 v[206:207], v8 offset:12800
    s_waitcnt lgkmcnt(6)
    v_mfma_f32_16x16x32_bf16 v[44:47], v[208:211], v[164:167], v[44:47]
    buffer_load_dwordx4 v[152:155], v20, s[20:23], s50 offen offset:0 sc1
    v_mfma_f32_16x16x32_bf16 v[48:51], v[208:211], v[168:171], v[48:51]
    v_mfma_f32_16x16x32_bf16 v[52:55], v[208:211], v[172:175], v[52:55]
    buffer_load_dwordx4 v[156:159], v20, s[20:23], s51 offen offset:0 sc1
    v_mfma_f32_16x16x32_bf16 v[56:59], v[208:211], v[176:179], v[56:59]
    v_mfma_f32_16x16x32_bf16 v[60:63], v[208:211], v[180:183], v[60:63]
    buffer_load_dwordx4 v[160:163], v20, s[20:23], s52 offen offset:0 sc1
    ds_read_b64_tr_b16 v[208:209], v9 offset:12288
    ds_read_b64_tr_b16 v[210:211], v9 offset:12800
    s_waitcnt lgkmcnt(6)
    v_mfma_f32_16x16x32_bf16 v[64:67], v[212:215], v[164:167], v[64:67]
    v_mfma_f32_16x16x32_bf16 v[68:71], v[212:215], v[168:171], v[68:71]
    s_add_u32 m0, s42, 4096
    s_nop 0
    buffer_load_dwordx4 v12, s[8:11], s43 offen offset:0 lds
    v_mfma_f32_16x16x32_bf16 v[72:75], v[212:215], v[172:175], v[72:75]
    v_mfma_f32_16x16x32_bf16 v[76:79], v[212:215], v[176:179], v[76:79]
    buffer_load_dwordx4 v13, s[8:11], s43 offen offset:1024 lds
    v_mfma_f32_16x16x32_bf16 v[80:83], v[212:215], v[180:183], v[80:83]
    ds_read_b64_tr_b16 v[212:213], v10 offset:12288
    ds_read_b64_tr_b16 v[214:215], v10 offset:12800
    s_waitcnt lgkmcnt(6)
    v_mfma_f32_16x16x32_bf16 v[84:87], v[216:219], v[164:167], v[84:87]
    buffer_load_dwordx4 v14, s[8:11], s43 offen offset:2048 lds
    v_mfma_f32_16x16x32_bf16 v[88:91], v[216:219], v[168:171], v[88:91]
    v_mfma_f32_16x16x32_bf16 v[92:95], v[216:219], v[172:175], v[92:95]
    buffer_load_dwordx4 v15, s[8:11], s43 offen offset:3072 lds
    s_add_u32 s43, s43, 36864
    v_mfma_f32_16x16x32_bf16 v[96:99], v[216:219], v[176:179], v[96:99]
    v_mfma_f32_16x16x32_bf16 v[100:103], v[216:219], v[180:183], v[100:103]
    ds_read_b64_tr_b16 v[216:217], v11 offset:12288
    ds_read_b64_tr_b16 v[218:219], v11 offset:12800
    s_waitcnt vmcnt(18)
    s_waitcnt lgkmcnt(6)
    v_mfma_f32_16x16x32_bf16 v[24:27], v[204:207], v[104:107], v[24:27]
    v_mfma_f32_16x16x32_bf16 v[28:31], v[204:207], v[108:111], v[28:31]
    buffer_load_dwordx4 v[164:167], v20, s[20:23], s48 offen offset:2048 sc1
    v_mfma_f32_16x16x32_bf16 v[32:35], v[204:207], v[112:115], v[32:35]
    v_mfma_f32_16x16x32_bf16 v[36:39], v[204:207], v[116:119], v[36:39]
    buffer_load_dwordx4 v[168:171], v20, s[20:23], s49 offen offset:2048 sc1
    v_mfma_f32_16x16x32_bf16 v[40:43], v[204:207], v[120:123], v[40:43]
    ds_read_b64_tr_b16 v[204:205], v8 offset:16384
    ds_read_b64_tr_b16 v[206:207], v8 offset:16896
    s_waitcnt lgkmcnt(6)
    v_mfma_f32_16x16x32_bf16 v[44:47], v[208:211], v[104:107], v[44:47]
    buffer_load_dwordx4 v[172:175], v20, s[20:23], s50 offen offset:2048 sc1
    v_mfma_f32_16x16x32_bf16 v[48:51], v[208:211], v[108:111], v[48:51]
    v_mfma_f32_16x16x32_bf16 v[52:55], v[208:211], v[112:115], v[52:55]
    buffer_load_dwordx4 v[176:179], v20, s[20:23], s51 offen offset:2048 sc1
    v_mfma_f32_16x16x32_bf16 v[56:59], v[208:211], v[116:119], v[56:59]
    v_mfma_f32_16x16x32_bf16 v[60:63], v[208:211], v[120:123], v[60:63]
    buffer_load_dwordx4 v[180:183], v20, s[20:23], s52 offen offset:2048 sc1
    v_add_u32 v20, 4096, v20
    ds_read_b64_tr_b16 v[208:209], v9 offset:16384
    ds_read_b64_tr_b16 v[210:211], v9 offset:16896
    s_waitcnt lgkmcnt(6)
    v_mfma_f32_16x16x32_bf16 v[64:67], v[212:215], v[104:107], v[64:67]
    v_mfma_f32_16x16x32_bf16 v[68:71], v[212:215], v[108:111], v[68:71]
    s_add_u32 m0, s42, 8192
    s_nop 0
    buffer_load_dwordx4 v12, s[8:11], s43 offen offset:0 lds
    v_mfma_f32_16x16x32_bf16 v[72:75], v[212:215], v[112:115], v[72:75]
    v_mfma_f32_16x16x32_bf16 v[76:79], v[212:215], v[116:119], v[76:79]
    buffer_load_dwordx4 v13, s[8:11], s43 offen offset:1024 lds
    v_mfma_f32_16x16x32_bf16 v[80:83], v[212:215], v[120:123], v[80:83]
    ds_read_b64_tr_b16 v[212:213], v10 offset:16384
    ds_read_b64_tr_b16 v[214:215], v10 offset:16896
    s_waitcnt lgkmcnt(6)
    v_mfma_f32_16x16x32_bf16 v[84:87], v[216:219], v[104:107], v[84:87]
    buffer_load_dwordx4 v14, s[8:11], s43 offen offset:2048 lds
    v_mfma_f32_16x16x32_bf16 v[88:91], v[216:219], v[108:111], v[88:91]
    v_mfma_f32_16x16x32_bf16 v[92:95], v[216:219], v[112:115], v[92:95]
    buffer_load_dwordx4 v15, s[8:11], s43 offen offset:3072 lds
    s_add_u32 s43, s43, 36864
    v_mfma_f32_16x16x32_bf16 v[96:99], v[216:219], v[116:119], v[96:99]
    v_mfma_f32_16x16x32_bf16 v[100:103], v[216:219], v[120:123], v[100:103]
    ds_read_b64_tr_b16 v[216:217], v11 offset:16384
    ds_read_b64_tr_b16 v[218:219], v11 offset:16896
    s_waitcnt vmcnt(18)
    s_waitcnt lgkmcnt(6)
    v_mfma_f32_16x16x32_bf16 v[24:27], v[204:207], v[124:127], v[24:27]
    v_mfma_f32_16x16x32_bf16 v[28:31], v[204:207], v[128:131], v[28:31]
    buffer_load_dwordx4 v[104:107], v20, s[20:23], s48 offen offset:0 sc1
    v_mfma_f32_16x16x32_bf16 v[32:35], v[204:207], v[132:135], v[32:35]
    v_mfma_f32_16x16x32_bf16 v[36:39], v[204:207], v[136:139], v[36:39]
    buffer_load_dwordx4 v[108:111], v20, s[20:23], s49 offen offset:0 sc1
    v_mfma_f32_16x16x32_bf16 v[40:43], v[204:207], v[140:143], v[40:43]
    ds_read_b64_tr_b16 v[204:205], v8 offset:0
    ds_read_b64_tr_b16 v[206:207], v8 offset:512
    s_waitcnt lgkmcnt(6)
    v_mfma_f32_16x16x32_bf16 v[44:47], v[208:211], v[124:127], v[44:47]
    buffer_load_dwordx4 v[112:115], v20, s[20:23], s50 offen offset:0 sc1
    v_mfma_f32_16x16x32_bf16 v[48:51], v[208:211], v[128:131], v[48:51]
    v_mfma_f32_16x16x32_bf16 v[52:55], v[208:211], v[132:135], v[52:55]
    buffer_load_dwordx4 v[116:119], v20, s[20:23], s51 offen offset:0 sc1
    v_mfma_f32_16x16x32_bf16 v[56:59], v[208:211], v[136:139], v[56:59]
    v_mfma_f32_16x16x32_bf16 v[60:63], v[208:211], v[140:143], v[60:63]
    buffer_load_dwordx4 v[120:123], v20, s[20:23], s52 offen offset:0 sc1
    ds_read_b64_tr_b16 v[208:209], v9 offset:0
    ds_read_b64_tr_b16 v[210:211], v9 offset:512
    s_waitcnt lgkmcnt(6)
    v_mfma_f32_16x16x32_bf16 v[64:67], v[212:215], v[124:127], v[64:67]
    v_mfma_f32_16x16x32_bf16 v[68:71], v[212:215], v[128:131], v[68:71]
    s_add_u32 m0, s42, 12288
    s_nop 0
    buffer_load_dwordx4 v12, s[8:11], s43 offen offset:0 lds
    v_mfma_f32_16x16x32_bf16 v[72:75], v[212:215], v[132:135], v[72:75]
    v_mfma_f32_16x16x32_bf16 v[76:79], v[212:215], v[136:139], v[76:79]
    buffer_load_dwordx4 v13, s[8:11], s43 offen offset:1024 lds
    v_mfma_f32_16x16x32_bf16 v[80:83], v[212:215], v[140:143], v[80:83]
    ds_read_b64_tr_b16 v[212:213], v10 offset:0
    ds_read_b64_tr_b16 v[214:215], v10 offset:512
    s_waitcnt lgkmcnt(6)
    v_mfma_f32_16x16x32_bf16 v[84:87], v[216:219], v[124:127], v[84:87]
    buffer_load_dwordx4 v14, s[8:11], s43 offen offset:2048 lds
    v_mfma_f32_16x16x32_bf16 v[88:91], v[216:219], v[128:131], v[88:91]
    v_mfma_f32_16x16x32_bf16 v[92:95], v[216:219], v[132:135], v[92:95]
    buffer_load_dwordx4 v15, s[8:11], s43 offen offset:3072 lds
    s_add_u32 s43, s43, 36864
    v_mfma_f32_16x16x32_bf16 v[96:99], v[216:219], v[136:139], v[96:99]
    v_mfma_f32_16x16x32_bf16 v[100:103], v[216:219], v[140:143], v[100:103]
    ds_read_b64_tr_b16 v[216:217], v11 offset:0
    ds_read_b64_tr_b16 v[218:219], v11 offset:512
    s_waitcnt vmcnt(18)
    s_waitcnt lgkmcnt(6)
    v_mfma_f32_16x16x32_bf16 v[24:27], v[204:207], v[144:147], v[24:27]
    v_mfma_f32_16x16x32_bf16 v[28:31], v[204:207], v[148:151], v[28:31]
    buffer_load_dwordx4 v[124:127], v20, s[20:23], s48 offen offset:2048 sc1
    v_mfma_f32_16x16x32_bf16 v[32:35], v[204:207], v[152:155], v[32:35]
    v_mfma_f32_16x16x32_bf16 v[36:39], v[204:207], v[156:159], v[36:39]
    buffer_load_dwordx4 v[128:131], v20, s[20:23], s49 offen offset:2048 sc1
    v_mfma_f32_16x16x32_bf16 v[40:43], v[204:207], v[160:163], v[40:43]
    ds_read_b64_tr_b16 v[204:205], v8 offset:4096
    ds_read_b64_tr_b16 v[206:207], v8 offset:4608
    s_waitcnt lgkmcnt(6)
    v_mfma_f32_16x16x32_bf16 v[44:47], v[208:211], v[144:147], v[44:47]
    buffer_load_dwordx4 v[132:135], v20, s[20:23], s50 offen offset:2048 sc1
    v_mfma_f32_16x16x32_bf16 v[48:51], v[208:211], v[148:151], v[48:51]
    v_mfma_f32_16x16x32_bf16 v[52:55], v[208:211], v[152:155], v[52:55]
    buffer_load_dwordx4 v[136:139], v20, s[20:23], s51 offen offset:2048 sc1
    v_mfma_f32_16x16x32_bf16 v[56:59], v[208:211], v[156:159], v[56:59]
    v_mfma_f32_16x16x32_bf16 v[60:63], v[208:211], v[160:163], v[60:63]
    buffer_load_dwordx4 v[140:143], v20, s[20:23], s52 offen offset:2048 sc1
    v_add_u32 v20, 4096, v20
    ds_read_b64_tr_b16 v[208:209], v9 offset:4096
    ds_read_b64_tr_b16 v[210:211], v9 offset:4608
    s_waitcnt lgkmcnt(6)
    v_mfma_f32_16x16x32_bf16 v[64:67], v[212:215], v[144:147], v[64:67]
    v_mfma_f32_16x16x32_bf16 v[68:71], v[212:215], v[148:151], v[68:71]
    s_add_u32 m0, s42, 16384
    s_nop 0
    buffer_load_dwordx4 v12, s[8:11], s43 offen offset:0 lds
    v_mfma_f32_16x16x32_bf16 v[72:75], v[212:215], v[152:155], v[72:75]
    v_mfma_f32_16x16x32_bf16 v[76:79], v[212:215], v[156:159], v[76:79]
    buffer_load_dwordx4 v13, s[8:11], s43 offen offset:1024 lds
    v_mfma_f32_16x16x32_bf16 v[80:83], v[212:215], v[160:163], v[80:83]
    ds_read_b64_tr_b16 v[212:213], v10 offset:4096
    ds_read_b64_tr_b16 v[214:215], v10 offset:4608
    s_waitcnt lgkmcnt(6)
    v_mfma_f32_16x16x32_bf16 v[84:87], v[216:219], v[144:147], v[84:87]
    buffer_load_dwordx4 v14, s[8:11], s43 offen offset:2048 lds
    v_mfma_f32_16x16x32_bf16 v[88:91], v[216:219], v[148:151], v[88:91]
    v_mfma_f32_16x16x32_bf16 v[92:95], v[216:219], v[152:155], v[92:95]
    buffer_load_dwordx4 v15, s[8:11], s43 offen offset:3072 lds
    s_add_u32 s43, s43, 36864
    v_mfma_f32_16x16x32_bf16 v[96:99], v[216:219], v[156:159], v[96:99]
    v_mfma_f32_16x16x32_bf16 v[100:103], v[216:219], v[160:163], v[100:103]
    ds_read_b64_tr_b16 v[216:217], v11 offset:4096
    ds_read_b64_tr_b16 v[218:219], v11 offset:4608
    s_waitcnt vmcnt(18)
    s_waitcnt lgkmcnt(6)
    v_mfma_f32_16x16x32_bf16 v[24:27], v[204:207], v[164:167], v[24:27]
    v_mfma_f32_16x16x32_bf16 v[28:31], v[204:207], v[168:171], v[28:31]
    buffer_load_dwordx4 v[144:147], v20, s[20:23], s48 offen offset:0 sc1
    v_mfma_f32_16x16x32_bf16 v[32:35], v[204:207], v[172:175], v[32:35]
    v_mfma_f32_16x16x32_bf16 v[36:39], v[204:207], v[176:179], v[36:39]
    buffer_load_dwordx4 v[148:151], v20, s[20:23], s49 offen offset:0 sc1
    v_mfma_f32_16x16x32_bf16 v[40:43], v[204:207], v[180:183], v[40:43]
    ds_read_b64_tr_b16 v[204:205], v8 offset:8192
    ds_read_b64_tr_b16 v[206:207], v8 offset:8704
    s_waitcnt lgkmcnt(6)
    v_mfma_f32_16x16x32_bf16 v[44:47], v[208:211], v[164:167], v[44:47]
    buffer_load_dwordx4 v[152:155], v20, s[20:23], s50 offen offset:0 sc1
    v_mfma_f32_16x16x32_bf16 v[48:51], v[208:211], v[168:171], v[48:51]
    v_mfma_f32_16x16x32_bf16 v[52:55], v[208:211], v[172:175], v[52:55]
    buffer_load_dwordx4 v[156:159], v20, s[20:23], s51 offen offset:0 sc1
    v_mfma_f32_16x16x32_bf16 v[56:59], v[208:211], v[176:179], v[56:59]
    v_mfma_f32_16x16x32_bf16 v[60:63], v[208:211], v[180:183], v[60:63]
    buffer_load_dwordx4 v[160:163], v20, s[20:23], s52 offen offset:0 sc1
    ds_read_b64_tr_b16 v[208:209], v9 offset:8192
    ds_read_b64_tr_b16 v[210:211], v9 offset:8704
    s_waitcnt lgkmcnt(6)
    v_mfma_f32_16x16x32_bf16 v[64:67], v[212:215], v[164:167], v[64:67]
    v_mfma_f32_16x16x32_bf16 v[68:71], v[212:215], v[168:171], v[68:71]
    s_add_u32 m0, s42, 0
    s_nop 0
    buffer_load_dwordx4 v12, s[8:11], s43 offen offset:0 lds
    v_mfma_f32_16x16x32_bf16 v[72:75], v[212:215], v[172:175], v[72:75]
    v_mfma_f32_16x16x32_bf16 v[76:79], v[212:215], v[176:179], v[76:79]
    buffer_load_dwordx4 v13, s[8:11], s43 offen offset:1024 lds
    v_mfma_f32_16x16x32_bf16 v[80:83], v[212:215], v[180:183], v[80:83]
    ds_read_b64_tr_b16 v[212:213], v10 offset:8192
    ds_read_b64_tr_b16 v[214:215], v10 offset:8704
    s_waitcnt lgkmcnt(6)
    v_mfma_f32_16x16x32_bf16 v[84:87], v[216:219], v[164:167], v[84:87]
    buffer_load_dwordx4 v14, s[8:11], s43 offen offset:2048 lds
    v_mfma_f32_16x16x32_bf16 v[88:91], v[216:219], v[168:171], v[88:91]
    v_mfma_f32_16x16x32_bf16 v[92:95], v[216:219], v[172:175], v[92:95]
    buffer_load_dwordx4 v15, s[8:11], s43 offen offset:3072 lds
    s_add_u32 s43, s43, 36864
    v_mfma_f32_16x16x32_bf16 v[96:99], v[216:219], v[176:179], v[96:99]
    v_mfma_f32_16x16x32_bf16 v[100:103], v[216:219], v[180:183], v[100:103]
    ds_read_b64_tr_b16 v[216:217], v11 offset:8192
    ds_read_b64_tr_b16 v[218:219], v11 offset:8704
    s_waitcnt vmcnt(18)
    s_waitcnt lgkmcnt(6)
    v_mfma_f32_16x16x32_bf16 v[24:27], v[204:207], v[104:107], v[24:27]
    v_mfma_f32_16x16x32_bf16 v[28:31], v[204:207], v[108:111], v[28:31]
    buffer_load_dwordx4 v[164:167], v20, s[20:23], s48 offen offset:2048 sc1
    v_mfma_f32_16x16x32_bf16 v[32:35], v[204:207], v[112:115], v[32:35]
    v_mfma_f32_16x16x32_bf16 v[36:39], v[204:207], v[116:119], v[36:39]
    buffer_load_dwordx4 v[168:171], v20, s[20:23], s49 offen offset:2048 sc1
    v_mfma_f32_16x16x32_bf16 v[40:43], v[204:207], v[120:123], v[40:43]
    ds_read_b64_tr_b16 v[204:205], v8 offset:12288
    ds_read_b64_tr_b16 v[206:207], v8 offset:12800
    s_waitcnt lgkmcnt(6)
    v_mfma_f32_16x16x32_bf16 v[44:47], v[208:211], v[104:107], v[44:47]
    buffer_load_dwordx4 v[172:175], v20, s[20:23], s50 offen offset:2048 sc1
    v_mfma_f32_16x16x32_bf16 v[48:51], v[208:211], v[108:111], v[48:51]
    v_mfma_f32_16x16x32_bf16 v[52:55], v[208:211], v[112:115], v[52:55]
    buffer_load_dwordx4 v[176:179], v20, s[20:23], s51 offen offset:2048 sc1
    v_mfma_f32_16x16x32_bf16 v[56:59], v[208:211], v[116:119], v[56:59]
    v_mfma_f32_16x16x32_bf16 v[60:63], v[208:211], v[120:123], v[60:63]
    buffer_load_dwordx4 v[180:183], v20, s[20:23], s52 offen offset:2048 sc1
    v_add_u32 v20, 4096, v20
    ds_read_b64_tr_b16 v[208:209], v9 offset:12288
    ds_read_b64_tr_b16 v[210:211], v9 offset:12800
    s_waitcnt lgkmcnt(6)
    v_mfma_f32_16x16x32_bf16 v[64:67], v[212:215], v[104:107], v[64:67]
    v_mfma_f32_16x16x32_bf16 v[68:71], v[212:215], v[108:111], v[68:71]
    s_add_u32 m0, s42, 4096
    s_nop 0
    buffer_load_dwordx4 v12, s[8:11], s43 offen offset:0 lds
    v_mfma_f32_16x16x32_bf16 v[72:75], v[212:215], v[112:115], v[72:75]
    v_mfma_f32_16x16x32_bf16 v[76:79], v[212:215], v[116:119], v[76:79]
    buffer_load_dwordx4 v13, s[8:11], s43 offen offset:1024 lds
    v_mfma_f32_16x16x32_bf16 v[80:83], v[212:215], v[120:123], v[80:83]
    ds_read_b64_tr_b16 v[212:213], v10 offset:12288
    ds_read_b64_tr_b16 v[214:215], v10 offset:12800
    s_waitcnt lgkmcnt(6)
    v_mfma_f32_16x16x32_bf16 v[84:87], v[216:219], v[104:107], v[84:87]
    buffer_load_dwordx4 v14, s[8:11], s43 offen offset:2048 lds
    v_mfma_f32_16x16x32_bf16 v[88:91], v[216:219], v[108:111], v[88:91]
    v_mfma_f32_16x16x32_bf16 v[92:95], v[216:219], v[112:115], v[92:95]
    buffer_load_dwordx4 v15, s[8:11], s43 offen offset:3072 lds
    s_add_u32 s43, s43, 36864
    v_mfma_f32_16x16x32_bf16 v[96:99], v[216:219], v[116:119], v[96:99]
    v_mfma_f32_16x16x32_bf16 v[100:103], v[216:219], v[120:123], v[100:103]
    ds_read_b64_tr_b16 v[216:217], v11 offset:12288
    ds_read_b64_tr_b16 v[218:219], v11 offset:12800
    s_waitcnt vmcnt(18)
    s_waitcnt lgkmcnt(6)
    v_mfma_f32_16x16x32_bf16 v[24:27], v[204:207], v[124:127], v[24:27]
    v_mfma_f32_16x16x32_bf16 v[28:31], v[204:207], v[128:131], v[28:31]
    buffer_load_dwordx4 v[104:107], v20, s[20:23], s48 offen offset:0 sc1
    v_mfma_f32_16x16x32_bf16 v[32:35], v[204:207], v[132:135], v[32:35]
    v_mfma_f32_16x16x32_bf16 v[36:39], v[204:207], v[136:139], v[36:39]
    buffer_load_dwordx4 v[108:111], v20, s[20:23], s49 offen offset:0 sc1
    v_mfma_f32_16x16x32_bf16 v[40:43], v[204:207], v[140:143], v[40:43]
    ds_read_b64_tr_b16 v[204:205], v8 offset:16384
    ds_read_b64_tr_b16 v[206:207], v8 offset:16896
    s_waitcnt lgkmcnt(6)
    v_mfma_f32_16x16x32_bf16 v[44:47], v[208:211], v[124:127], v[44:47]
    buffer_load_dwordx4 v[112:115], v20, s[20:23], s50 offen offset:0 sc1
    v_mfma_f32_16x16x32_bf16 v[48:51], v[208:211], v[128:131], v[48:51]
    v_mfma_f32_16x16x32_bf16 v[52:55], v[208:211], v[132:135], v[52:55]
    buffer_load_dwordx4 v[116:119], v20, s[20:23], s51 offen offset:0 sc1
    v_mfma_f32_16x16x32_bf16 v[56:59], v[208:211], v[136:139], v[56:59]
    v_mfma_f32_16x16x32_bf16 v[60:63], v[208:211], v[140:143], v[60:63]
    buffer_load_dwordx4 v[120:123], v20, s[20:23], s52 offen offset:0 sc1
    ds_read_b64_tr_b16 v[208:209], v9 offset:16384
    ds_read_b64_tr_b16 v[210:211], v9 offset:16896
    s_waitcnt lgkmcnt(6)
    v_mfma_f32_16x16x32_bf16 v[64:67], v[212:215], v[124:127], v[64:67]
    v_mfma_f32_16x16x32_bf16 v[68:71], v[212:215], v[128:131], v[68:71]
    s_add_u32 m0, s42, 8192
    s_nop 0
    buffer_load_dwordx4 v12, s[8:11], s43 offen offset:0 lds
    v_mfma_f32_16x16x32_bf16 v[72:75], v[212:215], v[132:135], v[72:75]
    v_mfma_f32_16x16x32_bf16 v[76:79], v[212:215], v[136:139], v[76:79]
    buffer_load_dwordx4 v13, s[8:11], s43 offen offset:1024 lds
    v_mfma_f32_16x16x32_bf16 v[80:83], v[212:215], v[140:143], v[80:83]
    ds_read_b64_tr_b16 v[212:213], v10 offset:16384
    ds_read_b64_tr_b16 v[214:215], v10 offset:16896
    s_waitcnt lgkmcnt(6)
    v_mfma_f32_16x16x32_bf16 v[84:87], v[216:219], v[124:127], v[84:87]
    buffer_load_dwordx4 v14, s[8:11], s43 offen offset:2048 lds
    v_mfma_f32_16x16x32_bf16 v[88:91], v[216:219], v[128:131], v[88:91]
    v_mfma_f32_16x16x32_bf16 v[92:95], v[216:219], v[132:135], v[92:95]
    buffer_load_dwordx4 v15, s[8:11], s43 offen offset:3072 lds
    s_add_u32 s43, s43, 36864
    v_mfma_f32_16x16x32_bf16 v[96:99], v[216:219], v[136:139], v[96:99]
    v_mfma_f32_16x16x32_bf16 v[100:103], v[216:219], v[140:143], v[100:103]
    ds_read_b64_tr_b16 v[216:217], v11 offset:16384
    ds_read_b64_tr_b16 v[218:219], v11 offset:16896
    s_waitcnt vmcnt(18)
    s_waitcnt lgkmcnt(6)
    v_mfma_f32_16x16x32_bf16 v[24:27], v[204:207], v[144:147], v[24:27]
    v_mfma_f32_16x16x32_bf16 v[28:31], v[204:207], v[148:151], v[28:31]
    buffer_load_dwordx4 v[124:127], v20, s[20:23], s48 offen offset:2048 sc1
    v_mfma_f32_16x16x32_bf16 v[32:35], v[204:207], v[152:155], v[32:35]
    v_mfma_f32_16x16x32_bf16 v[36:39], v[204:207], v[156:159], v[36:39]
    buffer_load_dwordx4 v[128:131], v20, s[20:23], s49 offen offset:2048 sc1
    v_mfma_f32_16x16x32_bf16 v[40:43], v[204:207], v[160:163], v[40:43]
    ds_read_b64_tr_b16 v[204:205], v8 offset:0
    ds_read_b64_tr_b16 v[206:207], v8 offset:512
    s_waitcnt lgkmcnt(6)
    v_mfma_f32_16x16x32_bf16 v[44:47], v[208:211], v[144:147], v[44:47]
    buffer_load_dwordx4 v[132:135], v20, s[20:23], s50 offen offset:2048 sc1
    v_mfma_f32_16x16x32_bf16 v[48:51], v[208:211], v[148:151], v[48:51]
    v_mfma_f32_16x16x32_bf16 v[52:55], v[208:211], v[152:155], v[52:55]
    buffer_load_dwordx4 v[136:139], v20, s[20:23], s51 offen offset:2048 sc1
    v_mfma_f32_16x16x32_bf16 v[56:59], v[208:211], v[156:159], v[56:59]
    v_mfma_f32_16x16x32_bf16 v[60:63], v[208:211], v[160:163], v[60:63]
    buffer_load_dwordx4 v[140:143], v20, s[20:23], s52 offen offset:2048 sc1
    v_add_u32 v20, 4096, v20
    ds_read_b64_tr_b16 v[208:209], v9 offset:0
    ds_read_b64_tr_b16 v[210:211], v9 offset:512
    s_waitcnt lgkmcnt(6)
    v_mfma_f32_16x16x32_bf16 v[64:67], v[212:215], v[144:147], v[64:67]
    v_mfma_f32_16x16x32_bf16 v[68:71], v[212:215], v[148:151], v[68:71]
    v_mfma_f32_16x16x32_bf16 v[72:75], v[212:215], v[152:155], v[72:75]
    v_mfma_f32_16x16x32_bf16 v[76:79], v[212:215], v[156:159], v[76:79]
    v_mfma_f32_16x16x32_bf16 v[80:83], v[212:215], v[160:163], v[80:83]
    ds_read_b64_tr_b16 v[212:213], v10 offset:0
    ds_read_b64_tr_b16 v[214:215], v10 offset:512
    s_waitcnt lgkmcnt(6)
    v_mfma_f32_16x16x32_bf16 v[84:87], v[216:219], v[144:147], v[84:87]
    v_mfma_f32_16x16x32_bf16 v[88:91], v[216:219], v[148:151], v[88:91]
    v_mfma_f32_16x16x32_bf16 v[92:95], v[216:219], v[152:155], v[92:95]
    v_mfma_f32_16x16x32_bf16 v[96:99], v[216:219], v[156:159], v[96:99]
    v_mfma_f32_16x16x32_bf16 v[100:103], v[216:219], v[160:163], v[100:103]
    ds_read_b64_tr_b16 v[216:217], v11 offset:0
    ds_read_b64_tr_b16 v[218:219], v11 offset:512
    s_waitcnt vmcnt(14)
    s_waitcnt lgkmcnt(6)
    v_mfma_f32_16x16x32_bf16 v[24:27], v[204:207], v[164:167], v[24:27]
    v_mfma_f32_16x16x32_bf16 v[28:31], v[204:207], v[168:171], v[28:31]
    v_mfma_f32_16x16x32_bf16 v[32:35], v[204:207], v[172:175], v[32:35]
    v_mfma_f32_16x16x32_bf16 v[36:39], v[204:207], v[176:179], v[36:39]
    v_mfma_f32_16x16x32_bf16 v[40:43], v[204:207], v[180:183], v[40:43]
    ds_read_b64_tr_b16 v[204:205], v8 offset:4096
    ds_read_b64_tr_b16 v[206:207], v8 offset:4608
    s_waitcnt lgkmcnt(6)
    v_mfma_f32_16x16x32_bf16 v[44:47], v[208:211], v[164:167], v[44:47]
    v_mfma_f32_16x16x32_bf16 v[48:51], v[208:211], v[168:171], v[48:51]
    v_mfma_f32_16x16x32_bf16 v[52:55], v[208:211], v[172:175], v[52:55]
    v_mfma_f32_16x16x32_bf16 v[56:59], v[208:211], v[176:179], v[56:59]
    v_mfma_f32_16x16x32_bf16 v[60:63], v[208:211], v[180:183], v[60:63]
    ds_read_b64_tr_b16 v[208:209], v9 offset:4096
    ds_read_b64_tr_b16 v[210:211], v9 offset:4608
    s_waitcnt lgkmcnt(6)
    v_mfma_f32_16x16x32_bf16 v[64:67], v[212:215], v[164:167], v[64:67]
    v_mfma_f32_16x16x32_bf16 v[68:71], v[212:215], v[168:171], v[68:71]
    v_mfma_f32_16x16x32_bf16 v[72:75], v[212:215], v[172:175], v[72:75]
    v_mfma_f32_16x16x32_bf16 v[76:79], v[212:215], v[176:179], v[76:79]
    v_mfma_f32_16x16x32_bf16 v[80:83], v[212:215], v[180:183], v[80:83]
    ds_read_b64_tr_b16 v[212:213], v10 offset:4096
    ds_read_b64_tr_b16 v[214:215], v10 offset:4608
    s_waitcnt lgkmcnt(6)
    v_mfma_f32_16x16x32_bf16 v[84:87], v[216:219], v[164:167], v[84:87]
    v_mfma_f32_16x16x32_bf16 v[88:91], v[216:219], v[168:171], v[88:91]
    v_mfma_f32_16x16x32_bf16 v[92:95], v[216:219], v[172:175], v[92:95]
    v_mfma_f32_16x16x32_bf16 v[96:99], v[216:219], v[176:179], v[96:99]
    v_mfma_f32_16x16x32_bf16 v[100:103], v[216:219], v[180:183], v[100:103]
    ds_read_b64_tr_b16 v[216:217], v11 offset:4096
    ds_read_b64_tr_b16 v[218:219], v11 offset:4608
    s_waitcnt vmcnt(5)
    s_waitcnt lgkmcnt(6)
    v_mfma_f32_16x16x32_bf16 v[24:27], v[204:207], v[104:107], v[24:27]
    v_mfma_f32_16x16x32_bf16 v[28:31], v[204:207], v[108:111], v[28:31]
    buffer_load_dword v22, v23, s[20:23], s56 offen sc1
    v_mfma_f32_16x16x32_bf16 v[32:35], v[204:207], v[112:115], v[32:35]
    v_mfma_f32_16x16x32_bf16 v[36:39], v[204:207], v[116:119], v[36:39]
    v_mfma_f32_16x16x32_bf16 v[40:43], v[204:207], v[120:123], v[40:43]
    ds_read_b64_tr_b16 v[204:205], v8 offset:8192
    ds_read_b64_tr_b16 v[206:207], v8 offset:8704
    s_waitcnt lgkmcnt(6)
    v_mfma_f32_16x16x32_bf16 v[44:47], v[208:211], v[104:107], v[44:47]
    v_mfma_f32_16x16x32_bf16 v[48:51], v[208:211], v[108:111], v[48:51]
    v_mfma_f32_16x16x32_bf16 v[52:55], v[208:211], v[112:115], v[52:55]
    v_mfma_f32_16x16x32_bf16 v[56:59], v[208:211], v[116:119], v[56:59]
    v_mfma_f32_16x16x32_bf16 v[60:63], v[208:211], v[120:123], v[60:63]
    ds_read_b64_tr_b16 v[208:209], v9 offset:8192
    ds_read_b64_tr_b16 v[210:211], v9 offset:8704
    s_waitcnt lgkmcnt(6)
    v_mfma_f32_16x16x32_bf16 v[64:67], v[212:215], v[104:107], v[64:67]
    v_mfma_f32_16x16x32_bf16 v[68:71], v[212:215], v[108:111], v[68:71]
    v_mfma_f32_16x16x32_bf16 v[72:75], v[212:215], v[112:115], v[72:75]
    v_mfma_f32_16x16x32_bf16 v[76:79], v[212:215], v[116:119], v[76:79]
    v_mfma_f32_16x16x32_bf16 v[80:83], v[212:215], v[120:123], v[80:83]
    ds_read_b64_tr_b16 v[212:213], v10 offset:8192
    ds_read_b64_tr_b16 v[214:215], v10 offset:8704
    s_waitcnt lgkmcnt(6)
    v_mfma_f32_16x16x32_bf16 v[84:87], v[216:219], v[104:107], v[84:87]
    v_mfma_f32_16x16x32_bf16 v[88:91], v[216:219], v[108:111], v[88:91]
    v_mfma_f32_16x16x32_bf16 v[92:95], v[216:219], v[112:115], v[92:95]
    v_mfma_f32_16x16x32_bf16 v[96:99], v[216:219], v[116:119], v[96:99]
    v_mfma_f32_16x16x32_bf16 v[100:103], v[216:219], v[120:123], v[100:103]
    ds_read_b64_tr_b16 v[216:217], v11 offset:8192
    ds_read_b64_tr_b16 v[218:219], v11 offset:8704
    s_waitcnt vmcnt(1)
    s_waitcnt lgkmcnt(6)
    v_mfma_f32_16x16x32_bf16 v[24:27], v[204:207], v[124:127], v[24:27]
    v_mfma_f32_16x16x32_bf16 v[28:31], v[204:207], v[128:131], v[28:31]
    v_mfma_f32_16x16x32_bf16 v[32:35], v[204:207], v[132:135], v[32:35]
    v_mfma_f32_16x16x32_bf16 v[36:39], v[204:207], v[136:139], v[36:39]
    v_mfma_f32_16x16x32_bf16 v[40:43], v[204:207], v[140:143], v[40:43]
    s_waitcnt lgkmcnt(4)
    v_mfma_f32_16x16x32_bf16 v[44:47], v[208:211], v[124:127], v[44:47]
    v_mfma_f32_16x16x32_bf16 v[48:51], v[208:211], v[128:131], v[48:51]
    v_mfma_f32_16x16x32_bf16 v[52:55], v[208:211], v[132:135], v[52:55]
    v_mfma_f32_16x16x32_bf16 v[56:59], v[208:211], v[136:139], v[56:59]
    v_mfma_f32_16x16x32_bf16 v[60:63], v[208:211], v[140:143], v[60:63]
    s_waitcnt lgkmcnt(2)
    v_mfma_f32_16x16x32_bf16 v[64:67], v[212:215], v[124:127], v[64:67]
    v_mfma_f32_16x16x32_bf16 v[68:71], v[212:215], v[128:131], v[68:71]
    v_mfma_f32_16x16x32_bf16 v[72:75], v[212:215], v[132:135], v[72:75]
    v_mfma_f32_16x16x32_bf16 v[76:79], v[212:215], v[136:139], v[76:79]
    v_mfma_f32_16x16x32_bf16 v[80:83], v[212:215], v[140:143], v[80:83]
    s_waitcnt lgkmcnt(0)
    v_mfma_f32_16x16x32_bf16 v[84:87], v[216:219], v[124:127], v[84:87]
    v_mfma_f32_16x16x32_bf16 v[88:91], v[216:219], v[128:131], v[88:91]
    v_mfma_f32_16x16x32_bf16 v[92:95], v[216:219], v[132:135], v[92:95]
    v_mfma_f32_16x16x32_bf16 v[96:99], v[216:219], v[136:139], v[96:99]
    v_mfma_f32_16x16x32_bf16 v[100:103], v[216:219], v[140:143], v[100:103]
    s_setprio 3
    v_mov_b32 v2, v12
    v_mov_b32 v3, v13
    v_add_u32 v4, 2304, v14
    v_add_u32 v5, 2304, v15
    v_mov_b32 v250, v18
    v_mov_b32 v251, v19
    s_add_u32 s47, s46, 0
    s_and_b32 s58, s47, 1
    s_lshl_b32 s58, s58, 8
    s_lshr_b32 s47, s47, 1
    s_mul_i32 s48, s47, 36864
    s_add_u32 s48, s48, s58
    s_add_u32 s47, s46, 1
    s_and_b32 s58, s47, 1
    s_lshl_b32 s58, s58, 8
    s_lshr_b32 s47, s47, 1
    s_mul_i32 s49, s47, 36864
    s_add_u32 s49, s49, s58
    s_add_u32 s47, s46, 2
    s_and_b32 s58, s47, 1
    s_lshl_b32 s58, s58, 8
    s_lshr_b32 s47, s47, 1
    s_mul_i32 s50, s47, 36864
    s_add_u32 s50, s50, s58
    s_add_u32 s47, s46, 3
    s_and_b32 s58, s47, 1
    s_lshl_b32 s58, s58, 8
    s_lshr_b32 s47, s47, 1
    s_mul_i32 s51, s47, 36864
    s_add_u32 s51, s51, s58
    s_add_u32 s47, s46, 4
    s_and_b32 s58, s47, 1
    s_lshl_b32 s58, s58, 8
    s_lshr_b32 s47, s47, 1
    s_mul_i32 s52, s47, 36864
    s_add_u32 s52, s52, s58
    s_mul_i32 s44, s40, 165888
    s_mov_b32 s45, s44
    s_lshl_b32 s58, s40, 13
    s_add_u32 s58, s58, 4718592
    v_add_u32 v21, s58, v6
    v_add_u32 v20, 4096, v21
    s_lshl_b32 s58, s40, 10
    s_add_u32 s58, s58, 4751360
    v_add_u32 v6, s58, v6
    v_and_b32 v245, 15, v1
    v_lshlrev_b32 v245, 8, v245
    v_lshrrev_b32 v246, 4, v1
    v_and_b32 v247, 7, v1
    v_xor_b32 v246, v246, v247
    v_lshl_add_u32 v245, v246, 4, v245
    s_mul_i32 s58, s40, 20480
    v_add_u32 v12, s58, v245
    v_xor_b32 v13, 64, v12
    ds_write_b128 v12, v[24:27] offset:0
    ds_write_b128 v12, v[28:31] offset:4096
    ds_write_b128 v12, v[32:35] offset:8192
    ds_write_b128 v12, v[36:39] offset:12288
    ds_write_b128 v12, v[40:43] offset:16384
    ds_write_b128 v13, v[44:47] offset:0
    ds_write_b128 v13, v[48:51] offset:4096
    ds_write_b128 v13, v[52:55] offset:8192
    ds_write_b128 v13, v[56:59] offset:12288
    ds_write_b128 v13, v[60:63] offset:16384
    ds_write_b128 v12, v[64:67] offset:128
    ds_write_b128 v12, v[68:71] offset:4224
    ds_write_b128 v12, v[72:75] offset:8320
    ds_write_b128 v12, v[76:79] offset:12416
    ds_write_b128 v12, v[80:83] offset:16512
    ds_write_b128 v13, v[84:87] offset:128
    ds_write_b128 v13, v[88:91] offset:4224
    ds_write_b128 v13, v[92:95] offset:8320
    ds_write_b128 v13, v[96:99] offset:12416
    ds_write_b128 v13, v[100:103] offset:16512
    v_lshrrev_b32 v245, 3, v1
    s_mul_i32 s58, s40, 20
    v_add_u32 v245, s58, v245
    v_and_b32 v246, 7, v245
    v_and_b32 v247, 7, v1
    v_lshlrev_b32 v247, 1, v247
    v_xor_b32 v247, v247, v246
    v_lshlrev_b32 v245, 8, v245
    v_lshl_add_u32 v16, v247, 4, v245
    v_xor_b32 v17, 16, v16
    v_add_u32 v18, 4096, v16
    v_add_u32 v19, 4096, v17
    s_waitcnt vmcnt(0)
    v_cmp_eq_u32 vcc, 0, v22
    s_nop 1
    s_cmp_eq_u64 vcc, 0
    s_cselect_b32 s57, 1, 0
    s_cbranch_scc0 OP_LATE
    buffer_load_dwordx4 v[104:107], v21, s[20:23], s48 offen offset:0 sc1
    buffer_load_dwordx4 v[108:111], v21, s[20:23], s49 offen offset:0 sc1
    buffer_load_dwordx4 v[112:115], v21, s[20:23], s50 offen offset:0 sc1
    buffer_load_dwordx4 v[116:119], v21, s[20:23], s51 offen offset:0 sc1
    buffer_load_dwordx4 v[120:123], v21, s[20:23], s52 offen offset:0 sc1
    buffer_load_dwordx4 v[124:127], v21, s[20:23], s48 offen offset:2048 sc1
    buffer_load_dwordx4 v[128:131], v21, s[20:23], s49 offen offset:2048 sc1
    buffer_load_dwordx4 v[132:135], v21, s[20:23], s50 offen offset:2048 sc1
    buffer_load_dwordx4 v[136:139], v21, s[20:23], s51 offen offset:2048 sc1
    buffer_load_dwordx4 v[140:143], v21, s[20:23], s52 offen offset:2048 sc1
    buffer_load_dwordx4 v[144:147], v20, s[20:23], s48 offen offset:0 sc1
    buffer_load_dwordx4 v[148:151], v20, s[20:23], s49 offen offset:0 sc1
    buffer_load_dwordx4 v[152:155], v20, s[20:23], s50 offen offset:0 sc1
    buffer_load_dwordx4 v[156:159], v20, s[20:23], s51 offen offset:0 sc1
    buffer_load_dwordx4 v[160:163], v20, s[20:23], s52 offen offset:0 sc1
    buffer_load_dwordx4 v[164:167], v20, s[20:23], s48 offen offset:2048 sc1
    buffer_load_dwordx4 v[168:171], v20, s[20:23], s49 offen offset:2048 sc1
    buffer_load_dwordx4 v[172:175], v20, s[20:23], s50 offen offset:2048 sc1
    buffer_load_dwordx4 v[176:179], v20, s[20:23], s51 offen offset:2048 sc1
    buffer_load_dwordx4 v[180:183], v20, s[20:23], s52 offen offset:2048 sc1
    s_mov_b32 exec_hi, 0
    buffer_load_dwordx4 v[184:187], v6, s[20:23], s48 offen sc1
    buffer_load_dwordx4 v[188:191], v6, s[20:23], s49 offen sc1
    buffer_load_dwordx4 v[192:195], v6, s[20:23], s50 offen sc1
    buffer_load_dwordx4 v[196:199], v6, s[20:23], s51 offen sc1
    buffer_load_dwordx4 v[200:203], v6, s[20:23], s52 offen sc1
    s_mov_b32 exec_hi, -1
OP_LATE:
    s_waitcnt lgkmcnt(0)
    s_barrier
    ds_read_b128 v[24:27], v16 offset:0
    ds_read_b128 v[28:31], v17 offset:0
    ds_read_b128 v[32:35], v16 offset:20480
    ds_read_b128 v[36:39], v17 offset:20480
    ds_read_b128 v[40:43], v16 offset:40960
    ds_read_b128 v[44:47], v17 offset:40960
    ds_read_b128 v[48:51], v16 offset:61440
    ds_read_b128 v[52:55], v17 offset:61440
    ds_read_b128 v[56:59], v16 offset:2048
    ds_read_b128 v[60:63], v17 offset:2048
    ds_read_b128 v[64:67], v16 offset:22528
    ds_read_b128 v[68:71], v17 offset:22528
    ds_read_b128 v[72:75], v16 offset:43008
    ds_read_b128 v[76:79], v17 offset:43008
    ds_read_b128 v[80:83], v16 offset:63488
    ds_read_b128 v[84:87], v17 offset:63488
    s_mov_b32 exec_hi, 0
    ds_read_b128 v[88:91], v18 offset:0
    ds_read_b128 v[92:95], v19 offset:0
    ds_read_b128 v[96:99], v18 offset:20480
    ds_read_b128 v[100:103], v19 offset:20480
    ds_read_b128 v[204:207], v18 offset:40960
    ds_read_b128 v[208:211], v19 offset:40960
    ds_read_b128 v[212:215], v18 offset:61440
    ds_read_b128 v[216:219], v19 offset:61440
    s_mov_b32 exec_hi, -1
    s_waitcnt lgkmcnt(0)
    s_barrier
    s_add_u32 m0, s42, 0
    s_nop 0
    buffer_load_dwordx4 v2, s[16:19], s44 offen offset:0 lds
    buffer_load_dwordx4 v3, s[16:19], s44 offen offset:1024 lds
    buffer_load_dwordx4 v4, s[16:19], s44 offen offset:2048 lds
    buffer_load_dwordx4 v5, s[16:19], s44 offen offset:3072 lds
    s_add_u32 s44, s44, 41472
    s_add_u32 m0, s42, 4096
    s_nop 0
    buffer_load_dwordx4 v2, s[16:19], s44 offen offset:0 lds
    buffer_load_dwordx4 v3, s[16:19], s44 offen offset:1024 lds
    buffer_load_dwordx4 v4, s[16:19], s44 offen offset:2048 lds
    buffer_load_dwordx4 v5, s[16:19], s44 offen offset:3072 lds
    s_add_u32 s44, s44, 41472
    s_add_u32 m0, s42, 8192
    s_nop 0
    buffer_load_dwordx4 v2, s[16:19], s44 offen offset:0 lds
    buffer_load_dwordx4 v3, s[16:19], s44 offen offset:1024 lds
    buffer_load_dwordx4 v4, s[16:19], s44 offen offset:2048 lds
    buffer_load_dwordx4 v5, s[16:19], s44 offen offset:3072 lds
    s_add_u32 s44, s44, 41472
    s_add_u32 m0, s42, 12288
    s_nop 0
    buffer_load_dwordx4 v2, s[16:19], s44 offen offset:0 lds
    buffer_load_dwordx4 v3, s[16:19], s44 offen offset:1024 lds
    buffer_load_dwordx4 v4, s[16:19], s44 offen offset:2048 lds
    buffer_load_dwordx4 v5, s[16:19], s44 offen offset:3072 lds
    s_add_u32 s44, s44, 41472
    s_add_u32 m0, s42, 16384
    s_nop 0
    buffer_load_dwordx4 v250, s[16:19], s45 offen offset:0 lds
    buffer_load_dwordx4 v251, s[16:19], s45 offen offset:1024 lds
    buffer_load_dwordx4 v4, s[16:19], s45 offen offset:2048 lds
    buffer_load_dwordx4 v5, s[16:19], s45 offen offset:3072 lds
    s_mov_b32 s58, 0xbfb8aa3b
    v_add_f32 v88, v88, v96
    v_add_f32 v204, v204, v212
    v_add_f32 v89, v89, v97
    v_add_f32 v205, v205, v213
    v_add_f32 v90, v90, v98
    v_add_f32 v206, v206, v214
    v_add_f32 v91, v91, v99
    v_add_f32 v207, v207, v215
    v_add_f32 v92, v92, v100
    v_add_f32 v208, v208, v216
    v_add_f32 v93, v93, v101
    v_add_f32 v209, v209, v217
    v_add_f32 v94, v94, v102
    v_add_f32 v210, v210, v218
    v_add_f32 v95, v95, v103
    v_add_f32 v211, v211, v219
    v_add_f32 v88, v88, v204
    v_add_f32 v89, v89, v205
    v_add_f32 v90, v90, v206
    v_add_f32 v91, v91, v207
    v_add_f32 v92, v92, v208
    v_add_f32 v93, v93, v209
    v_add_f32 v94, v94, v210
    v_add_f32 v95, v95, v211
    v_mul_f32 v96, s58, v88
    v_mul_f32 v97, s58, v89
    v_mul_f32 v98, s58, v90
    v_mul_f32 v99, s58, v91
    v_mul_f32 v100, s58, v92
    v_mul_f32 v101, s58, v93
    v_mul_f32 v102, s58, v94
    v_mul_f32 v103, s58, v95
    v_exp_f32 v96, v96
    v_exp_f32 v97, v97
    v_exp_f32 v98, v98
    v_exp_f32 v99, v99
    v_exp_f32 v100, v100
    v_exp_f32 v101, v101
    v_exp_f32 v102, v102
    v_exp_f32 v103, v103
    v_add_f32 v96, 1.0, v96
    v_add_f32 v97, 1.0, v97
    v_add_f32 v98, 1.0, v98
    v_add_f32 v99, 1.0, v99
    v_add_f32 v100, 1.0, v100
    v_add_f32 v101, 1.0, v101
    v_add_f32 v102, 1.0, v102
    v_add_f32 v103, 1.0, v103
    v_rcp_f32 v96, v96
    v_rcp_f32 v97, v97
    v_rcp_f32 v98, v98
    v_rcp_f32 v99, v99
    v_rcp_f32 v100, v100
    v_rcp_f32 v101, v101
    v_rcp_f32 v102, v102
    v_rcp_f32 v103, v103
    v_mul_f32 v88, v88, v96
    v_mul_f32 v89, v89, v97
    v_mul_f32 v90, v90, v98
    v_mul_f32 v91, v91, v99
    v_mul_f32 v92, v92, v100
    v_mul_f32 v93, v93, v101
    v_mul_f32 v94, v94, v102
    v_mul_f32 v95, v95, v103
    v_cvt_pk_bf16_f32 v228, v88, v89
    v_cvt_pk_bf16_f32 v229, v90, v91
    v_cvt_pk_bf16_f32 v230, v92, v93
    v_cvt_pk_bf16_f32 v231, v94, v95
    v_add_f32 v24, v24, v32
    v_add_f32 v40, v40, v48
    v_add_f32 v25, v25, v33
    v_add_f32 v41, v41, v49
    v_add_f32 v26, v26, v34
    v_add_f32 v42, v42, v50
    v_add_f32 v27, v27, v35
    v_add_f32 v43, v43, v51
    v_add_f32 v28, v28, v36
    v_add_f32 v44, v44, v52
    v_add_f32 v29, v29, v37
    v_add_f32 v45, v45, v53
    v_add_f32 v30, v30, v38
    v_add_f32 v46, v46, v54
    v_add_f32 v31, v31, v39
    v_add_f32 v47, v47, v55
    v_add_f32 v24, v24, v40
    v_add_f32 v25, v25, v41
    v_add_f32 v26, v26, v42
    v_add_f32 v27, v27, v43
    v_add_f32 v28, v28, v44
    v_add_f32 v29, v29, v45
    v_add_f32 v30, v30, v46
    v_add_f32 v31, v31, v47
    v_mul_f32 v32, s58, v24
    v_mul_f32 v33, s58, v25
    v_mul_f32 v34, s58, v26
    v_mul_f32 v35, s58, v27
    v_mul_f32 v36, s58, v28
    v_mul_f32 v37, s58, v29
    v_mul_f32 v38, s58, v30
    v_mul_f32 v39, s58, v31
    v_exp_f32 v32, v32
    v_exp_f32 v33, v33
    v_exp_f32 v34, v34
    v_exp_f32 v35, v35
    v_exp_f32 v36, v36
    v_exp_f32 v37, v37
    v_exp_f32 v38, v38
    v_exp_f32 v39, v39
    v_add_f32 v32, 1.0, v32
    v_add_f32 v33, 1.0, v33
    v_add_f32 v34, 1.0, v34
    v_add_f32 v35, 1.0, v35
    v_add_f32 v36, 1.0, v36
    v_add_f32 v37, 1.0, v37
    v_add_f32 v38, 1.0, v38
    v_add_f32 v39, 1.0, v39
    v_rcp_f32 v32, v32
    v_rcp_f32 v33, v33
    v_rcp_f32 v34, v34
    v_rcp_f32 v35, v35
    v_rcp_f32 v36, v36
    v_rcp_f32 v37, v37
    v_rcp_f32 v38, v38
    v_rcp_f32 v39, v39
    v_mul_f32 v24, v24, v32
    v_mul_f32 v25, v25, v33
    v_mul_f32 v26, v26, v34
    v_mul_f32 v27, v27, v35
    v_mul_f32 v28, v28, v36
    v_mul_f32 v29, v29, v37
    v_mul_f32 v30, v30, v38
    v_mul_f32 v31, v31, v39
    v_cvt_pk_bf16_f32 v220, v24, v25
    v_cvt_pk_bf16_f32 v221, v26, v27
    v_cvt_pk_bf16_f32 v222, v28, v29
    v_cvt_pk_bf16_f32 v223, v30, v31
    v_add_f32 v56, v56, v64
    v_add_f32 v72, v72, v80
    v_add_f32 v57, v57, v65
    v_add_f32 v73, v73, v81
    v_add_f32 v58, v58, v66
    v_add_f32 v74, v74, v82
    v_add_f32 v59, v59, v67
    v_add_f32 v75, v75, v83
    v_add_f32 v60, v60, v68
    v_add_f32 v76, v76, v84
    v_add_f32 v61, v61, v69
    v_add_f32 v77, v77, v85
    v_add_f32 v62, v62, v70
    v_add_f32 v78, v78, v86
    v_add_f32 v63, v63, v71
    v_add_f32 v79, v79, v87
    v_add_f32 v56, v56, v72
    v_add_f32 v57, v57, v73
    v_add_f32 v58, v58, v74
    v_add_f32 v59, v59, v75
    v_add_f32 v60, v60, v76
    v_add_f32 v61, v61, v77
    v_add_f32 v62, v62, v78
    v_add_f32 v63, v63, v79
    v_mul_f32 v64, s58, v56
    v_mul_f32 v65, s58, v57
    v_mul_f32 v66, s58, v58
    v_mul_f32 v67, s58, v59
    v_mul_f32 v68, s58, v60
    v_mul_f32 v69, s58, v61
    v_mul_f32 v70, s58, v62
    v_mul_f32 v71, s58, v63
    v_exp_f32 v64, v64
    v_exp_f32 v65, v65
    v_exp_f32 v66, v66
    v_exp_f32 v67, v67
    v_exp_f32 v68, v68
    v_exp_f32 v69, v69
    v_exp_f32 v70, v70
    v_exp_f32 v71, v71
    v_add_f32 v64, 1.0, v64
    v_add_f32 v65, 1.0, v65
    v_add_f32 v66, 1.0, v66
    v_add_f32 v67, 1.0, v67
    v_add_f32 v68, 1.0, v68
    v_add_f32 v69, 1.0, v69
    v_add_f32 v70, 1.0, v70
    v_add_f32 v71, 1.0, v71
    v_rcp_f32 v64, v64
    v_rcp_f32 v65, v65
    v_rcp_f32 v66, v66
    v_rcp_f32 v67, v67
    v_rcp_f32 v68, v68
    v_rcp_f32 v69, v69
    v_rcp_f32 v70, v70
    v_rcp_f32 v71, v71
    v_mul_f32 v56, v56, v64
    v_mul_f32 v57, v57, v65
    v_mul_f32 v58, v58, v66
    v_mul_f32 v59, v59, v67
    v_mul_f32 v60, v60, v68
    v_mul_f32 v61, v61, v69
    v_mul_f32 v62, v62, v70
    v_mul_f32 v63, v63, v71
    v_cvt_pk_bf16_f32 v224, v56, v57
    v_cvt_pk_bf16_f32 v225, v58, v59
    v_cvt_pk_bf16_f32 v226, v60, v61
    v_cvt_pk_bf16_f32 v227, v62, v63
    s_cmp_lg_u32 s57, 0
    s_cbranch_scc1 OP_HAVE
    s_mov_b32 s47, 0
    buffer_load_dword v22, v23, s[20:23], s56 offen sc1
OPO_P:
    s_waitcnt vmcnt(0)
    v_cmp_eq_u32 vcc, 0, v22
    s_nop 1
    s_cmp_eq_u64 vcc, 0
    s_cbranch_scc1 OPO_OK
    s_add_u32 s47, s47, 1
    s_cmp_ge_u32 s47, 0x40000
    s_cbranch_scc1 OPO_OK
    s_sleep 4
    buffer_load_dword v22, v23, s[20:23], s56 offen sc1
    s_branch OPO_P
OPO_OK:
    buffer_load_dwordx4 v[104:107], v21, s[20:23], s48 offen offset:0 sc1
    buffer_load_dwordx4 v[108:111], v21, s[20:23], s49 offen offset:0 sc1
    buffer_load_dwordx4 v[112:115], v21, s[20:23], s50 offen offset:0 sc1
    buffer_load_dwordx4 v[116:119], v21, s[20:23], s51 offen offset:0 sc1
    buffer_load_dwordx4 v[120:123], v21, s[20:23], s52 offen offset:0 sc1
    buffer_load_dwordx4 v[124:127], v21, s[20:23], s48 offen offset:2048 sc1
    buffer_load_dwordx4 v[128:131], v21, s[20:23], s49 offen offset:2048 sc1
    buffer_load_dwordx4 v[132:135], v21, s[20:23], s50 offen offset:2048 sc1
    buffer_load_dwordx4 v[136:139], v21, s[20:23], s51 offen offset:2048 sc1
    buffer_load_dwordx4 v[140:143], v21, s[20:23], s52 offen offset:2048 sc1
    buffer_load_dwordx4 v[144:147], v20, s[20:23], s48 offen offset:0 sc1
    buffer_load_dwordx4 v[148:151], v20, s[20:23], s49 offen offset:0 sc1
    buffer_load_dwordx4 v[152:155], v20, s[20:23], s50 offen offset:0 sc1
    buffer_load_dwordx4 v[156:159], v20, s[20:23], s51 offen offset:0 sc1
    buffer_load_dwordx4 v[160:163], v20, s[20:23], s52 offen offset:0 sc1
    buffer_load_dwordx4 v[164:167], v20, s[20:23], s48 offen offset:2048 sc1
    buffer_load_dwordx4 v[168:171], v20, s[20:23], s49 offen offset:2048 sc1
    buffer_load_dwordx4 v[172:175], v20, s[20:23], s50 offen offset:2048 sc1
    buffer_load_dwordx4 v[176:179], v20, s[20:23], s51 offen offset:2048 sc1
    buffer_load_dwordx4 v[180:183], v20, s[20:23], s52 offen offset:2048 sc1
    s_mov_b32 exec_hi, 0
    buffer_load_dwordx4 v[184:187], v6, s[20:23], s48 offen sc1
    buffer_load_dwordx4 v[188:191], v6, s[20:23], s49 offen sc1
    buffer_load_dwordx4 v[192:195], v6, s[20:23], s50 offen sc1
    buffer_load_dwordx4 v[196:199], v6, s[20:23], s51 offen sc1
    buffer_load_dwordx4 v[200:203], v6, s[20:23], s52 offen sc1
    s_mov_b32 exec_hi, -1
OP_HAVE:
    s_waitcnt vmcnt(15)
    ds_read_b64_tr_b16 v[204:205], v8 offset:0
    ds_read_b64_tr_b16 v[206:207], v8 offset:512
    ds_read_b64_tr_b16 v[208:209], v9 offset:0
    ds_read_b64_tr_b16 v[210:211], v9 offset:512
    ds_read_b64_tr_b16 v[212:213], v10 offset:0
    ds_read_b64_tr_b16 v[214:215], v10 offset:512
    ds_read_b64_tr_b16 v[216:217], v11 offset:0
    ds_read_b64_tr_b16 v[218:219], v11 offset:512
    s_waitcnt vmcnt(12)
    s_waitcnt lgkmcnt(6)
    v_mfma_f32_16x16x32_bf16 v[24:27], v[204:207], v[104:107], 0
    v_mfma_f32_16x16x32_bf16 v[28:31], v[204:207], v[108:111], 0
    v_mfma_f32_16x16x32_bf16 v[32:35], v[204:207], v[112:115], 0
    v_mfma_f32_16x16x32_bf16 v[36:39], v[204:207], v[116:119], 0
    v_mfma_f32_16x16x32_bf16 v[40:43], v[204:207], v[120:123], 0
    ds_read_b64_tr_b16 v[204:205], v8 offset:4096
    ds_read_b64_tr_b16 v[206:207], v8 offset:4608
    s_waitcnt lgkmcnt(6)
    v_mfma_f32_16x16x32_bf16 v[44:47], v[208:211], v[104:107], 0
    v_mfma_f32_16x16x32_bf16 v[48:51], v[208:211], v[108:111], 0
    v_mfma_f32_16x16x32_bf16 v[52:55], v[208:211], v[112:115], 0
    v_mfma_f32_16x16x32_bf16 v[56:59], v[208:211], v[116:119], 0
    v_mfma_f32_16x16x32_bf16 v[60:63], v[208:211], v[120:123], 0
    ds_read_b64_tr_b16 v[208:209], v9 offset:4096
    ds_read_b64_tr_b16 v[210:211], v9 offset:4608
    s_waitcnt lgkmcnt(6)
    v_mfma_f32_16x16x32_bf16 v[64:67], v[212:215], v[104:107], 0
    v_mfma_f32_16x16x32_bf16 v[68:71], v[212:215], v[108:111], 0
    v_mfma_f32_16x16x32_bf16 v[72:75], v[212:215], v[112:115], 0
    v_mfma_f32_16x16x32_bf16 v[76:79], v[212:215], v[116:119], 0
    v_mfma_f32_16x16x32_bf16 v[80:83], v[212:215], v[120:123], 0
    ds_read_b64_tr_b16 v[212:213], v10 offset:4096
    ds_read_b64_tr_b16 v[214:215], v10 offset:4608
    s_waitcnt lgkmcnt(6)
    v_mfma_f32_16x16x32_bf16 v[84:87], v[216:219], v[104:107], 0
    v_mfma_f32_16x16x32_bf16 v[88:91], v[216:219], v[108:111], 0
    v_mfma_f32_16x16x32_bf16 v[92:95], v[216:219], v[112:115], 0
    v_mfma_f32_16x16x32_bf16 v[96:99], v[216:219], v[116:119], 0
    v_mfma_f32_16x16x32_bf16 v[100:103], v[216:219], v[120:123], 0
    ds_read_b64_tr_b16 v[216:217], v11 offset:4096
    ds_read_b64_tr_b16 v[218:219], v11 offset:4608
    s_waitcnt vmcnt(8)
    s_waitcnt lgkmcnt(6)
    v_mfma_f32_16x16x32_bf16 v[24:27], v[204:207], v[124:127], v[24:27]
    v_mfma_f32_16x16x32_bf16 v[28:31], v[204:207], v[128:131], v[28:31]
    v_mfma_f32_16x16x32_bf16 v[32:35], v[204:207], v[132:135], v[32:35]
    v_mfma_f32_16x16x32_bf16 v[36:39], v[204:207], v[136:139], v[36:39]
    v_mfma_f32_16x16x32_bf16 v[40:43], v[204:207], v[140:143], v[40:43]
    ds_read_b64_tr_b16 v[204:205], v8 offset:8192
    ds_read_b64_tr_b16 v[206:207], v8 offset:8704
    s_waitcnt lgkmcnt(6)
    v_mfma_f32_16x16x32_bf16 v[44:47], v[208:211], v[124:127], v[44:47]
    v_mfma_f32_16x16x32_bf16 v[48:51], v[208:211], v[128:131], v[48:51]
    v_mfma_f32_16x16x32_bf16 v[52:55], v[208:211], v[132:135], v[52:55]
    v_mfma_f32_16x16x32_bf16 v[56:59], v[208:211], v[136:139], v[56:59]
    v_mfma_f32_16x16x32_bf16 v[60:63], v[208:211], v[140:143], v[60:63]
    ds_read_b64_tr_b16 v[208:209], v9 offset:8192
    ds_read_b64_tr_b16 v[210:211], v9 offset:8704
    s_waitcnt lgkmcnt(6)
    v_mfma_f32_16x16x32_bf16 v[64:67], v[212:215], v[124:127], v[64:67]
    v_mfma_f32_16x16x32_bf16 v[68:71], v[212:215], v[128:131], v[68:71]
    v_mfma_f32_16x16x32_bf16 v[72:75], v[212:215], v[132:135], v[72:75]
    v_mfma_f32_16x16x32_bf16 v[76:79], v[212:215], v[136:139], v[76:79]
    v_mfma_f32_16x16x32_bf16 v[80:83], v[212:215], v[140:143], v[80:83]
    ds_read_b64_tr_b16 v[212:213], v10 offset:8192
    ds_read_b64_tr_b16 v[214:215], v10 offset:8704
    s_waitcnt lgkmcnt(6)
    v_mfma_f32_16x16x32_bf16 v[84:87], v[216:219], v[124:127], v[84:87]
    v_mfma_f32_16x16x32_bf16 v[88:91], v[216:219], v[128:131], v[88:91]
    v_mfma_f32_16x16x32_bf16 v[92:95], v[216:219], v[132:135], v[92:95]
    v_mfma_f32_16x16x32_bf16 v[96:99], v[216:219], v[136:139], v[96:99]
    v_mfma_f32_16x16x32_bf16 v[100:103], v[216:219], v[140:143], v[100:103]
    ds_read_b64_tr_b16 v[216:217], v11 offset:8192
    ds_read_b64_tr_b16 v[218:219], v11 offset:8704
    s_waitcnt vmcnt(4)
    s_waitcnt lgkmcnt(6)
    v_mfma_f32_16x16x32_bf16 v[24:27], v[204:207], v[144:147], v[24:27]
    v_mfma_f32_16x16x32_bf16 v[28:31], v[204:207], v[148:151], v[28:31]
    v_mfma_f32_16x16x32_bf16 v[32:35], v[204:207], v[152:155], v[32:35]
    v_mfma_f32_16x16x32_bf16 v[36:39], v[204:207], v[156:159], v[36:39]
    v_mfma_f32_16x16x32_bf16 v[40:43], v[204:207], v[160:163], v[40:43]
    ds_read_b64_tr_b16 v[204:205], v8 offset:12288
    ds_read_b64_tr_b16 v[206:207], v8 offset:12800
    s_waitcnt lgkmcnt(6)
    v_mfma_f32_16x16x32_bf16 v[44:47], v[208:211], v[144:147], v[44:47]
    v_mfma_f32_16x16x32_bf16 v[48:51], v[208:211], v[148:151], v[48:51]
    v_mfma_f32_16x16x32_bf16 v[52:55], v[208:211], v[152:155], v[52:55]
    v_mfma_f32_16x16x32_bf16 v[56:59], v[208:211], v[156:159], v[56:59]
    v_mfma_f32_16x16x32_bf16 v[60:63], v[208:211], v[160:163], v[60:63]
    ds_read_b64_tr_b16 v[208:209], v9 offset:12288
    ds_read_b64_tr_b16 v[210:211], v9 offset:12800
    s_waitcnt lgkmcnt(6)
    v_mfma_f32_16x16x32_bf16 v[64:67], v[212:215], v[144:147], v[64:67]
    v_mfma_f32_16x16x32_bf16 v[68:71], v[212:215], v[148:151], v[68:71]
    v_mfma_f32_16x16x32_bf16 v[72:75], v[212:215], v[152:155], v[72:75]
    v_mfma_f32_16x16x32_bf16 v[76:79], v[212:215], v[156:159], v[76:79]
    v_mfma_f32_16x16x32_bf16 v[80:83], v[212:215], v[160:163], v[80:83]
    ds_read_b64_tr_b16 v[212:213], v10 offset:12288
    ds_read_b64_tr_b16 v[214:215], v10 offset:12800
    s_waitcnt lgkmcnt(6)
    v_mfma_f32_16x16x32_bf16 v[84:87], v[216:219], v[144:147], v[84:87]
    v_mfma_f32_16x16x32_bf16 v[88:91], v[216:219], v[148:151], v[88:91]
    v_mfma_f32_16x16x32_bf16 v[92:95], v[216:219], v[152:155], v[92:95]
    v_mfma_f32_16x16x32_bf16 v[96:99], v[216:219], v[156:159], v[96:99]
    v_mfma_f32_16x16x32_bf16 v[100:103], v[216:219], v[160:163], v[100:103]
    ds_read_b64_tr_b16 v[216:217], v11 offset:12288
    ds_read_b64_tr_b16 v[218:219], v11 offset:12800
    s_waitcnt vmcnt(0)
    s_waitcnt lgkmcnt(6)
    v_mfma_f32_16x16x32_bf16 v[24:27], v[204:207], v[164:167], v[24:27]
    v_mfma_f32_16x16x32_bf16 v[28:31], v[204:207], v[168:171], v[28:31]
    v_mfma_f32_16x16x32_bf16 v[32:35], v[204:207], v[172:175], v[32:35]
    v_mfma_f32_16x16x32_bf16 v[36:39], v[204:207], v[176:179], v[36:39]
    v_mfma_f32_16x16x32_bf16 v[40:43], v[204:207], v[180:183], v[40:43]
    ds_read_b64_tr_b16 v[204:205], v8 offset:16384
    ds_read_b64_tr_b16 v[206:207], v8 offset:16896
    s_waitcnt lgkmcnt(6)
    v_mfma_f32_16x16x32_bf16 v[44:47], v[208:211], v[164:167], v[44:47]
    v_mfma_f32_16x16x32_bf16 v[48:51], v[208:211], v[168:171], v[48:51]
    v_mfma_f32_16x16x32_bf16 v[52:55], v[208:211], v[172:175], v[52:55]
    v_mfma_f32_16x16x32_bf16 v[56:59], v[208:211], v[176:179], v[56:59]
    v_mfma_f32_16x16x32_bf16 v[60:63], v[208:211], v[180:183], v[60:63]
    ds_read_b64_tr_b16 v[208:209], v9 offset:16384
    ds_read_b64_tr_b16 v[210:211], v9 offset:16896
    s_waitcnt lgkmcnt(6)
    v_mfma_f32_16x16x32_bf16 v[64:67], v[212:215], v[164:167], v[64:67]
    v_mfma_f32_16x16x32_bf16 v[68:71], v[212:215], v[168:171], v[68:71]
    v_mfma_f32_16x16x32_bf16 v[72:75], v[212:215], v[172:175], v[72:75]
    v_mfma_f32_16x16x32_bf16 v[76:79], v[212:215], v[176:179], v[76:79]
    v_mfma_f32_16x16x32_bf16 v[80:83], v[212:215], v[180:183], v[80:83]
    ds_read_b64_tr_b16 v[212:213], v10 offset:16384
    ds_read_b64_tr_b16 v[214:215], v10 offset:16896
    s_waitcnt lgkmcnt(6)
    v_mfma_f32_16x16x32_bf16 v[84:87], v[216:219], v[164:167], v[84:87]
    v_mfma_f32_16x16x32_bf16 v[88:91], v[216:219], v[168:171], v[88:91]
    v_mfma_f32_16x16x32_bf16 v[92:95], v[216:219], v[172:175], v[92:95]
    v_mfma_f32_16x16x32_bf16 v[96:99], v[216:219], v[176:179], v[96:99]
    v_mfma_f32_16x16x32_bf16 v[100:103], v[216:219], v[180:183], v[100:103]
    ds_read_b64_tr_b16 v[216:217], v11 offset:16384
    ds_read_b64_tr_b16 v[218:219], v11 offset:16896
    s_waitcnt vmcnt(0)
    s_waitcnt lgkmcnt(6)
    v_mfma_f32_16x16x32_bf16 v[24:27], v[204:207], v[184:187], v[24:27]
    v_mfma_f32_16x16x32_bf16 v[28:31], v[204:207], v[188:191], v[28:31]
    v_mfma_f32_16x16x32_bf16 v[32:35], v[204:207], v[192:195], v[32:35]
    v_mfma_f32_16x16x32_bf16 v[36:39], v[204:207], v[196:199], v[36:39]
    v_mfma_f32_16x16x32_bf16 v[40:43], v[204:207], v[200:203], v[40:43]
    s_waitcnt lgkmcnt(4)
    v_mfma_f32_16x16x32_bf16 v[44:47], v[208:211], v[184:187], v[44:47]
    v_mfma_f32_16x16x32_bf16 v[48:51], v[208:211], v[188:191], v[48:51]
    v_mfma_f32_16x16x32_bf16 v[52:55], v[208:211], v[192:195], v[52:55]
    v_mfma_f32_16x16x32_bf16 v[56:59], v[208:211], v[196:199], v[56:59]
    v_mfma_f32_16x16x32_bf16 v[60:63], v[208:211], v[200:203], v[60:63]
    s_waitcnt lgkmcnt(2)
    v_mfma_f32_16x16x32_bf16 v[64:67], v[212:215], v[184:187], v[64:67]
    v_mfma_f32_16x16x32_bf16 v[68:71], v[212:215], v[188:191], v[68:71]
    v_mfma_f32_16x16x32_bf16 v[72:75], v[212:215], v[192:195], v[72:75]
    v_mfma_f32_16x16x32_bf16 v[76:79], v[212:215], v[196:199], v[76:79]
    v_mfma_f32_16x16x32_bf16 v[80:83], v[212:215], v[200:203], v[80:83]
    s_waitcnt lgkmcnt(0)
    v_mfma_f32_16x16x32_bf16 v[84:87], v[216:219], v[184:187], v[84:87]
    v_mfma_f32_16x16x32_bf16 v[88:91], v[216:219], v[188:191], v[88:91]
    v_mfma_f32_16x16x32_bf16 v[92:95], v[216:219], v[192:195], v[92:95]
    v_mfma_f32_16x16x32_bf16 v[96:99], v[216:219], v[196:199], v[96:99]
    v_mfma_f32_16x16x32_bf16 v[100:103], v[216:219], v[200:203], v[100:103]
    ds_write_b128 v12, v[24:27] offset:0
    ds_write_b128 v12, v[28:31] offset:4096
    ds_write_b128 v12, v[32:35] offset:8192
    ds_write_b128 v12, v[36:39] offset:12288
    ds_write_b128 v12, v[40:43] offset:16384
    ds_write_b128 v13, v[44:47] offset:0
    ds_write_b128 v13, v[48:51] offset:4096
    ds_write_b128 v13, v[52:55] offset:8192
    ds_write_b128 v13, v[56:59] offset:12288
    ds_write_b128 v13, v[60:63] offset:16384
    ds_write_b128 v12, v[64:67] offset:128
    ds_write_b128 v12, v[68:71] offset:4224
    ds_write_b128 v12, v[72:75] offset:8320
    ds_write_b128 v12, v[76:79] offset:12416
    ds_write_b128 v12, v[80:83] offset:16512
    ds_write_b128 v13, v[84:87] offset:128
    ds_write_b128 v13, v[88:91] offset:4224
    ds_write_b128 v13, v[92:95] offset:8320
    ds_write_b128 v13, v[96:99] offset:12416
    ds_write_b128 v13, v[100:103] offset:16512
    s_waitcnt lgkmcnt(0)
    s_barrier
    ds_read_b128 v[104:107], v16 offset:0
    ds_read_b128 v[108:111], v17 offset:0
    ds_read_b128 v[112:115], v16 offset:20480
    ds_read_b128 v[116:119], v17 offset:20480
    ds_read_b128 v[120:123], v16 offset:40960
    ds_read_b128 v[124:127], v17 offset:40960
    ds_read_b128 v[128:131], v16 offset:61440
    ds_read_b128 v[132:135], v17 offset:61440
    ds_read_b128 v[136:139], v16 offset:2048
    ds_read_b128 v[140:143], v17 offset:2048
    ds_read_b128 v[144:147], v16 offset:22528
    ds_read_b128 v[148:151], v17 offset:22528
    ds_read_b128 v[152:155], v16 offset:43008
    ds_read_b128 v[156:159], v17 offset:43008
    ds_read_b128 v[160:163], v16 offset:63488
    ds_read_b128 v[164:167], v17 offset:63488
    s_mov_b32 exec_hi, 0
    ds_read_b128 v[168:171], v18 offset:0
    ds_read_b128 v[172:175], v19 offset:0
    ds_read_b128 v[176:179], v18 offset:20480
    ds_read_b128 v[180:183], v19 offset:20480
    ds_read_b128 v[184:187], v18 offset:40960
    ds_read_b128 v[188:191], v19 offset:40960
    ds_read_b128 v[192:195], v18 offset:61440
    ds_read_b128 v[196:199], v19 offset:61440
    s_mov_b32 exec_hi, -1
    v_lshlrev_b32 v24, 16, v232
    v_and_b32 v25, 0xffff0000, v232
    v_lshlrev_b32 v32, 16, v220
    v_and_b32 v33, 0xffff0000, v220
    v_lshlrev_b32 v26, 16, v233
    v_and_b32 v27, 0xffff0000, v233
    v_lshlrev_b32 v34, 16, v221
    v_and_b32 v35, 0xffff0000, v221
    v_lshlrev_b32 v28, 16, v234
    v_and_b32 v29, 0xffff0000, v234
    v_lshlrev_b32 v36, 16, v222
    v_and_b32 v37, 0xffff0000, v222
    v_lshlrev_b32 v30, 16, v235
    v_and_b32 v31, 0xffff0000, v235
    v_lshlrev_b32 v38, 16, v223
    v_and_b32 v39, 0xffff0000, v223
    s_waitcnt lgkmcnt(15)
    v_add_f32 v104, v104, v112
    v_add_f32 v120, v120, v128
    v_add_f32 v105, v105, v113
    v_add_f32 v121, v121, v129
    v_add_f32 v106, v106, v114
    v_add_f32 v122, v122, v130
    v_add_f32 v107, v107, v115
    v_add_f32 v123, v123, v131
    v_add_f32 v108, v108, v116
    v_add_f32 v124, v124, v132
    v_add_f32 v109, v109, v117
    v_add_f32 v125, v125, v133
    v_add_f32 v110, v110, v118
    v_add_f32 v126, v126, v134
    v_add_f32 v111, v111, v119
    v_add_f32 v127, v127, v135
    v_add_f32 v104, v104, v120
    v_add_f32 v105, v105, v121
    v_add_f32 v106, v106, v122
    v_add_f32 v107, v107, v123
    v_add_f32 v108, v108, v124
    v_add_f32 v109, v109, v125
    v_add_f32 v110, v110, v126
    v_add_f32 v111, v111, v127
    v_fmac_f32 v24, v104, v32
    v_fmac_f32 v25, v105, v33
    v_fmac_f32 v26, v106, v34
    v_fmac_f32 v27, v107, v35
    v_fmac_f32 v28, v108, v36
    v_fmac_f32 v29, v109, v37
    v_fmac_f32 v30, v110, v38
    v_fmac_f32 v31, v111, v39
    v_cvt_pk_bf16_f32 v232, v24, v25
    v_cvt_pk_bf16_f32 v233, v26, v27
    v_cvt_pk_bf16_f32 v234, v28, v29
    v_cvt_pk_bf16_f32 v235, v30, v31
    buffer_store_dwordx4 v[232:235], v7, s[4:7], s59 offen
    v_lshlrev_b32 v40, 16, v236
    v_and_b32 v41, 0xffff0000, v236
    v_lshlrev_b32 v48, 16, v224
    v_and_b32 v49, 0xffff0000, v224
    v_lshlrev_b32 v42, 16, v237
    v_and_b32 v43, 0xffff0000, v237
    v_lshlrev_b32 v50, 16, v225
    v_and_b32 v51, 0xffff0000, v225
    v_lshlrev_b32 v44, 16, v238
    v_and_b32 v45, 0xffff0000, v238
    v_lshlrev_b32 v52, 16, v226
    v_and_b32 v53, 0xffff0000, v226
    v_lshlrev_b32 v46, 16, v239
    v_and_b32 v47, 0xffff0000, v239
    v_lshlrev_b32 v54, 16, v227
    v_and_b32 v55, 0xffff0000, v227
    s_waitcnt lgkmcnt(8)
    v_add_f32 v136, v136, v144
    v_add_f32 v152, v152, v160
    v_add_f32 v137, v137, v145
    v_add_f32 v153, v153, v161
    v_add_f32 v138, v138, v146
    v_add_f32 v154, v154, v162
    v_add_f32 v139, v139, v147
    v_add_f32 v155, v155, v163
    v_add_f32 v140, v140, v148
    v_add_f32 v156, v156, v164
    v_add_f32 v141, v141, v149
    v_add_f32 v157, v157, v165
    v_add_f32 v142, v142, v150
    v_add_f32 v158, v158, v166
    v_add_f32 v143, v143, v151
    v_add_f32 v159, v159, v167
    v_add_f32 v136, v136, v152
    v_add_f32 v137, v137, v153
    v_add_f32 v138, v138, v154
    v_add_f32 v139, v139, v155
    v_add_f32 v140, v140, v156
    v_add_f32 v141, v141, v157
    v_add_f32 v142, v142, v158
    v_add_f32 v143, v143, v159
    v_fmac_f32 v40, v136, v48
    v_fmac_f32 v41, v137, v49
    v_fmac_f32 v42, v138, v50
    v_fmac_f32 v43, v139, v51
    v_fmac_f32 v44, v140, v52
    v_fmac_f32 v45, v141, v53
    v_fmac_f32 v46, v142, v54
    v_fmac_f32 v47, v143, v55
    v_cvt_pk_bf16_f32 v236, v40, v41
    v_cvt_pk_bf16_f32 v237, v42, v43
    v_cvt_pk_bf16_f32 v238, v44, v45
    v_cvt_pk_bf16_f32 v239, v46, v47
    buffer_store_dwordx4 v[236:239], v7, s[4:7], s60 offen
    v_lshlrev_b32 v56, 16, v240
    v_and_b32 v57, 0xffff0000, v240
    v_lshlrev_b32 v64, 16, v228
    v_and_b32 v65, 0xffff0000, v228
    v_lshlrev_b32 v58, 16, v241
    v_and_b32 v59, 0xffff0000, v241
    v_lshlrev_b32 v66, 16, v229
    v_and_b32 v67, 0xffff0000, v229
    v_lshlrev_b32 v60, 16, v242
    v_and_b32 v61, 0xffff0000, v242
    v_lshlrev_b32 v68, 16, v230
    v_and_b32 v69, 0xffff0000, v230
    v_lshlrev_b32 v62, 16, v243
    v_and_b32 v63, 0xffff0000, v243
    v_lshlrev_b32 v70, 16, v231
    v_and_b32 v71, 0xffff0000, v231
    s_waitcnt lgkmcnt(0)
    v_add_f32 v168, v168, v176
    v_add_f32 v184, v184, v192
    v_add_f32 v169, v169, v177
    v_add_f32 v185, v185, v193
    v_add_f32 v170, v170, v178
    v_add_f32 v186, v186, v194
    v_add_f32 v171, v171, v179
    v_add_f32 v187, v187, v195
    v_add_f32 v172, v172, v180
    v_add_f32 v188, v188, v196
    v_add_f32 v173, v173, v181
    v_add_f32 v189, v189, v197
    v_add_f32 v174, v174, v182
    v_add_f32 v190, v190, v198
    v_add_f32 v175, v175, v183
    v_add_f32 v191, v191, v199
    v_add_f32 v168, v168, v184
    v_add_f32 v169, v169, v185
    v_add_f32 v170, v170, v186
    v_add_f32 v171, v171, v187
    v_add_f32 v172, v172, v188
    v_add_f32 v173, v173, v189
    v_add_f32 v174, v174, v190
    v_add_f32 v175, v175, v191
    v_fmac_f32 v56, v168, v64
    v_fmac_f32 v57, v169, v65
    v_fmac_f32 v58, v170, v66
    v_fmac_f32 v59, v171, v67
    v_fmac_f32 v60, v172, v68
    v_fmac_f32 v61, v173, v69
    v_fmac_f32 v62, v174, v70
    v_fmac_f32 v63, v175, v71
    v_cvt_pk_bf16_f32 v240, v56, v57
    v_cvt_pk_bf16_f32 v241, v58, v59
    v_cvt_pk_bf16_f32 v242, v60, v61
    v_cvt_pk_bf16_f32 v243, v62, v63
    s_mov_b32 exec_hi, 0
    buffer_store_dwordx4 v[240:243], v7, s[4:7], s61 offen
    s_mov_b32 exec_hi, -1
    s_endpgm
K2_ATT:
    s_setprio 3
    s_mov_b32 s8, s60
    s_and_b32 s9, s61, 0xffff
    s_mov_b32 s10, 663552
    s_mov_b32 s11, 0x00020000
    s_setprio 1
    v_and_b32 v1, 63, v0
    v_lshrrev_b32 v240, 6, v0
    s_and_b32 s28, s3, 7
    s_lshr_b32 s29, s3, 3
    s_and_b32 s30, s28, 1
    s_lshl_b32 s30, s30, 3
    s_and_b32 s31, s29, 7
    s_add_u32 s30, s30, s31
    s_lshr_b32 s31, s28, 1
    s_lshl_b32 s31, s31, 2
    s_lshr_b32 s32, s29, 3
    s_add_u32 s31, s31, s32
    v_readfirstlane_b32 s32, v240
    v_lshlrev_b32 v2, 4, v1
    s_lshl_b32 s33, s30, 2
    s_add_u32 s33, s33, s32
    v_add_u32 v3, 49152, v2
    s_mul_i32 s34, s33, 36864
    s_add_u32 s34, s34, 0
    s_lshl_b32 s35, s32, 12
    s_mul_i32 s37, s31, 294912
    s_add_u32 s37, s37, 15302656
    s_add_u32 s37, s37, s35
    buffer_load_dwordx4 v[16:19], v2, s[20:23], s34 offen offset:0
    buffer_load_dwordx4 v[20:23], v2, s[20:23], s34 offen offset:1024
    s_add_u32 m0, s35, 0
    s_nop 0
    buffer_load_dwordx4 v2, s[20:23], s37 offen offset:0 lds
    buffer_load_dwordx4 v2, s[20:23], s37 offen offset:1024 lds
    buffer_load_dwordx4 v2, s[20:23], s37 offen offset:2048 lds
    buffer_load_dwordx4 v2, s[20:23], s37 offen offset:3072 lds
    s_add_u32 s37, s37, 16384
    buffer_load_dwordx4 v[24:27], v2, s[20:23], s34 offen offset:2048
    buffer_load_dwordx4 v[28:31], v2, s[20:23], s34 offen offset:3072
    s_add_u32 s34, s34, 4096
    s_add_u32 m0, s35, 16384
    s_nop 0
    buffer_load_dwordx4 v2, s[20:23], s37 offen offset:0 lds
    buffer_load_dwordx4 v2, s[20:23], s37 offen offset:1024 lds
    buffer_load_dwordx4 v2, s[20:23], s37 offen offset:2048 lds
    buffer_load_dwordx4 v2, s[20:23], s37 offen offset:3072 lds
    s_add_u32 s37, s37, 16384
    buffer_load_dwordx4 v[32:35], v2, s[20:23], s34 offen offset:0
    buffer_load_dwordx4 v[36:39], v2, s[20:23], s34 offen offset:1024
    s_add_u32 m0, s35, 32768
    s_nop 0
    buffer_load_dwordx4 v2, s[20:23], s37 offen offset:0 lds
    buffer_load_dwordx4 v2, s[20:23], s37 offen offset:1024 lds
    buffer_load_dwordx4 v2, s[20:23], s37 offen offset:2048 lds
    buffer_load_dwordx4 v2, s[20:23], s37 offen offset:3072 lds
    s_add_u32 s37, s37, 16384
    buffer_load_dwordx4 v[40:43], v2, s[20:23], s34 offen offset:2048
    buffer_load_dwordx4 v[44:47], v2, s[20:23], s34 offen offset:3072
    s_add_u32 s34, s34, 4096
    s_add_u32 m0, s35, 49152
    s_nop 0
    buffer_load_dwordx4 v2, s[20:23], s37 offen offset:0 lds
    buffer_load_dwordx4 v2, s[20:23], s37 offen offset:1024 lds
    buffer_load_dwordx4 v2, s[20:23], s37 offen offset:2048 lds
    buffer_load_dwordx4 v2, s[20:23], s37 offen offset:3072 lds
    s_add_u32 s37, s37, 16384
    v_and_b32 v241, 31, v1
    v_lshrrev_b32 v240, 5, v1
    s_lshl_b32 s47, s31, 7
    s_add_u32 s47, s47, s33
    s_mul_i32 s48, s47, 1152
    s_add_u32 s48, s48, 2359296
    s_add_u32 s59, s48, 73728
    s_mul_i32 s49, s47, 2560
    s_add_u32 s49, s49, 7077888
    s_add_u32 s50, s49, 163840
    s_mov_b32 s51, 0x3eae1a93
    s_mov_b32 s54, 0x02020202
    s_mov_b32 s55, 0x02020202
    s_mov_b32 s56, 0x01010101
    s_mov_b32 s57, 0x01010101
    v_mul_u32_u24 v4, 73728, v240
    v_lshl_add_u32 v4, v241, 2, v4
    v_mul_u32_u24 v5, 163840, v240
    v_lshl_add_u32 v5, v241, 4, v5
    v_lshlrev_b32 v6, 8, v240
    s_lshl_b32 s52, s47, 2
    s_add_u32 s52, s52, 12320768
    s_lshl_b32 s53, s31, 7
    s_lshl_b32 s58, s30, 2
    s_add_u32 s53, s53, s58
    s_add_u32 s53, s53, 12603392
    s_lshl_b32 s60, s30, 7
    s_lshl_b32 s58, s31, 2
    s_add_u32 s60, s60, s58
    s_add_u32 s60, s60, 12599360
    s_mul_i32 s61, s33, 144
    s_mul_i32 s43, s31, 9
    s_add_u32 s61, s61, s43
    s_lshl_b32 s61, s61, 10
    s_add_u32 s61, s61, 30408704
    v_mov_b32 v249, 0xbdd2d3e8
    v_mov_b32 v248, v2
    v_add_u32 v250, 4096, v2
    v_add_u32 v251, 8192, v2
    s_waitcnt vmcnt(18)
    s_barrier
    ds_read_b128 v[56:59], v2 offset:0
    ds_read_b128 v[60:63], v2 offset:1024
    ds_read_b128 v[64:67], v2 offset:2048
    ds_read_b128 v[68:71], v2 offset:3072
    ds_read_b128 v[72:75], v2 offset:4096
    ds_read_b128 v[76:79], v2 offset:5120
    ds_read_b128 v[80:83], v2 offset:6144
    ds_read_b128 v[84:87], v2 offset:7168
    s_waitcnt lgkmcnt(6)
    v_mfma_f32_32x32x16_bf16 v[112:127], v[56:59], v[16:19], 0
    ds_read_b128 v[88:91], v2 offset:8192
    v_mfma_f32_32x32x16_bf16 v[128:143], v[60:63], v[16:19], 0
    ds_read_b128 v[92:95], v2 offset:9216
    s_waitcnt lgkmcnt(6)
    v_mfma_f32_32x32x16_bf16 v[144:159], v[64:67], v[16:19], 0
    ds_read_b128 v[96:99], v2 offset:10240
    v_mfma_f32_32x32x16_bf16 v[160:175], v[68:71], v[16:19], 0
    ds_read_b128 v[100:103], v2 offset:11264
    s_waitcnt lgkmcnt(6)
    v_mfma_f32_32x32x16_bf16 v[176:191], v[72:75], v[16:19], 0
    ds_read_b128 v[56:59], v2 offset:12288
    v_mfma_f32_32x32x16_bf16 v[192:207], v[76:79], v[16:19], 0
    ds_read_b128 v[60:63], v2 offset:13312
    s_waitcnt lgkmcnt(6)
    v_mfma_f32_32x32x16_bf16 v[208:223], v[80:83], v[16:19], 0
    ds_read_b128 v[64:67], v2 offset:14336
    v_mfma_f32_32x32x16_bf16 v[224:239], v[84:87], v[16:19], 0
    ds_read_b128 v[68:71], v2 offset:15360
    s_waitcnt vmcnt(12)
    s_barrier
    s_waitcnt lgkmcnt(6)
    v_mfma_f32_32x32x16_bf16 v[112:127], v[88:91], v[20:23], v[112:127]
    ds_read_b128 v[72:75], v2 offset:16384
    buffer_load_dwordx4 v[48:51], v2, s[20:23], s34 offen offset:0
    v_mfma_f32_32x32x16_bf16 v[128:143], v[92:95], v[20:23], v[128:143]
    ds_read_b128 v[76:79], v2 offset:17408
    s_waitcnt lgkmcnt(6)
    v_mfma_f32_32x32x16_bf16 v[144:159], v[96:99], v[20:23], v[144:159]
    ds_read_b128 v[80:83], v2 offset:18432
    buffer_load_dwordx4 v[52:55], v2, s[20:23], s34 offen offset:1024
    v_mfma_f32_32x32x16_bf16 v[160:175], v[100:103], v[20:23], v[160:175]
    ds_read_b128 v[84:87], v2 offset:19456
    s_waitcnt lgkmcnt(6)
    v_mfma_f32_32x32x16_bf16 v[176:191], v[56:59], v[20:23], v[176:191]
    ds_read_b128 v[88:91], v2 offset:20480
    s_add_u32 m0, s35, 65536
    s_nop 0
    buffer_load_dwordx4 v2, s[20:23], s37 offen offset:0 lds
    v_mfma_f32_32x32x16_bf16 v[192:207], v[60:63], v[20:23], v[192:207]
    ds_read_b128 v[92:95], v2 offset:21504
    s_waitcnt lgkmcnt(6)
    v_mfma_f32_32x32x16_bf16 v[208:223], v[64:67], v[20:23], v[208:223]
    ds_read_b128 v[96:99], v2 offset:22528
    buffer_load_dwordx4 v2, s[20:23], s37 offen offset:1024 lds
    v_mfma_f32_32x32x16_bf16 v[224:239], v[68:71], v[20:23], v[224:239]
    ds_read_b128 v[100:103], v2 offset:23552
    s_waitcnt lgkmcnt(6)
    v_mfma_f32_32x32x16_bf16 v[112:127], v[72:75], v[24:27], v[112:127]
    ds_read_b128 v[56:59], v2 offset:24576
    buffer_load_dwordx4 v2, s[20:23], s37 offen offset:2048 lds
    v_mfma_f32_32x32x16_bf16 v[128:143], v[76:79], v[24:27], v[128:143]
    ds_read_b128 v[60:63], v2 offset:25600
    s_waitcnt lgkmcnt(6)
    v_mfma_f32_32x32x16_bf16 v[144:159], v[80:83], v[24:27], v[144:159]
    ds_read_b128 v[64:67], v2 offset:26624
    buffer_load_dwordx4 v2, s[20:23], s37 offen offset:3072 lds
    s_add_u32 s37, s37, 16384
    v_mfma_f32_32x32x16_bf16 v[160:175], v[84:87], v[24:27], v[160:175]
    ds_read_b128 v[68:71], v2 offset:27648
    s_waitcnt lgkmcnt(6)
    v_mfma_f32_32x32x16_bf16 v[176:191], v[88:91], v[24:27], v[176:191]
    ds_read_b128 v[72:75], v2 offset:28672
    v_mfma_f32_32x32x16_bf16 v[192:207], v[92:95], v[24:27], v[192:207]
    ds_read_b128 v[76:79], v2 offset:29696
    s_waitcnt lgkmcnt(6)
    v_mfma_f32_32x32x16_bf16 v[208:223], v[96:99], v[24:27], v[208:223]
    ds_read_b128 v[80:83], v2 offset:30720
    v_mfma_f32_32x32x16_bf16 v[224:239], v[100:103], v[24:27], v[224:239]
    ds_read_b128 v[84:87], v2 offset:31744
    s_waitcnt vmcnt(12)
    s_barrier
    s_waitcnt lgkmcnt(6)
    v_mfma_f32_32x32x16_bf16 v[112:127], v[56:59], v[28:31], v[112:127]
    ds_read_b128 v[88:91], v2 offset:32768
    buffer_load_dwordx4 v[16:19], v2, s[20:23], s34 offen offset:2048
    v_mfma_f32_32x32x16_bf16 v[128:143], v[60:63], v[28:31], v[128:143]
    ds_read_b128 v[92:95], v2 offset:33792
    s_waitcnt lgkmcnt(6)
    v_mfma_f32_32x32x16_bf16 v[144:159], v[64:67], v[28:31], v[144:159]
    ds_read_b128 v[96:99], v2 offset:34816
    buffer_load_dwordx4 v[20:23], v2, s[20:23], s34 offen offset:3072
    s_add_u32 s34, s34, 4096
    v_mfma_f32_32x32x16_bf16 v[160:175], v[68:71], v[28:31], v[160:175]
    ds_read_b128 v[100:103], v2 offset:35840
    s_waitcnt lgkmcnt(6)
    v_mfma_f32_32x32x16_bf16 v[176:191], v[72:75], v[28:31], v[176:191]
    ds_read_b128 v[56:59], v2 offset:36864
    s_add_u32 m0, s35, 0
    s_nop 0
    buffer_load_dwordx4 v2, s[20:23], s37 offen offset:0 lds
    v_mfma_f32_32x32x16_bf16 v[192:207], v[76:79], v[28:31], v[192:207]
    ds_read_b128 v[60:63], v2 offset:37888
    s_waitcnt lgkmcnt(6)
    v_mfma_f32_32x32x16_bf16 v[208:223], v[80:83], v[28:31], v[208:223]
    ds_read_b128 v[64:67], v2 offset:38912
    buffer_load_dwordx4 v2, s[20:23], s37 offen offset:1024 lds
    v_mfma_f32_32x32x16_bf16 v[224:239], v[84:87], v[28:31], v[224:239]
    ds_read_b128 v[68:71], v2 offset:39936
    s_waitcnt lgkmcnt(6)
    v_mfma_f32_32x32x16_bf16 v[112:127], v[88:91], v[32:35], v[112:127]
    ds_read_b128 v[72:75], v2 offset:40960
    buffer_load_dwordx4 v2, s[20:23], s37 offen offset:2048 lds
    v_mfma_f32_32x32x16_bf16 v[128:143], v[92:95], v[32:35], v[128:143]
    ds_read_b128 v[76:79], v2 offset:41984
    s_waitcnt lgkmcnt(6)
    v_mfma_f32_32x32x16_bf16 v[144:159], v[96:99], v[32:35], v[144:159]
    ds_read_b128 v[80:83], v2 offset:43008
    buffer_load_dwordx4 v2, s[20:23], s37 offen offset:3072 lds
    s_add_u32 s37, s37, 16384
    v_mfma_f32_32x32x16_bf16 v[160:175], v[100:103], v[32:35], v[160:175]
    ds_read_b128 v[84:87], v2 offset:44032
    s_waitcnt lgkmcnt(6)
    v_mfma_f32_32x32x16_bf16 v[176:191], v[56:59], v[32:35], v[176:191]
    ds_read_b128 v[88:91], v2 offset:45056
    v_mfma_f32_32x32x16_bf16 v[192:207], v[60:63], v[32:35], v[192:207]
    ds_read_b128 v[92:95], v2 offset:46080
    s_waitcnt lgkmcnt(6)
    v_mfma_f32_32x32x16_bf16 v[208:223], v[64:67], v[32:35], v[208:223]
    ds_read_b128 v[96:99], v2 offset:47104
    v_mfma_f32_32x32x16_bf16 v[224:239], v[68:71], v[32:35], v[224:239]
    ds_read_b128 v[100:103], v2 offset:48128
    s_waitcnt vmcnt(12)
    s_barrier
    s_waitcnt lgkmcnt(6)
    v_mfma_f32_32x32x16_bf16 v[112:127], v[72:75], v[36:39], v[112:127]
    ds_read_b128 v[56:59], v3 offset:0
    buffer_load_dwordx4 v[24:27], v2, s[20:23], s34 offen offset:0
    v_mfma_f32_32x32x16_bf16 v[128:143], v[76:79], v[36:39], v[128:143]
    ds_read_b128 v[60:63], v3 offset:1024
    s_waitcnt lgkmcnt(6)
    v_mfma_f32_32x32x16_bf16 v[144:159], v[80:83], v[36:39], v[144:159]
    ds_read_b128 v[64:67], v3 offset:2048
    buffer_load_dwordx4 v[28:31], v2, s[20:23], s34 offen offset:1024
    v_mfma_f32_32x32x16_bf16 v[160:175], v[84:87], v[36:39], v[160:175]
    ds_read_b128 v[68:71], v3 offset:3072
    s_waitcnt lgkmcnt(6)
    v_mfma_f32_32x32x16_bf16 v[176:191], v[88:91], v[36:39], v[176:191]
    ds_read_b128 v[72:75], v3 offset:4096
    s_add_u32 m0, s35, 16384
    s_nop 0
    buffer_load_dwordx4 v2, s[20:23], s37 offen offset:0 lds
    v_mfma_f32_32x32x16_bf16 v[192:207], v[92:95], v[36:39], v[192:207]
    ds_read_b128 v[76:79], v3 offset:5120
    s_waitcnt lgkmcnt(6)
    v_mfma_f32_32x32x16_bf16 v[208:223], v[96:99], v[36:39], v[208:223]
    ds_read_b128 v[80:83], v3 offset:6144
    buffer_load_dwordx4 v2, s[20:23], s37 offen offset:1024 lds
    v_mfma_f32_32x32x16_bf16 v[224:239], v[100:103], v[36:39], v[224:239]
    ds_read_b128 v[84:87], v3 offset:7168
    s_waitcnt lgkmcnt(6)
    v_mfma_f32_32x32x16_bf16 v[112:127], v[56:59], v[40:43], v[112:127]
    ds_read_b128 v[88:91], v3 offset:8192
    buffer_load_dwordx4 v2, s[20:23], s37 offen offset:2048 lds
    v_mfma_f32_32x32x16_bf16 v[128:143], v[60:63], v[40:43], v[128:143]
    ds_read_b128 v[92:95], v3 offset:9216
    s_waitcnt lgkmcnt(6)
    v_mfma_f32_32x32x16_bf16 v[144:159], v[64:67], v[40:43], v[144:159]
    ds_read_b128 v[96:99], v3 offset:10240
    buffer_load_dwordx4 v2, s[20:23], s37 offen offset:3072 lds
    s_add_u32 s37, s37, 16384
    v_mfma_f32_32x32x16_bf16 v[160:175], v[68:71], v[40:43], v[160:175]
    ds_read_b128 v[100:103], v3 offset:11264
    s_waitcnt lgkmcnt(6)
    v_mfma_f32_32x32x16_bf16 v[176:191], v[72:75], v[40:43], v[176:191]
    ds_read_b128 v[56:59], v3 offset:12288
    v_mfma_f32_32x32x16_bf16 v[192:207], v[76:79], v[40:43], v[192:207]
    ds_read_b128 v[60:63], v3 offset:13312
    s_waitcnt lgkmcnt(6)
    v_mfma_f32_32x32x16_bf16 v[208:223], v[80:83], v[40:43], v[208:223]
    ds_read_b128 v[64:67], v3 offset:14336
    v_mfma_f32_32x32x16_bf16 v[224:239], v[84:87], v[40:43], v[224:239]
    ds_read_b128 v[68:71], v3 offset:15360
    s_waitcnt vmcnt(12)
    s_barrier
    s_waitcnt lgkmcnt(6)
    v_mfma_f32_32x32x16_bf16 v[112:127], v[88:91], v[44:47], v[112:127]
    ds_read_b128 v[72:75], v3 offset:16384
    buffer_load_dwordx4 v[32:35], v2, s[20:23], s34 offen offset:2048
    v_mfma_f32_32x32x16_bf16 v[128:143], v[92:95], v[44:47], v[128:143]
    ds_read_b128 v[76:79], v3 offset:17408
    s_waitcnt lgkmcnt(6)
    v_mfma_f32_32x32x16_bf16 v[144:159], v[96:99], v[44:47], v[144:159]
    ds_read_b128 v[80:83], v3 offset:18432
    buffer_load_dwordx4 v[36:39], v2, s[20:23], s34 offen offset:3072
    s_add_u32 s34, s34, 4096
    v_mfma_f32_32x32x16_bf16 v[160:175], v[100:103], v[44:47], v[160:175]
    ds_read_b128 v[84:87], v3 offset:19456
    s_waitcnt lgkmcnt(6)
    v_mfma_f32_32x32x16_bf16 v[176:191], v[56:59], v[44:47], v[176:191]
    ds_read_b128 v[88:91], v3 offset:20480
    s_add_u32 m0, s35, 32768
    s_nop 0
    buffer_load_dwordx4 v2, s[20:23], s37 offen offset:0 lds
    v_mfma_f32_32x32x16_bf16 v[192:207], v[60:63], v[44:47], v[192:207]
    ds_read_b128 v[92:95], v3 offset:21504
    s_waitcnt lgkmcnt(6)
    v_mfma_f32_32x32x16_bf16 v[208:223], v[64:67], v[44:47], v[208:223]
    ds_read_b128 v[96:99], v3 offset:22528
    buffer_load_dwordx4 v2, s[20:23], s37 offen offset:1024 lds
    v_mfma_f32_32x32x16_bf16 v[224:239], v[68:71], v[44:47], v[224:239]
    ds_read_b128 v[100:103], v3 offset:23552
    s_waitcnt lgkmcnt(6)
    v_mfma_f32_32x32x16_bf16 v[112:127], v[72:75], v[48:51], v[112:127]
    ds_read_b128 v[56:59], v3 offset:24576
    buffer_load_dwordx4 v2, s[20:23], s37 offen offset:2048 lds
    v_mfma_f32_32x32x16_bf16 v[128:143], v[76:79], v[48:51], v[128:143]
    ds_read_b128 v[60:63], v3 offset:25600
    s_waitcnt lgkmcnt(6)
    v_mfma_f32_32x32x16_bf16 v[144:159], v[80:83], v[48:51], v[144:159]
    ds_read_b128 v[64:67], v3 offset:26624
    buffer_load_dwordx4 v2, s[20:23], s37 offen offset:3072 lds
    s_add_u32 s37, s37, 16384
    v_mfma_f32_32x32x16_bf16 v[160:175], v[84:87], v[48:51], v[160:175]
    ds_read_b128 v[68:71], v3 offset:27648
    s_waitcnt lgkmcnt(6)
    v_mfma_f32_32x32x16_bf16 v[176:191], v[88:91], v[48:51], v[176:191]
    ds_read_b128 v[72:75], v3 offset:28672
    v_mfma_f32_32x32x16_bf16 v[192:207], v[92:95], v[48:51], v[192:207]
    ds_read_b128 v[76:79], v3 offset:29696
    s_waitcnt lgkmcnt(6)
    v_mfma_f32_32x32x16_bf16 v[208:223], v[96:99], v[48:51], v[208:223]
    ds_read_b128 v[80:83], v3 offset:30720
    v_mfma_f32_32x32x16_bf16 v[224:239], v[100:103], v[48:51], v[224:239]
    ds_read_b128 v[84:87], v3 offset:31744
    s_waitcnt vmcnt(12)
    s_barrier
    s_waitcnt lgkmcnt(6)
    v_mfma_f32_32x32x16_bf16 v[112:127], v[56:59], v[52:55], v[112:127]
    ds_read_b128 v[88:91], v2 offset:0
    buffer_load_dwordx4 v[40:43], v2, s[20:23], s34 offen offset:0
    v_mfma_f32_32x32x16_bf16 v[128:143], v[60:63], v[52:55], v[128:143]
    ds_read_b128 v[92:95], v2 offset:1024
    s_waitcnt lgkmcnt(6)
    v_mfma_f32_32x32x16_bf16 v[144:159], v[64:67], v[52:55], v[144:159]
    ds_read_b128 v[96:99], v2 offset:2048
    buffer_load_dwordx4 v[44:47], v2, s[20:23], s34 offen offset:1024
    v_mfma_f32_32x32x16_bf16 v[160:175], v[68:71], v[52:55], v[160:175]
    ds_read_b128 v[100:103], v2 offset:3072
    s_waitcnt lgkmcnt(6)
    v_mfma_f32_32x32x16_bf16 v[176:191], v[72:75], v[52:55], v[176:191]
    ds_read_b128 v[56:59], v2 offset:4096
    s_add_u32 m0, s35, 49152
    s_nop 0
    buffer_load_dwordx4 v2, s[20:23], s37 offen offset:0 lds
    v_mfma_f32_32x32x16_bf16 v[192:207], v[76:79], v[52:55], v[192:207]
    ds_read_b128 v[60:63], v2 offset:5120
    s_waitcnt lgkmcnt(6)
    v_mfma_f32_32x32x16_bf16 v[208:223], v[80:83], v[52:55], v[208:223]
    ds_read_b128 v[64:67], v2 offset:6144
    buffer_load_dwordx4 v2, s[20:23], s37 offen offset:1024 lds
    v_mfma_f32_32x32x16_bf16 v[224:239], v[84:87], v[52:55], v[224:239]
    ds_read_b128 v[68:71], v2 offset:7168
    s_waitcnt lgkmcnt(6)
    v_mfma_f32_32x32x16_bf16 v[112:127], v[88:91], v[16:19], v[112:127]
    ds_read_b128 v[72:75], v2 offset:8192
    buffer_load_dwordx4 v2, s[20:23], s37 offen offset:2048 lds
    v_mfma_f32_32x32x16_bf16 v[128:143], v[92:95], v[16:19], v[128:143]
    ds_read_b128 v[76:79], v2 offset:9216
    s_waitcnt lgkmcnt(6)
    v_mfma_f32_32x32x16_bf16 v[144:159], v[96:99], v[16:19], v[144:159]
    ds_read_b128 v[80:83], v2 offset:10240
    buffer_load_dwordx4 v2, s[20:23], s37 offen offset:3072 lds
    s_add_u32 s37, s37, 16384
    v_mfma_f32_32x32x16_bf16 v[160:175], v[100:103], v[16:19], v[160:175]
    ds_read_b128 v[84:87], v2 offset:11264
    s_waitcnt lgkmcnt(6)
    v_mfma_f32_32x32x16_bf16 v[176:191], v[56:59], v[16:19], v[176:191]
    ds_read_b128 v[88:91], v2 offset:12288
    v_mfma_f32_32x32x16_bf16 v[192:207], v[60:63], v[16:19], v[192:207]
    ds_read_b128 v[92:95], v2 offset:13312
    s_waitcnt lgkmcnt(6)
    v_mfma_f32_32x32x16_bf16 v[208:223], v[64:67], v[16:19], v[208:223]
    ds_read_b128 v[96:99], v2 offset:14336
    v_mfma_f32_32x32x16_bf16 v[224:239], v[68:71], v[16:19], v[224:239]
    ds_read_b128 v[100:103], v2 offset:15360
    s_waitcnt vmcnt(12)
    s_barrier
    s_waitcnt lgkmcnt(6)
    v_mfma_f32_32x32x16_bf16 v[112:127], v[72:75], v[20:23], v[112:127]
    ds_read_b128 v[56:59], v2 offset:16384
    buffer_load_dwordx4 v[48:51], v2, s[20:23], s34 offen offset:2048
    v_mfma_f32_32x32x16_bf16 v[128:143], v[76:79], v[20:23], v[128:143]
    ds_read_b128 v[60:63], v2 offset:17408
    s_waitcnt lgkmcnt(6)
    v_mfma_f32_32x32x16_bf16 v[144:159], v[80:83], v[20:23], v[144:159]
    ds_read_b128 v[64:67], v2 offset:18432
    buffer_load_dwordx4 v[52:55], v2, s[20:23], s34 offen offset:3072
    s_add_u32 s34, s34, 4096
    v_mfma_f32_32x32x16_bf16 v[160:175], v[84:87], v[20:23], v[160:175]
    ds_read_b128 v[68:71], v2 offset:19456
    s_waitcnt lgkmcnt(6)
    v_mfma_f32_32x32x16_bf16 v[176:191], v[88:91], v[20:23], v[176:191]
    ds_read_b128 v[72:75], v2 offset:20480
    s_add_u32 m0, s35, 65536
    s_nop 0
    buffer_load_dwordx4 v2, s[20:23], s37 offen offset:0 lds
    v_mfma_f32_32x32x16_bf16 v[192:207], v[92:95], v[20:23], v[192:207]
    ds_read_b128 v[76:79], v2 offset:21504
    s_waitcnt lgkmcnt(6)
    v_mfma_f32_32x32x16_bf16 v[208:223], v[96:99], v[20:23], v[208:223]
    ds_read_b128 v[80:83], v2 offset:22528
    buffer_load_dwordx4 v2, s[20:23], s37 offen offset:1024 lds
    v_mfma_f32_32x32x16_bf16 v[224:239], v[100:103], v[20:23], v[224:239]
    ds_read_b128 v[84:87], v2 offset:23552
    s_waitcnt lgkmcnt(6)
    v_mfma_f32_32x32x16_bf16 v[112:127], v[56:59], v[24:27], v[112:127]
    ds_read_b128 v[88:91], v2 offset:24576
    buffer_load_dwordx4 v2, s[20:23], s37 offen offset:2048 lds
    v_mfma_f32_32x32x16_bf16 v[128:143], v[60:63], v[24:27], v[128:143]
    ds_read_b128 v[92:95], v2 offset:25600
    s_waitcnt lgkmcnt(6)
    v_mfma_f32_32x32x16_bf16 v[144:159], v[64:67], v[24:27], v[144:159]
    ds_read_b128 v[96:99], v2 offset:26624
    buffer_load_dwordx4 v2, s[20:23], s37 offen offset:3072 lds
    s_add_u32 s37, s37, 16384
    v_mfma_f32_32x32x16_bf16 v[160:175], v[68:71], v[24:27], v[160:175]
    ds_read_b128 v[100:103], v2 offset:27648
    s_waitcnt lgkmcnt(6)
    v_mfma_f32_32x32x16_bf16 v[176:191], v[72:75], v[24:27], v[176:191]
    ds_read_b128 v[56:59], v2 offset:28672
    v_mfma_f32_32x32x16_bf16 v[192:207], v[76:79], v[24:27], v[192:207]
    ds_read_b128 v[60:63], v2 offset:29696
    s_waitcnt lgkmcnt(6)
    v_mfma_f32_32x32x16_bf16 v[208:223], v[80:83], v[24:27], v[208:223]
    ds_read_b128 v[64:67], v2 offset:30720
    v_mfma_f32_32x32x16_bf16 v[224:239], v[84:87], v[24:27], v[224:239]
    ds_read_b128 v[68:71], v2 offset:31744
    s_waitcnt vmcnt(12)
    s_barrier
    s_waitcnt lgkmcnt(6)
    v_mfma_f32_32x32x16_bf16 v[112:127], v[88:91], v[28:31], v[112:127]
    ds_read_b128 v[72:75], v2 offset:32768
    buffer_load_dwordx4 v[16:19], v2, s[20:23], s34 offen offset:0
    v_mfma_f32_32x32x16_bf16 v[128:143], v[92:95], v[28:31], v[128:143]
    ds_read_b128 v[76:79], v2 offset:33792
    s_waitcnt lgkmcnt(6)
    v_mfma_f32_32x32x16_bf16 v[144:159], v[96:99], v[28:31], v[144:159]
    ds_read_b128 v[80:83], v2 offset:34816
    buffer_load_dwordx4 v[20:23], v2, s[20:23], s34 offen offset:1024
    v_mfma_f32_32x32x16_bf16 v[160:175], v[100:103], v[28:31], v[160:175]
    ds_read_b128 v[84:87], v2 offset:35840
    s_waitcnt lgkmcnt(6)
    v_mfma_f32_32x32x16_bf16 v[176:191], v[56:59], v[28:31], v[176:191]
    ds_read_b128 v[88:91], v2 offset:36864
    s_add_u32 m0, s35, 0
    s_nop 0
    buffer_load_dwordx4 v2, s[20:23], s37 offen offset:0 lds
    v_mfma_f32_32x32x16_bf16 v[192:207], v[60:63], v[28:31], v[192:207]
    ds_read_b128 v[92:95], v2 offset:37888
    s_waitcnt lgkmcnt(6)
    v_mfma_f32_32x32x16_bf16 v[208:223], v[64:67], v[28:31], v[208:223]
    ds_read_b128 v[96:99], v2 offset:38912
    buffer_load_dwordx4 v2, s[20:23], s37 offen offset:1024 lds
    v_mfma_f32_32x32x16_bf16 v[224:239], v[68:71], v[28:31], v[224:239]
    ds_read_b128 v[100:103], v2 offset:39936
    s_waitcnt lgkmcnt(6)
    v_mfma_f32_32x32x16_bf16 v[112:127], v[72:75], v[32:35], v[112:127]
    ds_read_b128 v[56:59], v2 offset:40960
    buffer_load_dwordx4 v2, s[20:23], s37 offen offset:2048 lds
    v_mfma_f32_32x32x16_bf16 v[128:143], v[76:79], v[32:35], v[128:143]
    ds_read_b128 v[60:63], v2 offset:41984
    s_waitcnt lgkmcnt(6)
    v_mfma_f32_32x32x16_bf16 v[144:159], v[80:83], v[32:35], v[144:159]
    ds_read_b128 v[64:67], v2 offset:43008
    buffer_load_dwordx4 v2, s[20:23], s37 offen offset:3072 lds
    s_add_u32 s37, s37, 16384
    v_mfma_f32_32x32x16_bf16 v[160:175], v[84:87], v[32:35], v[160:175]
    ds_read_b128 v[68:71], v2 offset:44032
    s_waitcnt lgkmcnt(6)
    v_mfma_f32_32x32x16_bf16 v[176:191], v[88:91], v[32:35], v[176:191]
    ds_read_b128 v[72:75], v2 offset:45056
    v_mfma_f32_32x32x16_bf16 v[192:207], v[92:95], v[32:35], v[192:207]
    ds_read_b128 v[76:79], v2 offset:46080
    s_waitcnt lgkmcnt(6)
    v_mfma_f32_32x32x16_bf16 v[208:223], v[96:99], v[32:35], v[208:223]
    ds_read_b128 v[80:83], v2 offset:47104
    v_mfma_f32_32x32x16_bf16 v[224:239], v[100:103], v[32:35], v[224:239]
    ds_read_b128 v[84:87], v2 offset:48128
    s_waitcnt vmcnt(12)
    s_barrier
    s_waitcnt lgkmcnt(6)
    v_mfma_f32_32x32x16_bf16 v[112:127], v[56:59], v[36:39], v[112:127]
    ds_read_b128 v[88:91], v3 offset:0
    buffer_load_dwordx4 v[24:27], v2, s[20:23], s34 offen offset:2048
    v_mfma_f32_32x32x16_bf16 v[128:143], v[60:63], v[36:39], v[128:143]
    ds_read_b128 v[92:95], v3 offset:1024
    s_waitcnt lgkmcnt(6)
    v_mfma_f32_32x32x16_bf16 v[144:159], v[64:67], v[36:39], v[144:159]
    ds_read_b128 v[96:99], v3 offset:2048
    buffer_load_dwordx4 v[28:31], v2, s[20:23], s34 offen offset:3072
    s_add_u32 s34, s34, 4096
    v_mfma_f32_32x32x16_bf16 v[160:175], v[68:71], v[36:39], v[160:175]
    ds_read_b128 v[100:103], v3 offset:3072
    s_waitcnt lgkmcnt(6)
    v_mfma_f32_32x32x16_bf16 v[176:191], v[72:75], v[36:39], v[176:191]
    ds_read_b128 v[56:59], v3 offset:4096
    s_add_u32 m0, s35, 16384
    s_nop 0
    buffer_load_dwordx4 v2, s[20:23], s37 offen offset:0 lds
    v_mfma_f32_32x32x16_bf16 v[192:207], v[76:79], v[36:39], v[192:207]
    ds_read_b128 v[60:63], v3 offset:5120
    s_waitcnt lgkmcnt(6)
    v_mfma_f32_32x32x16_bf16 v[208:223], v[80:83], v[36:39], v[208:223]
    ds_read_b128 v[64:67], v3 offset:6144
    buffer_load_dwordx4 v2, s[20:23], s37 offen offset:1024 lds
    v_mfma_f32_32x32x16_bf16 v[224:239], v[84:87], v[36:39], v[224:239]
    ds_read_b128 v[68:71], v3 offset:7168
    s_waitcnt lgkmcnt(6)
    v_mfma_f32_32x32x16_bf16 v[112:127], v[88:91], v[40:43], v[112:127]
    ds_read_b128 v[72:75], v3 offset:8192
    buffer_load_dwordx4 v2, s[20:23], s37 offen offset:2048 lds
    v_mfma_f32_32x32x16_bf16 v[128:143], v[92:95], v[40:43], v[128:143]
    ds_read_b128 v[76:79], v3 offset:9216
    s_waitcnt lgkmcnt(6)
    v_mfma_f32_32x32x16_bf16 v[144:159], v[96:99], v[40:43], v[144:159]
    ds_read_b128 v[80:83], v3 offset:10240
    buffer_load_dwordx4 v2, s[20:23], s37 offen offset:3072 lds
    s_add_u32 s37, s37, 16384
    v_mfma_f32_32x32x16_bf16 v[160:175], v[100:103], v[40:43], v[160:175]
    ds_read_b128 v[84:87], v3 offset:11264
    s_waitcnt lgkmcnt(6)
    v_mfma_f32_32x32x16_bf16 v[176:191], v[56:59], v[40:43], v[176:191]
    ds_read_b128 v[88:91], v3 offset:12288
    v_mfma_f32_32x32x16_bf16 v[192:207], v[60:63], v[40:43], v[192:207]
    ds_read_b128 v[92:95], v3 offset:13312
    s_waitcnt lgkmcnt(6)
    v_mfma_f32_32x32x16_bf16 v[208:223], v[64:67], v[40:43], v[208:223]
    ds_read_b128 v[96:99], v3 offset:14336
    v_mfma_f32_32x32x16_bf16 v[224:239], v[68:71], v[40:43], v[224:239]
    ds_read_b128 v[100:103], v3 offset:15360
    s_waitcnt vmcnt(12)
    s_barrier
    s_waitcnt lgkmcnt(6)
    v_mfma_f32_32x32x16_bf16 v[112:127], v[72:75], v[44:47], v[112:127]
    ds_read_b128 v[56:59], v3 offset:16384
    buffer_load_dwordx4 v[32:35], v2, s[20:23], s34 offen offset:0
    v_mfma_f32_32x32x16_bf16 v[128:143], v[76:79], v[44:47], v[128:143]
    ds_read_b128 v[60:63], v3 offset:17408
    s_waitcnt lgkmcnt(6)
    v_mfma_f32_32x32x16_bf16 v[144:159], v[80:83], v[44:47], v[144:159]
    ds_read_b128 v[64:67], v3 offset:18432
    buffer_load_dwordx4 v[36:39], v2, s[20:23], s34 offen offset:1024
    v_mfma_f32_32x32x16_bf16 v[160:175], v[84:87], v[44:47], v[160:175]
    ds_read_b128 v[68:71], v3 offset:19456
    s_waitcnt lgkmcnt(6)
    v_mfma_f32_32x32x16_bf16 v[176:191], v[88:91], v[44:47], v[176:191]
    ds_read_b128 v[72:75], v3 offset:20480
    s_add_u32 m0, s35, 32768
    s_nop 0
    buffer_load_dwordx4 v2, s[20:23], s37 offen offset:0 lds
    v_mfma_f32_32x32x16_bf16 v[192:207], v[92:95], v[44:47], v[192:207]
    ds_read_b128 v[76:79], v3 offset:21504
    s_waitcnt lgkmcnt(6)
    v_mfma_f32_32x32x16_bf16 v[208:223], v[96:99], v[44:47], v[208:223]
    ds_read_b128 v[80:83], v3 offset:22528
    buffer_load_dwordx4 v2, s[20:23], s37 offen offset:1024 lds
    v_mfma_f32_32x32x16_bf16 v[224:239], v[100:103], v[44:47], v[224:239]
    ds_read_b128 v[84:87], v3 offset:23552
    s_waitcnt lgkmcnt(6)
    v_mfma_f32_32x32x16_bf16 v[112:127], v[56:59], v[48:51], v[112:127]
    ds_read_b128 v[88:91], v3 offset:24576
    buffer_load_dwordx4 v2, s[20:23], s37 offen offset:2048 lds
    v_mfma_f32_32x32x16_bf16 v[128:143], v[60:63], v[48:51], v[128:143]
    ds_read_b128 v[92:95], v3 offset:25600
    s_waitcnt lgkmcnt(6)
    v_mfma_f32_32x32x16_bf16 v[144:159], v[64:67], v[48:51], v[144:159]
    ds_read_b128 v[96:99], v3 offset:26624
    buffer_load_dwordx4 v2, s[20:23], s37 offen offset:3072 lds
    s_add_u32 s37, s37, 16384
    v_mfma_f32_32x32x16_bf16 v[160:175], v[68:71], v[48:51], v[160:175]
    ds_read_b128 v[100:103], v3 offset:27648
    s_waitcnt lgkmcnt(6)
    v_mfma_f32_32x32x16_bf16 v[176:191], v[72:75], v[48:51], v[176:191]
    ds_read_b128 v[56:59], v3 offset:28672
    v_mfma_f32_32x32x16_bf16 v[192:207], v[76:79], v[48:51], v[192:207]
    ds_read_b128 v[60:63], v3 offset:29696
    s_waitcnt lgkmcnt(6)
    v_mfma_f32_32x32x16_bf16 v[208:223], v[80:83], v[48:51], v[208:223]
    ds_read_b128 v[64:67], v3 offset:30720
    v_mfma_f32_32x32x16_bf16 v[224:239], v[84:87], v[48:51], v[224:239]
    ds_read_b128 v[68:71], v3 offset:31744
    s_waitcnt vmcnt(12)
    s_barrier
    s_waitcnt lgkmcnt(6)
    v_mfma_f32_32x32x16_bf16 v[112:127], v[88:91], v[52:55], v[112:127]
    ds_read_b128 v[72:75], v2 offset:0
    buffer_load_dwordx4 v[40:43], v2, s[20:23], s34 offen offset:2048
    v_mfma_f32_32x32x16_bf16 v[128:143], v[92:95], v[52:55], v[128:143]
    ds_read_b128 v[76:79], v2 offset:1024
    s_waitcnt lgkmcnt(6)
    v_mfma_f32_32x32x16_bf16 v[144:159], v[96:99], v[52:55], v[144:159]
    ds_read_b128 v[80:83], v2 offset:2048
    buffer_load_dwordx4 v[44:47], v2, s[20:23], s34 offen offset:3072
    s_add_u32 s34, s34, 4096
    v_mfma_f32_32x32x16_bf16 v[160:175], v[100:103], v[52:55], v[160:175]
    ds_read_b128 v[84:87], v2 offset:3072
    s_waitcnt lgkmcnt(6)
    v_mfma_f32_32x32x16_bf16 v[176:191], v[56:59], v[52:55], v[176:191]
    ds_read_b128 v[88:91], v2 offset:4096
    s_add_u32 m0, s35, 49152
    s_nop 0
    buffer_load_dwordx4 v2, s[20:23], s37 offen offset:0 lds
    v_mfma_f32_32x32x16_bf16 v[192:207], v[60:63], v[52:55], v[192:207]
    ds_read_b128 v[92:95], v2 offset:5120
    s_waitcnt lgkmcnt(6)
    v_mfma_f32_32x32x16_bf16 v[208:223], v[64:67], v[52:55], v[208:223]
    ds_read_b128 v[96:99], v2 offset:6144
    buffer_load_dwordx4 v2, s[20:23], s37 offen offset:1024 lds
    v_mfma_f32_32x32x16_bf16 v[224:239], v[68:71], v[52:55], v[224:239]
    ds_read_b128 v[100:103], v2 offset:7168
    s_waitcnt lgkmcnt(6)
    v_mfma_f32_32x32x16_bf16 v[112:127], v[72:75], v[16:19], v[112:127]
    ds_read_b128 v[56:59], v2 offset:8192
    buffer_load_dwordx4 v2, s[20:23], s37 offen offset:2048 lds
    v_mfma_f32_32x32x16_bf16 v[128:143], v[76:79], v[16:19], v[128:143]
    ds_read_b128 v[60:63], v2 offset:9216
    s_waitcnt lgkmcnt(6)
    v_mfma_f32_32x32x16_bf16 v[144:159], v[80:83], v[16:19], v[144:159]
    ds_read_b128 v[64:67], v2 offset:10240
    buffer_load_dwordx4 v2, s[20:23], s37 offen offset:3072 lds
    s_add_u32 s37, s37, 16384
    v_mfma_f32_32x32x16_bf16 v[160:175], v[84:87], v[16:19], v[160:175]
    ds_read_b128 v[68:71], v2 offset:11264
    s_waitcnt lgkmcnt(6)
    v_mfma_f32_32x32x16_bf16 v[176:191], v[88:91], v[16:19], v[176:191]
    ds_read_b128 v[72:75], v2 offset:12288
    v_mfma_f32_32x32x16_bf16 v[192:207], v[92:95], v[16:19], v[192:207]
    ds_read_b128 v[76:79], v2 offset:13312
    s_waitcnt lgkmcnt(6)
    v_mfma_f32_32x32x16_bf16 v[208:223], v[96:99], v[16:19], v[208:223]
    ds_read_b128 v[80:83], v2 offset:14336
    v_mfma_f32_32x32x16_bf16 v[224:239], v[100:103], v[16:19], v[224:239]
    ds_read_b128 v[84:87], v2 offset:15360
    s_waitcnt vmcnt(12)
    s_barrier
    s_waitcnt lgkmcnt(6)
    v_mfma_f32_32x32x16_bf16 v[112:127], v[56:59], v[20:23], v[112:127]
    ds_read_b128 v[88:91], v2 offset:16384
    buffer_load_dwordx4 v[48:51], v2, s[20:23], s34 offen offset:0
    v_mfma_f32_32x32x16_bf16 v[128:143], v[60:63], v[20:23], v[128:143]
    ds_read_b128 v[92:95], v2 offset:17408
    s_waitcnt lgkmcnt(6)
    v_mfma_f32_32x32x16_bf16 v[144:159], v[64:67], v[20:23], v[144:159]
    ds_read_b128 v[96:99], v2 offset:18432
    buffer_load_dwordx4 v[52:55], v2, s[20:23], s34 offen offset:1024
    v_mfma_f32_32x32x16_bf16 v[160:175], v[68:71], v[20:23], v[160:175]
    ds_read_b128 v[100:103], v2 offset:19456
    s_waitcnt lgkmcnt(6)
    v_mfma_f32_32x32x16_bf16 v[176:191], v[72:75], v[20:23], v[176:191]
    ds_read_b128 v[56:59], v2 offset:20480
    s_add_u32 m0, s35, 65536
    s_nop 0
    buffer_load_dwordx4 v2, s[20:23], s37 offen offset:0 lds
    v_mfma_f32_32x32x16_bf16 v[192:207], v[76:79], v[20:23], v[192:207]
    ds_read_b128 v[60:63], v2 offset:21504
    s_waitcnt lgkmcnt(6)
    v_mfma_f32_32x32x16_bf16 v[208:223], v[80:83], v[20:23], v[208:223]
    ds_read_b128 v[64:67], v2 offset:22528
    buffer_load_dwordx4 v2, s[20:23], s37 offen offset:1024 lds
    v_mfma_f32_32x32x16_bf16 v[224:239], v[84:87], v[20:23], v[224:239]
    ds_read_b128 v[68:71], v2 offset:23552
    s_waitcnt lgkmcnt(6)
    v_mfma_f32_32x32x16_bf16 v[112:127], v[88:91], v[24:27], v[112:127]
    ds_read_b128 v[72:75], v2 offset:24576
    buffer_load_dwordx4 v2, s[20:23], s37 offen offset:2048 lds
    v_mfma_f32_32x32x16_bf16 v[128:143], v[92:95], v[24:27], v[128:143]
    ds_read_b128 v[76:79], v2 offset:25600
    s_waitcnt lgkmcnt(6)
    v_mfma_f32_32x32x16_bf16 v[144:159], v[96:99], v[24:27], v[144:159]
    ds_read_b128 v[80:83], v2 offset:26624
    buffer_load_dwordx4 v2, s[20:23], s37 offen offset:3072 lds
    s_add_u32 s37, s37, 16384
    v_mfma_f32_32x32x16_bf16 v[160:175], v[100:103], v[24:27], v[160:175]
    ds_read_b128 v[84:87], v2 offset:27648
    s_waitcnt lgkmcnt(6)
    v_mfma_f32_32x32x16_bf16 v[176:191], v[56:59], v[24:27], v[176:191]
    ds_read_b128 v[88:91], v2 offset:28672
    v_mfma_f32_32x32x16_bf16 v[192:207], v[60:63], v[24:27], v[192:207]
    ds_read_b128 v[92:95], v2 offset:29696
    s_waitcnt lgkmcnt(6)
    v_mfma_f32_32x32x16_bf16 v[208:223], v[64:67], v[24:27], v[208:223]
    ds_read_b128 v[96:99], v2 offset:30720
    v_mfma_f32_32x32x16_bf16 v[224:239], v[68:71], v[24:27], v[224:239]
    ds_read_b128 v[100:103], v2 offset:31744
    s_waitcnt vmcnt(12)
    s_barrier
    s_waitcnt lgkmcnt(6)
    v_mfma_f32_32x32x16_bf16 v[112:127], v[72:75], v[28:31], v[112:127]
    ds_read_b128 v[56:59], v2 offset:32768
    buffer_load_dwordx4 v[16:19], v2, s[20:23], s34 offen offset:2048
    v_mfma_f32_32x32x16_bf16 v[128:143], v[76:79], v[28:31], v[128:143]
    ds_read_b128 v[60:63], v2 offset:33792
    s_waitcnt lgkmcnt(6)
    v_mfma_f32_32x32x16_bf16 v[144:159], v[80:83], v[28:31], v[144:159]
    ds_read_b128 v[64:67], v2 offset:34816
    buffer_load_dwordx4 v[20:23], v2, s[20:23], s34 offen offset:3072
    s_add_u32 s34, s34, 4096
    v_mfma_f32_32x32x16_bf16 v[160:175], v[84:87], v[28:31], v[160:175]
    ds_read_b128 v[68:71], v2 offset:35840
    s_waitcnt lgkmcnt(6)
    v_mfma_f32_32x32x16_bf16 v[176:191], v[88:91], v[28:31], v[176:191]
    ds_read_b128 v[72:75], v2 offset:36864
    s_add_u32 m0, s35, 0
    s_nop 0
    buffer_load_dwordx4 v2, s[20:23], s37 offen offset:0 lds
    v_mfma_f32_32x32x16_bf16 v[192:207], v[92:95], v[28:31], v[192:207]
    ds_read_b128 v[76:79], v2 offset:37888
    s_waitcnt lgkmcnt(6)
    v_mfma_f32_32x32x16_bf16 v[208:223], v[96:99], v[28:31], v[208:223]
    ds_read_b128 v[80:83], v2 offset:38912
    buffer_load_dwordx4 v2, s[20:23], s37 offen offset:1024 lds
    v_mfma_f32_32x32x16_bf16 v[224:239], v[100:103], v[28:31], v[224:239]
    ds_read_b128 v[84:87], v2 offset:39936
    s_waitcnt lgkmcnt(6)
    v_mfma_f32_32x32x16_bf16 v[112:127], v[56:59], v[32:35], v[112:127]
    ds_read_b128 v[88:91], v2 offset:40960
    buffer_load_dwordx4 v2, s[20:23], s37 offen offset:2048 lds
    v_mfma_f32_32x32x16_bf16 v[128:143], v[60:63], v[32:35], v[128:143]
    ds_read_b128 v[92:95], v2 offset:41984
    s_waitcnt lgkmcnt(6)
    v_mfma_f32_32x32x16_bf16 v[144:159], v[64:67], v[32:35], v[144:159]
    ds_read_b128 v[96:99], v2 offset:43008
    buffer_load_dwordx4 v2, s[20:23], s37 offen offset:3072 lds
    s_add_u32 s37, s37, 16384
    v_mfma_f32_32x32x16_bf16 v[160:175], v[68:71], v[32:35], v[160:175]
    ds_read_b128 v[100:103], v2 offset:44032
    s_waitcnt lgkmcnt(6)
    v_mfma_f32_32x32x16_bf16 v[176:191], v[72:75], v[32:35], v[176:191]
    ds_read_b128 v[56:59], v2 offset:45056
    v_mfma_f32_32x32x16_bf16 v[192:207], v[76:79], v[32:35], v[192:207]
    ds_read_b128 v[60:63], v2 offset:46080
    s_waitcnt lgkmcnt(6)
    v_mfma_f32_32x32x16_bf16 v[208:223], v[80:83], v[32:35], v[208:223]
    ds_read_b128 v[64:67], v2 offset:47104
    v_mfma_f32_32x32x16_bf16 v[224:239], v[84:87], v[32:35], v[224:239]
    ds_read_b128 v[68:71], v2 offset:48128
    s_waitcnt vmcnt(12)
    s_barrier
    s_waitcnt lgkmcnt(6)
    v_mfma_f32_32x32x16_bf16 v[112:127], v[88:91], v[36:39], v[112:127]
    ds_read_b128 v[72:75], v3 offset:0
    buffer_load_dwordx4 v[24:27], v2, s[20:23], s34 offen offset:0
    v_mfma_f32_32x32x16_bf16 v[128:143], v[92:95], v[36:39], v[128:143]
    ds_read_b128 v[76:79], v3 offset:1024
    s_waitcnt lgkmcnt(6)
    v_mfma_f32_32x32x16_bf16 v[144:159], v[96:99], v[36:39], v[144:159]
    ds_read_b128 v[80:83], v3 offset:2048
    buffer_load_dwordx4 v[28:31], v2, s[20:23], s34 offen offset:1024
    v_mfma_f32_32x32x16_bf16 v[160:175], v[100:103], v[36:39], v[160:175]
    ds_read_b128 v[84:87], v3 offset:3072
    s_waitcnt lgkmcnt(6)
    v_mfma_f32_32x32x16_bf16 v[176:191], v[56:59], v[36:39], v[176:191]
    ds_read_b128 v[88:91], v3 offset:4096
    s_add_u32 m0, s35, 16384
    s_nop 0
    buffer_load_dwordx4 v2, s[20:23], s37 offen offset:0 lds
    v_mfma_f32_32x32x16_bf16 v[192:207], v[60:63], v[36:39], v[192:207]
    ds_read_b128 v[92:95], v3 offset:5120
    s_waitcnt lgkmcnt(6)
    v_mfma_f32_32x32x16_bf16 v[208:223], v[64:67], v[36:39], v[208:223]
    ds_read_b128 v[96:99], v3 offset:6144
    buffer_load_dwordx4 v2, s[20:23], s37 offen offset:1024 lds
    v_mfma_f32_32x32x16_bf16 v[224:239], v[68:71], v[36:39], v[224:239]
    ds_read_b128 v[100:103], v3 offset:7168
    s_waitcnt lgkmcnt(6)
    v_mfma_f32_32x32x16_bf16 v[112:127], v[72:75], v[40:43], v[112:127]
    ds_read_b128 v[56:59], v3 offset:8192
    buffer_load_dwordx4 v2, s[20:23], s37 offen offset:2048 lds
    v_mfma_f32_32x32x16_bf16 v[128:143], v[76:79], v[40:43], v[128:143]
    ds_read_b128 v[60:63], v3 offset:9216
    s_waitcnt lgkmcnt(6)
    v_mfma_f32_32x32x16_bf16 v[144:159], v[80:83], v[40:43], v[144:159]
    ds_read_b128 v[64:67], v3 offset:10240
    buffer_load_dwordx4 v2, s[20:23], s37 offen offset:3072 lds
    s_add_u32 s37, s37, 16384
    v_mfma_f32_32x32x16_bf16 v[160:175], v[84:87], v[40:43], v[160:175]
    ds_read_b128 v[68:71], v3 offset:11264
    s_waitcnt lgkmcnt(6)
    v_mfma_f32_32x32x16_bf16 v[176:191], v[88:91], v[40:43], v[176:191]
    ds_read_b128 v[72:75], v3 offset:12288
    v_mfma_f32_32x32x16_bf16 v[192:207], v[92:95], v[40:43], v[192:207]
    ds_read_b128 v[76:79], v3 offset:13312
    s_waitcnt lgkmcnt(6)
    v_mfma_f32_32x32x16_bf16 v[208:223], v[96:99], v[40:43], v[208:223]
    ds_read_b128 v[80:83], v3 offset:14336
    v_mfma_f32_32x32x16_bf16 v[224:239], v[100:103], v[40:43], v[224:239]
    ds_read_b128 v[84:87], v3 offset:15360
    s_waitcnt vmcnt(12)
    s_barrier
    s_waitcnt lgkmcnt(6)
    v_mfma_f32_32x32x16_bf16 v[112:127], v[56:59], v[44:47], v[112:127]
    ds_read_b128 v[88:91], v3 offset:16384
    buffer_load_dwordx4 v[32:35], v2, s[20:23], s34 offen offset:2048
    v_mfma_f32_32x32x16_bf16 v[128:143], v[60:63], v[44:47], v[128:143]
    ds_read_b128 v[92:95], v3 offset:17408
    s_waitcnt lgkmcnt(6)
    v_mfma_f32_32x32x16_bf16 v[144:159], v[64:67], v[44:47], v[144:159]
    ds_read_b128 v[96:99], v3 offset:18432
    buffer_load_dwordx4 v[36:39], v2, s[20:23], s34 offen offset:3072
    s_add_u32 s34, s34, 4096
    v_mfma_f32_32x32x16_bf16 v[160:175], v[68:71], v[44:47], v[160:175]
    ds_read_b128 v[100:103], v3 offset:19456
    s_waitcnt lgkmcnt(6)
    v_mfma_f32_32x32x16_bf16 v[176:191], v[72:75], v[44:47], v[176:191]
    ds_read_b128 v[56:59], v3 offset:20480
    s_add_u32 m0, s35, 32768
    s_nop 0
    buffer_load_dwordx4 v2, s[20:23], s37 offen offset:0 lds
    v_mfma_f32_32x32x16_bf16 v[192:207], v[76:79], v[44:47], v[192:207]
    ds_read_b128 v[60:63], v3 offset:21504
    s_waitcnt lgkmcnt(6)
    v_mfma_f32_32x32x16_bf16 v[208:223], v[80:83], v[44:47], v[208:223]
    ds_read_b128 v[64:67], v3 offset:22528
    buffer_load_dwordx4 v2, s[20:23], s37 offen offset:1024 lds
    v_mfma_f32_32x32x16_bf16 v[224:239], v[84:87], v[44:47], v[224:239]
    ds_read_b128 v[68:71], v3 offset:23552
    s_waitcnt lgkmcnt(6)
    v_mfma_f32_32x32x16_bf16 v[112:127], v[88:91], v[48:51], v[112:127]
    ds_read_b128 v[72:75], v3 offset:24576
    buffer_load_dwordx4 v2, s[20:23], s37 offen offset:2048 lds
    v_mfma_f32_32x32x16_bf16 v[128:143], v[92:95], v[48:51], v[128:143]
    ds_read_b128 v[76:79], v3 offset:25600
    s_waitcnt lgkmcnt(6)
    v_mfma_f32_32x32x16_bf16 v[144:159], v[96:99], v[48:51], v[144:159]
    ds_read_b128 v[80:83], v3 offset:26624
    buffer_load_dwordx4 v2, s[20:23], s37 offen offset:3072 lds
    s_add_u32 s37, s37, 16384
    v_mfma_f32_32x32x16_bf16 v[160:175], v[100:103], v[48:51], v[160:175]
    ds_read_b128 v[84:87], v3 offset:27648
    s_waitcnt lgkmcnt(6)
    v_mfma_f32_32x32x16_bf16 v[176:191], v[56:59], v[48:51], v[176:191]
    ds_read_b128 v[88:91], v3 offset:28672
    v_mfma_f32_32x32x16_bf16 v[192:207], v[60:63], v[48:51], v[192:207]
    ds_read_b128 v[92:95], v3 offset:29696
    s_waitcnt lgkmcnt(6)
    v_mfma_f32_32x32x16_bf16 v[208:223], v[64:67], v[48:51], v[208:223]
    ds_read_b128 v[96:99], v3 offset:30720
    v_mfma_f32_32x32x16_bf16 v[224:239], v[68:71], v[48:51], v[224:239]
    ds_read_b128 v[100:103], v3 offset:31744
    s_waitcnt vmcnt(12)
    s_barrier
    s_waitcnt lgkmcnt(6)
    v_mfma_f32_32x32x16_bf16 v[112:127], v[72:75], v[52:55], v[112:127]
    ds_read_b128 v[56:59], v2 offset:0
    v_mfma_f32_32x32x16_bf16 v[128:143], v[76:79], v[52:55], v[128:143]
    ds_read_b128 v[60:63], v2 offset:1024
    s_waitcnt lgkmcnt(6)
    v_mfma_f32_32x32x16_bf16 v[144:159], v[80:83], v[52:55], v[144:159]
    ds_read_b128 v[64:67], v2 offset:2048
    v_mfma_f32_32x32x16_bf16 v[160:175], v[84:87], v[52:55], v[160:175]
    ds_read_b128 v[68:71], v2 offset:3072
    s_waitcnt lgkmcnt(6)
    v_mfma_f32_32x32x16_bf16 v[176:191], v[88:91], v[52:55], v[176:191]
    ds_read_b128 v[72:75], v2 offset:4096
    v_mfma_f32_32x32x16_bf16 v[192:207], v[92:95], v[52:55], v[192:207]
    ds_read_b128 v[76:79], v2 offset:5120
    s_waitcnt lgkmcnt(6)
    v_mfma_f32_32x32x16_bf16 v[208:223], v[96:99], v[52:55], v[208:223]
    ds_read_b128 v[80:83], v2 offset:6144
    v_mfma_f32_32x32x16_bf16 v[224:239], v[100:103], v[52:55], v[224:239]
    ds_read_b128 v[84:87], v2 offset:7168
    s_waitcnt lgkmcnt(6)
    v_mfma_f32_32x32x16_bf16 v[112:127], v[56:59], v[16:19], v[112:127]
    ds_read_b128 v[88:91], v2 offset:8192
    v_mfma_f32_32x32x16_bf16 v[128:143], v[60:63], v[16:19], v[128:143]
    ds_read_b128 v[92:95], v2 offset:9216
    s_waitcnt lgkmcnt(6)
    v_mfma_f32_32x32x16_bf16 v[144:159], v[64:67], v[16:19], v[144:159]
    ds_read_b128 v[96:99], v2 offset:10240
    v_mfma_f32_32x32x16_bf16 v[160:175], v[68:71], v[16:19], v[160:175]
    ds_read_b128 v[100:103], v2 offset:11264
    s_waitcnt lgkmcnt(6)
    v_mfma_f32_32x32x16_bf16 v[176:191], v[72:75], v[16:19], v[176:191]
    ds_read_b128 v[56:59], v2 offset:12288
    v_mfma_f32_32x32x16_bf16 v[192:207], v[76:79], v[16:19], v[192:207]
    ds_read_b128 v[60:63], v2 offset:13312
    s_waitcnt lgkmcnt(6)
    v_mfma_f32_32x32x16_bf16 v[208:223], v[80:83], v[16:19], v[208:223]
    ds_read_b128 v[64:67], v2 offset:14336
    v_mfma_f32_32x32x16_bf16 v[224:239], v[84:87], v[16:19], v[224:239]
    ds_read_b128 v[68:71], v2 offset:15360
    s_waitcnt vmcnt(6)
    s_barrier
    s_waitcnt lgkmcnt(6)
    v_mfma_f32_32x32x16_bf16 v[112:127], v[88:91], v[20:23], v[112:127]
    ds_read_b128 v[72:75], v2 offset:16384
    v_mfma_f32_32x32x16_bf16 v[128:143], v[92:95], v[20:23], v[128:143]
    ds_read_b128 v[76:79], v2 offset:17408
    s_waitcnt lgkmcnt(6)
    v_mfma_f32_32x32x16_bf16 v[144:159], v[96:99], v[20:23], v[144:159]
    ds_read_b128 v[80:83], v2 offset:18432
    v_mfma_f32_32x32x16_bf16 v[160:175], v[100:103], v[20:23], v[160:175]
    ds_read_b128 v[84:87], v2 offset:19456
    s_waitcnt lgkmcnt(6)
    v_mfma_f32_32x32x16_bf16 v[176:191], v[56:59], v[20:23], v[176:191]
    ds_read_b128 v[88:91], v2 offset:20480
    v_mfma_f32_32x32x16_bf16 v[192:207], v[60:63], v[20:23], v[192:207]
    ds_read_b128 v[92:95], v2 offset:21504
    s_waitcnt lgkmcnt(6)
    v_mfma_f32_32x32x16_bf16 v[208:223], v[64:67], v[20:23], v[208:223]
    ds_read_b128 v[96:99], v2 offset:22528
    v_mfma_f32_32x32x16_bf16 v[224:239], v[68:71], v[20:23], v[224:239]
    ds_read_b128 v[100:103], v2 offset:23552
    s_waitcnt lgkmcnt(6)
    v_mfma_f32_32x32x16_bf16 v[112:127], v[72:75], v[24:27], v[112:127]
    ds_read_b128 v[56:59], v2 offset:24576
    v_mfma_f32_32x32x16_bf16 v[128:143], v[76:79], v[24:27], v[128:143]
    ds_read_b128 v[60:63], v2 offset:25600
    s_waitcnt lgkmcnt(6)
    v_mfma_f32_32x32x16_bf16 v[144:159], v[80:83], v[24:27], v[144:159]
    ds_read_b128 v[64:67], v2 offset:26624
    v_mfma_f32_32x32x16_bf16 v[160:175], v[84:87], v[24:27], v[160:175]
    ds_read_b128 v[68:71], v2 offset:27648
    s_waitcnt lgkmcnt(6)
    v_mfma_f32_32x32x16_bf16 v[176:191], v[88:91], v[24:27], v[176:191]
    ds_read_b128 v[72:75], v2 offset:28672
    v_mfma_f32_32x32x16_bf16 v[192:207], v[92:95], v[24:27], v[192:207]
    ds_read_b128 v[76:79], v2 offset:29696
    s_waitcnt lgkmcnt(6)
    v_mfma_f32_32x32x16_bf16 v[208:223], v[96:99], v[24:27], v[208:223]
    ds_read_b128 v[80:83], v2 offset:30720
    v_mfma_f32_32x32x16_bf16 v[224:239], v[100:103], v[24:27], v[224:239]
    ds_read_b128 v[84:87], v2 offset:31744
    s_waitcnt vmcnt(0)
    s_barrier
    s_waitcnt lgkmcnt(6)
    v_mfma_f32_32x32x16_bf16 v[112:127], v[56:59], v[28:31], v[112:127]
    ds_read_b128 v[88:91], v2 offset:32768
    v_mfma_f32_32x32x16_bf16 v[128:143], v[60:63], v[28:31], v[128:143]
    ds_read_b128 v[92:95], v2 offset:33792
    s_waitcnt lgkmcnt(6)
    v_mfma_f32_32x32x16_bf16 v[144:159], v[64:67], v[28:31], v[144:159]
    ds_read_b128 v[96:99], v2 offset:34816
    v_mfma_f32_32x32x16_bf16 v[160:175], v[68:71], v[28:31], v[160:175]
    ds_read_b128 v[100:103], v2 offset:35840
    s_waitcnt lgkmcnt(6)
    v_mfma_f32_32x32x16_bf16 v[176:191], v[72:75], v[28:31], v[176:191]
    ds_read_b128 v[56:59], v2 offset:36864
    v_mfma_f32_32x32x16_bf16 v[192:207], v[76:79], v[28:31], v[192:207]
    ds_read_b128 v[60:63], v2 offset:37888
    s_waitcnt lgkmcnt(6)
    v_mfma_f32_32x32x16_bf16 v[208:223], v[80:83], v[28:31], v[208:223]
    ds_read_b128 v[64:67], v2 offset:38912
    v_mfma_f32_32x32x16_bf16 v[224:239], v[84:87], v[28:31], v[224:239]
    ds_read_b128 v[68:71], v2 offset:39936
    s_waitcnt lgkmcnt(6)
    v_mfma_f32_32x32x16_bf16 v[112:127], v[88:91], v[32:35], v[112:127]
    ds_read_b128 v[72:75], v2 offset:40960
    v_mfma_f32_32x32x16_bf16 v[128:143], v[92:95], v[32:35], v[128:143]
    ds_read_b128 v[76:79], v2 offset:41984
    s_waitcnt lgkmcnt(6)
    v_mfma_f32_32x32x16_bf16 v[144:159], v[96:99], v[32:35], v[144:159]
    ds_read_b128 v[80:83], v2 offset:43008
    v_mfma_f32_32x32x16_bf16 v[160:175], v[100:103], v[32:35], v[160:175]
    ds_read_b128 v[84:87], v2 offset:44032
    s_waitcnt lgkmcnt(6)
    v_mfma_f32_32x32x16_bf16 v[176:191], v[56:59], v[32:35], v[176:191]
    ds_read_b128 v[88:91], v2 offset:45056
    v_mfma_f32_32x32x16_bf16 v[192:207], v[60:63], v[32:35], v[192:207]
    ds_read_b128 v[92:95], v2 offset:46080
    s_waitcnt lgkmcnt(6)
    v_mfma_f32_32x32x16_bf16 v[208:223], v[64:67], v[32:35], v[208:223]
    ds_read_b128 v[96:99], v2 offset:47104
    v_mfma_f32_32x32x16_bf16 v[224:239], v[68:71], v[32:35], v[224:239]
    ds_read_b128 v[100:103], v2 offset:48128
    s_waitcnt lgkmcnt(6)
    v_mfma_f32_32x32x16_bf16 v[112:127], v[72:75], v[36:39], v[112:127]
    v_mfma_f32_32x32x16_bf16 v[128:143], v[76:79], v[36:39], v[128:143]
    s_waitcnt lgkmcnt(4)
    v_mfma_f32_32x32x16_bf16 v[144:159], v[80:83], v[36:39], v[144:159]
    v_mfma_f32_32x32x16_bf16 v[160:175], v[84:87], v[36:39], v[160:175]
    s_waitcnt lgkmcnt(2)
    v_mfma_f32_32x32x16_bf16 v[176:191], v[88:91], v[36:39], v[176:191]
    v_mfma_f32_32x32x16_bf16 v[192:207], v[92:95], v[36:39], v[192:207]
    s_waitcnt lgkmcnt(0)
    v_mfma_f32_32x32x16_bf16 v[208:223], v[96:99], v[36:39], v[208:223]
    v_mfma_f32_32x32x16_bf16 v[224:239], v[100:103], v[36:39], v[224:239]
    s_setprio 3
    s_nop 1
    v_cvt_pk_bf16_f32 v16, v128, v129
    v_cvt_pk_bf16_f32 v17, v130, v131
    v_cvt_pk_bf16_f32 v18, v132, v133
    v_cvt_pk_bf16_f32 v19, v134, v135
    v_cvt_pk_bf16_f32 v20, v136, v137
    v_cvt_pk_bf16_f32 v21, v138, v139
    v_cvt_pk_bf16_f32 v22, v140, v141
    v_cvt_pk_bf16_f32 v23, v142, v143
    buffer_store_dwordx4 v[16:19], v2, s[20:23], s49 offen offset:0 sc1
    buffer_store_dwordx4 v[20:23], v2, s[20:23], s50 offen offset:0 sc1
    v_cvt_pk_bf16_f32 v24, v144, v145
    v_cvt_pk_bf16_f32 v25, v146, v147
    v_cvt_pk_bf16_f32 v26, v148, v149
    v_cvt_pk_bf16_f32 v27, v150, v151
    v_cvt_pk_bf16_f32 v28, v152, v153
    v_cvt_pk_bf16_f32 v29, v154, v155
    v_cvt_pk_bf16_f32 v30, v156, v157
    v_cvt_pk_bf16_f32 v31, v158, v159
    buffer_store_dwordx4 v[24:27], v2, s[20:23], s49 offen offset:1024 sc1
    buffer_store_dwordx4 v[28:31], v2, s[20:23], s50 offen offset:1024 sc1
    v_mul_f32 v112, s51, v112
    v_mul_f32 v113, s51, v113
    v_mul_f32 v114, s51, v114
    v_mul_f32 v115, s51, v115
    v_mul_f32 v116, s51, v116
    v_mul_f32 v117, s51, v117
    v_mul_f32 v118, s51, v118
    v_mul_f32 v119, s51, v119
    v_mul_f32 v120, s51, v120
    v_mul_f32 v121, s51, v121
    v_mul_f32 v122, s51, v122
    v_mul_f32 v123, s51, v123
    v_mul_f32 v124, s51, v124
    v_mul_f32 v125, s51, v125
    v_mul_f32 v126, s51, v126
    v_mul_f32 v127, s51, v127
    v_cvt_pk_bf16_f32 v32, v112, v113
    v_cvt_pk_bf16_f32 v33, v114, v115
    v_cvt_pk_bf16_f32 v34, v116, v117
    v_cvt_pk_bf16_f32 v35, v118, v119
    v_cvt_pk_bf16_f32 v36, v120, v121
    v_cvt_pk_bf16_f32 v37, v122, v123
    v_cvt_pk_bf16_f32 v38, v124, v125
    v_cvt_pk_bf16_f32 v39, v126, v127
    buffer_store_dwordx4 v[32:35], v2, s[20:23], s48 offen offset:0 sc1
    buffer_store_dwordx4 v[36:39], v2, s[20:23], s59 offen offset:0 sc1
    v_mul_f32 v160, s51, v160
    v_mul_f32 v161, s51, v161
    v_cvt_pk_bf16_f32 v48, v160, v161
    v_cvt_pk_bf16_f32 v44, v162, v163
    v_mov_b32 v45, 0x3f803f80
    v_cvt_pk_bf16_f32 v46, v164, v165
    v_mov_b32_dpp v47, v44 row_shr:1 row_mask:0xf bank_mask:0xf
    v_cndmask_b32 v45, v45, v47, s[54:55]
    v_cndmask_b32 v45, v45, 0, s[56:57]
    v_cndmask_b32 v44, v44, 0, s[56:57]
    v_mov_b32 v47, 0x00003f80
    buffer_store_dwordx4 v[44:47], v5, s[20:23], s49 offen offset:2048 sc1
    buffer_store_dword v48, v4, s[20:23], s48 offen offset:1024 sc1
    v_mul_f32 v49, v128, v128
    v_mul_f32 v50, v136, v136
    v_fmac_f32 v49, v129, v129
    v_fmac_f32 v50, v137, v137
    v_fmac_f32 v49, v130, v130
    v_fmac_f32 v50, v138, v138
    v_fmac_f32 v49, v131, v131
    v_fmac_f32 v50, v139, v139
    v_fmac_f32 v49, v132, v132
    v_fmac_f32 v50, v140, v140
    v_fmac_f32 v49, v133, v133
    v_fmac_f32 v50, v141, v141
    v_fmac_f32 v49, v134, v134
    v_fmac_f32 v50, v142, v142
    v_fmac_f32 v49, v135, v135
    v_fmac_f32 v50, v143, v143
    s_nop 1
    v_permlane32_swap_b32 v49, v50
    v_add_f32 v49, v49, v50
    v_fmac_f32 v49, v162, v162
    v_fmac_f32 v49, v163, v163
    s_nop 1
    v_max_f32_dpp v49, v49, v49 quad_perm:[1,0,3,2] row_mask:0xf bank_mask:0xf
    s_nop 1
    v_max_f32_dpp v49, v49, v49 quad_perm:[2,3,0,1] row_mask:0xf bank_mask:0xf
    s_nop 1
    v_max_f32_dpp v49, v49, v49 row_half_mirror row_mask:0xf bank_mask:0xf
    s_nop 1
    v_max_f32_dpp v49, v49, v49 row_mirror row_mask:0xf bank_mask:0xf
    v_mov_b32 v50, v49
    s_nop 1
    v_permlane16_swap_b32 v49, v50
    v_max_f32 v49, v49, v50
    s_mov_b32 exec_lo, 1
    s_mov_b32 exec_hi, 1
    buffer_store_dword v49, v6, s[20:23], s52 offen sc1
    s_mov_b64 exec, -1
    s_setprio 1
    s_mov_b32 s56, 0xc0135761
    v_mul_f32 v240, v176, v176
    v_mul_f32 v241, v177, v177
    v_mul_f32 v242, v178, v178
    v_mul_f32 v243, v179, v179
    v_mul_f32 v244, v180, v180
    v_mul_f32 v245, v181, v181
    v_mul_f32 v246, v182, v182
    v_mul_f32 v247, v183, v183
    v_fma_f32 v240, v240, v249, s56
    v_fma_f32 v241, v241, v249, s56
    v_fma_f32 v242, v242, v249, s56
    v_fma_f32 v243, v243, v249, s56
    v_fma_f32 v244, v244, v249, s56
    v_fma_f32 v245, v245, v249, s56
    v_fma_f32 v246, v246, v249, s56
    v_fma_f32 v247, v247, v249, s56
    v_mul_f32 v240, v240, v176
    v_mul_f32 v241, v241, v177
    v_mul_f32 v242, v242, v178
    v_mul_f32 v243, v243, v179
    v_mul_f32 v244, v244, v180
    v_mul_f32 v245, v245, v181
    v_mul_f32 v246, v246, v182
    v_mul_f32 v247, v247, v183
    v_exp_f32 v240, v240
    v_exp_f32 v241, v241
    v_exp_f32 v242, v242
    v_exp_f32 v243, v243
    v_exp_f32 v244, v244
    v_exp_f32 v245, v245
    v_exp_f32 v246, v246
    v_exp_f32 v247, v247
    v_add_f32 v240, 1.0, v240
    v_add_f32 v241, 1.0, v241
    v_add_f32 v242, 1.0, v242
    v_add_f32 v243, 1.0, v243
    v_add_f32 v244, 1.0, v244
    v_add_f32 v245, 1.0, v245
    v_add_f32 v246, 1.0, v246
    v_add_f32 v247, 1.0, v247
    v_rcp_f32 v240, v240
    v_rcp_f32 v241, v241
    v_rcp_f32 v242, v242
    v_rcp_f32 v243, v243
    v_rcp_f32 v244, v244
    v_rcp_f32 v245, v245
    v_rcp_f32 v246, v246
    v_rcp_f32 v247, v247
    v_mul_f32 v176, v176, v240
    v_mul_f32 v177, v177, v241
    v_mul_f32 v178, v178, v242
    v_mul_f32 v179, v179, v243
    v_mul_f32 v180, v180, v244
    v_mul_f32 v181, v181, v245
    v_mul_f32 v182, v182, v246
    v_mul_f32 v183, v183, v247
    v_cvt_pk_bf16_f32 v176, v176, v177
    v_cvt_pk_bf16_f32 v177, v178, v179
    v_cvt_pk_bf16_f32 v178, v180, v181
    v_cvt_pk_bf16_f32 v179, v182, v183
    v_mul_f32 v240, v184, v184
    v_mul_f32 v241, v185, v185
    v_mul_f32 v242, v186, v186
    v_mul_f32 v243, v187, v187
    v_mul_f32 v244, v188, v188
    v_mul_f32 v245, v189, v189
    v_mul_f32 v246, v190, v190
    v_mul_f32 v247, v191, v191
    v_fma_f32 v240, v240, v249, s56
    v_fma_f32 v241, v241, v249, s56
    v_fma_f32 v242, v242, v249, s56
    v_fma_f32 v243, v243, v249, s56
    v_fma_f32 v244, v244, v249, s56
    v_fma_f32 v245, v245, v249, s56
    v_fma_f32 v246, v246, v249, s56
    v_fma_f32 v247, v247, v249, s56
    v_mul_f32 v240, v240, v184
    v_mul_f32 v241, v241, v185
    v_mul_f32 v242, v242, v186
    v_mul_f32 v243, v243, v187
    v_mul_f32 v244, v244, v188
    v_mul_f32 v245, v245, v189
    v_mul_f32 v246, v246, v190
    v_mul_f32 v247, v247, v191
    v_exp_f32 v240, v240
    v_exp_f32 v241, v241
    v_exp_f32 v242, v242
    v_exp_f32 v243, v243
    v_exp_f32 v244, v244
    v_exp_f32 v245, v245
    v_exp_f32 v246, v246
    v_exp_f32 v247, v247
    v_add_f32 v240, 1.0, v240
    v_add_f32 v241, 1.0, v241
    v_add_f32 v242, 1.0, v242
    v_add_f32 v243, 1.0, v243
    v_add_f32 v244, 1.0, v244
    v_add_f32 v245, 1.0, v245
    v_add_f32 v246, 1.0, v246
    v_add_f32 v247, 1.0, v247
    v_rcp_f32 v240, v240
    v_rcp_f32 v241, v241
    v_rcp_f32 v242, v242
    v_rcp_f32 v243, v243
    v_rcp_f32 v244, v244
    v_rcp_f32 v245, v245
    v_rcp_f32 v246, v246
    v_rcp_f32 v247, v247
    v_mul_f32 v184, v184, v240
    v_mul_f32 v185, v185, v241
    v_mul_f32 v186, v186, v242
    v_mul_f32 v187, v187, v243
    v_mul_f32 v188, v188, v244
    v_mul_f32 v189, v189, v245
    v_mul_f32 v190, v190, v246
    v_mul_f32 v191, v191, v247
    v_cvt_pk_bf16_f32 v184, v184, v185
    v_cvt_pk_bf16_f32 v185, v186, v187
    v_cvt_pk_bf16_f32 v186, v188, v189
    v_cvt_pk_bf16_f32 v187, v190, v191
    v_mul_f32 v240, v192, v192
    v_mul_f32 v241, v193, v193
    v_mul_f32 v242, v194, v194
    v_mul_f32 v243, v195, v195
    v_mul_f32 v244, v196, v196
    v_mul_f32 v245, v197, v197
    v_mul_f32 v246, v198, v198
    v_mul_f32 v247, v199, v199
    v_fma_f32 v240, v240, v249, s56
    v_fma_f32 v241, v241, v249, s56
    v_fma_f32 v242, v242, v249, s56
    v_fma_f32 v243, v243, v249, s56
    v_fma_f32 v244, v244, v249, s56
    v_fma_f32 v245, v245, v249, s56
    v_fma_f32 v246, v246, v249, s56
    v_fma_f32 v247, v247, v249, s56
    v_mul_f32 v240, v240, v192
    v_mul_f32 v241, v241, v193
    v_mul_f32 v242, v242, v194
    v_mul_f32 v243, v243, v195
    v_mul_f32 v244, v244, v196
    v_mul_f32 v245, v245, v197
    v_mul_f32 v246, v246, v198
    v_mul_f32 v247, v247, v199
    v_exp_f32 v240, v240
    v_exp_f32 v241, v241
    v_exp_f32 v242, v242
    v_exp_f32 v243, v243
    v_exp_f32 v244, v244
    v_exp_f32 v245, v245
    v_exp_f32 v246, v246
    v_exp_f32 v247, v247
    v_add_f32 v240, 1.0, v240
    v_add_f32 v241, 1.0, v241
    v_add_f32 v242, 1.0, v242
    v_add_f32 v243, 1.0, v243
    v_add_f32 v244, 1.0, v244
    v_add_f32 v245, 1.0, v245
    v_add_f32 v246, 1.0, v246
    v_add_f32 v247, 1.0, v247
    v_rcp_f32 v240, v240
    v_rcp_f32 v241, v241
    v_rcp_f32 v242, v242
    v_rcp_f32 v243, v243
    v_rcp_f32 v244, v244
    v_rcp_f32 v245, v245
    v_rcp_f32 v246, v246
    v_rcp_f32 v247, v247
    v_mul_f32 v192, v192, v240
    v_mul_f32 v193, v193, v241
    v_mul_f32 v194, v194, v242
    v_mul_f32 v195, v195, v243
    v_mul_f32 v196, v196, v244
    v_mul_f32 v197, v197, v245
    v_mul_f32 v198, v198, v246
    v_mul_f32 v199, v199, v247
    v_cvt_pk_bf16_f32 v192, v192, v193
    v_cvt_pk_bf16_f32 v193, v194, v195
    v_cvt_pk_bf16_f32 v194, v196, v197
    v_cvt_pk_bf16_f32 v195, v198, v199
    v_mul_f32 v240, v200, v200
    v_mul_f32 v241, v201, v201
    v_mul_f32 v242, v202, v202
    v_mul_f32 v243, v203, v203
    v_mul_f32 v244, v204, v204
    v_mul_f32 v245, v205, v205
    v_mul_f32 v246, v206, v206
    v_mul_f32 v247, v207, v207
    v_fma_f32 v240, v240, v249, s56
    v_fma_f32 v241, v241, v249, s56
    v_fma_f32 v242, v242, v249, s56
    v_fma_f32 v243, v243, v249, s56
    v_fma_f32 v244, v244, v249, s56
    v_fma_f32 v245, v245, v249, s56
    v_fma_f32 v246, v246, v249, s56
    v_fma_f32 v247, v247, v249, s56
    v_mul_f32 v240, v240, v200
    v_mul_f32 v241, v241, v201
    v_mul_f32 v242, v242, v202
    v_mul_f32 v243, v243, v203
    v_mul_f32 v244, v244, v204
    v_mul_f32 v245, v245, v205
    v_mul_f32 v246, v246, v206
    v_mul_f32 v247, v247, v207
    v_exp_f32 v240, v240
    v_exp_f32 v241, v241
    v_exp_f32 v242, v242
    v_exp_f32 v243, v243
    v_exp_f32 v244, v244
    v_exp_f32 v245, v245
    v_exp_f32 v246, v246
    v_exp_f32 v247, v247
    v_add_f32 v240, 1.0, v240
    v_add_f32 v241, 1.0, v241
    v_add_f32 v242, 1.0, v242
    v_add_f32 v243, 1.0, v243
    v_add_f32 v244, 1.0, v244
    v_add_f32 v245, 1.0, v245
    v_add_f32 v246, 1.0, v246
    v_add_f32 v247, 1.0, v247
    v_rcp_f32 v240, v240
    v_rcp_f32 v241, v241
    v_rcp_f32 v242, v242
    v_rcp_f32 v243, v243
    v_rcp_f32 v244, v244
    v_rcp_f32 v245, v245
    v_rcp_f32 v246, v246
    v_rcp_f32 v247, v247
    v_mul_f32 v200, v200, v240
    v_mul_f32 v201, v201, v241
    v_mul_f32 v202, v202, v242
    v_mul_f32 v203, v203, v243
    v_mul_f32 v204, v204, v244
    v_mul_f32 v205, v205, v245
    v_mul_f32 v206, v206, v246
    v_mul_f32 v207, v207, v247
    v_cvt_pk_bf16_f32 v200, v200, v201
    v_cvt_pk_bf16_f32 v201, v202, v203
    v_cvt_pk_bf16_f32 v202, v204, v205
    v_cvt_pk_bf16_f32 v203, v206, v207
    s_waitcnt vmcnt(0)
    s_barrier
    s_cmp_lg_u32 s32, 0
    s_cbranch_scc1 QK_F1
    v_mov_b32 v8, 0
    v_mov_b32 v9, 1
    s_mov_b64 exec, 1
    buffer_store_dword v9, v8, s[20:23], s53 offen sc1
    s_mov_b64 exec, -1
QK_F1:
    v_mul_f32 v240, v208, v208
    v_mul_f32 v241, v209, v209
    v_mul_f32 v242, v210, v210
    v_mul_f32 v243, v211, v211
    v_mul_f32 v244, v212, v212
    v_mul_f32 v245, v213, v213
    v_mul_f32 v246, v214, v214
    v_mul_f32 v247, v215, v215
    v_fma_f32 v240, v240, v249, s56
    v_fma_f32 v241, v241, v249, s56
    v_fma_f32 v242, v242, v249, s56
    v_fma_f32 v243, v243, v249, s56
    v_fma_f32 v244, v244, v249, s56
    v_fma_f32 v245, v245, v249, s56
    v_fma_f32 v246, v246, v249, s56
    v_fma_f32 v247, v247, v249, s56
    v_mul_f32 v240, v240, v208
    v_mul_f32 v241, v241, v209
    v_mul_f32 v242, v242, v210
    v_mul_f32 v243, v243, v211
    v_mul_f32 v244, v244, v212
    v_mul_f32 v245, v245, v213
    v_mul_f32 v246, v246, v214
    v_mul_f32 v247, v247, v215
    v_exp_f32 v240, v240
    v_exp_f32 v241, v241
    v_exp_f32 v242, v242
    v_exp_f32 v243, v243
    v_exp_f32 v244, v244
    v_exp_f32 v245, v245
    v_exp_f32 v246, v246
    v_exp_f32 v247, v247
    v_add_f32 v240, 1.0, v240
    v_add_f32 v241, 1.0, v241
    v_add_f32 v242, 1.0, v242
    v_add_f32 v243, 1.0, v243
    v_add_f32 v244, 1.0, v244
    v_add_f32 v245, 1.0, v245
    v_add_f32 v246, 1.0, v246
    v_add_f32 v247, 1.0, v247
    v_rcp_f32 v240, v240
    v_rcp_f32 v241, v241
    v_rcp_f32 v242, v242
    v_rcp_f32 v243, v243
    v_rcp_f32 v244, v244
    v_rcp_f32 v245, v245
    v_rcp_f32 v246, v246
    v_rcp_f32 v247, v247
    v_mul_f32 v208, v208, v240
    v_mul_f32 v209, v209, v241
    v_mul_f32 v210, v210, v242
    v_mul_f32 v211, v211, v243
    v_mul_f32 v212, v212, v244
    v_mul_f32 v213, v213, v245
    v_mul_f32 v214, v214, v246
    v_mul_f32 v215, v215, v247
    v_cvt_pk_bf16_f32 v208, v208, v209
    v_cvt_pk_bf16_f32 v209, v210, v211
    v_cvt_pk_bf16_f32 v210, v212, v213
    v_cvt_pk_bf16_f32 v211, v214, v215
    v_mul_f32 v240, v216, v216
    v_mul_f32 v241, v217, v217
    v_mul_f32 v242, v218, v218
    v_mul_f32 v243, v219, v219
    v_mul_f32 v244, v220, v220
    v_mul_f32 v245, v221, v221
    v_mul_f32 v246, v222, v222
    v_mul_f32 v247, v223, v223
    v_fma_f32 v240, v240, v249, s56
    v_fma_f32 v241, v241, v249, s56
    v_fma_f32 v242, v242, v249, s56
    v_fma_f32 v243, v243, v249, s56
    v_fma_f32 v244, v244, v249, s56
    v_fma_f32 v245, v245, v249, s56
    v_fma_f32 v246, v246, v249, s56
    v_fma_f32 v247, v247, v249, s56
    v_mul_f32 v240, v240, v216
    v_mul_f32 v241, v241, v217
    v_mul_f32 v242, v242, v218
    v_mul_f32 v243, v243, v219
    v_mul_f32 v244, v244, v220
    v_mul_f32 v245, v245, v221
    v_mul_f32 v246, v246, v222
    v_mul_f32 v247, v247, v223
    v_exp_f32 v240, v240
    v_exp_f32 v241, v241
    v_exp_f32 v242, v242
    v_exp_f32 v243, v243
    v_exp_f32 v244, v244
    v_exp_f32 v245, v245
    v_exp_f32 v246, v246
    v_exp_f32 v247, v247
    v_add_f32 v240, 1.0, v240
    v_add_f32 v241, 1.0, v241
    v_add_f32 v242, 1.0, v242
    v_add_f32 v243, 1.0, v243
    v_add_f32 v244, 1.0, v244
    v_add_f32 v245, 1.0, v245
    v_add_f32 v246, 1.0, v246
    v_add_f32 v247, 1.0, v247
    v_rcp_f32 v240, v240
    v_rcp_f32 v241, v241
    v_rcp_f32 v242, v242
    v_rcp_f32 v243, v243
    v_rcp_f32 v244, v244
    v_rcp_f32 v245, v245
    v_rcp_f32 v246, v246
    v_rcp_f32 v247, v247
    v_mul_f32 v216, v216, v240
    v_mul_f32 v217, v217, v241
    v_mul_f32 v218, v218, v242
    v_mul_f32 v219, v219, v243
    v_mul_f32 v220, v220, v244
    v_mul_f32 v221, v221, v245
    v_mul_f32 v222, v222, v246
    v_mul_f32 v223, v223, v247
    v_cvt_pk_bf16_f32 v216, v216, v217
    v_cvt_pk_bf16_f32 v217, v218, v219
    v_cvt_pk_bf16_f32 v218, v220, v221
    v_cvt_pk_bf16_f32 v219, v222, v223
    v_mul_f32 v240, v224, v224
    v_mul_f32 v241, v225, v225
    v_mul_f32 v242, v226, v226
    v_mul_f32 v243, v227, v227
    v_mul_f32 v244, v228, v228
    v_mul_f32 v245, v229, v229
    v_mul_f32 v246, v230, v230
    v_mul_f32 v247, v231, v231
    v_fma_f32 v240, v240, v249, s56
    v_fma_f32 v241, v241, v249, s56
    v_fma_f32 v242, v242, v249, s56
    v_fma_f32 v243, v243, v249, s56
    v_fma_f32 v244, v244, v249, s56
    v_fma_f32 v245, v245, v249, s56
    v_fma_f32 v246, v246, v249, s56
    v_fma_f32 v247, v247, v249, s56
    v_mul_f32 v240, v240, v224
    v_mul_f32 v241, v241, v225
    v_mul_f32 v242, v242, v226
    v_mul_f32 v243, v243, v227
    v_mul_f32 v244, v244, v228
    v_mul_f32 v245, v245, v229
    v_mul_f32 v246, v246, v230
    v_mul_f32 v247, v247, v231
    v_exp_f32 v240, v240
    v_exp_f32 v241, v241
    v_exp_f32 v242, v242
    v_exp_f32 v243, v243
    v_exp_f32 v244, v244
    v_exp_f32 v245, v245
    v_exp_f32 v246, v246
    v_exp_f32 v247, v247
    v_add_f32 v240, 1.0, v240
    v_add_f32 v241, 1.0, v241
    v_add_f32 v242, 1.0, v242
    v_add_f32 v243, 1.0, v243
    v_add_f32 v244, 1.0, v244
    v_add_f32 v245, 1.0, v245
    v_add_f32 v246, 1.0, v246
    v_add_f32 v247, 1.0, v247
    v_rcp_f32 v240, v240
    v_rcp_f32 v241, v241
    v_rcp_f32 v242, v242
    v_rcp_f32 v243, v243
    v_rcp_f32 v244, v244
    v_rcp_f32 v245, v245
    v_rcp_f32 v246, v246
    v_rcp_f32 v247, v247
    v_mul_f32 v224, v224, v240
    v_mul_f32 v225, v225, v241
    v_mul_f32 v226, v226, v242
    v_mul_f32 v227, v227, v243
    v_mul_f32 v228, v228, v244
    v_mul_f32 v229, v229, v245
    v_mul_f32 v230, v230, v246
    v_mul_f32 v231, v231, v247
    v_cvt_pk_bf16_f32 v224, v224, v225
    v_cvt_pk_bf16_f32 v225, v226, v227
    v_cvt_pk_bf16_f32 v226, v228, v229
    v_cvt_pk_bf16_f32 v227, v230, v231
    s_setprio 3
    s_mov_b32 s12, s24
    s_and_b32 s13, s25, 0xffff
    s_mov_b32 s14, 2654208
    s_mov_b32 s15, 0x00020000
    v_and_b32 v1, 63, v0
    v_lshrrev_b32 v6, 6, v0
    s_and_b32 s28, s3, 7
    s_lshr_b32 s29, s3, 3
    s_lshl_b32 s30, s28, 2
    s_lshr_b32 s31, s29, 3
    s_add_u32 s30, s30, s31
    s_and_b32 s31, s29, 7
    v_readfirstlane_b32 s32, v6
    v_lshlrev_b32 v5, 4, v1
    s_mul_i32 s33, s30, 163840
    s_add_u32 s33, s33, 7077888
    s_mul_i32 s35, s32, 5120
    s_lshl_b32 s36, s31, 3
    s_lshl_b32 s37, s32, 1
    s_add_u32 s36, s36, s37
    s_lshl_b32 s37, s30, 6
    s_add_u32 s37, s37, s36
    s_mul_i32 s37, s37, 1152
    s_add_u32 s37, s37, 2359296
    s_lshl_b32 s38, s30, 8
    s_add_u32 s38, s38, 12320768
    v_lshlrev_b32 v7, 2, v1
    v_mov_b32 v104, 0
    v_mov_b32 v108, 0
    s_cmp_lg_u32 s32, 0
    s_cbranch_scc1 ATKV_OK
    s_lshr_b32 s44, s30, 1
    s_lshl_b32 s44, s44, 7
    s_add_u32 s44, s44, 12603392
    v_and_b32 v8, 15, v1
    v_lshlrev_b32 v8, 2, v8
    s_mov_b32 s47, 0
    buffer_load_dword v9, v8, s[20:23], s44 offen sc1
ATKV_P:
    s_waitcnt vmcnt(0)
    v_cmp_eq_u32 vcc, 0, v9
    s_nop 1
    s_cmp_eq_u64 vcc, 0
    s_cbranch_scc1 ATKV_OK
    s_add_u32 s47, s47, 1
    s_cmp_ge_u32 s47, 0x40000
    s_cbranch_scc1 ATKV_OK
    s_sleep 6
    buffer_load_dword v9, v8, s[20:23], s44 offen sc1
    s_branch ATKV_P
ATKV_OK:
    s_barrier
    buffer_load_dwordx4 v[96:99], v5, s[20:23], s37 offen sc1
    buffer_load_dwordx4 v[100:103], v5, s[20:23], s37 offen offset:1152 sc1
    buffer_load_dword v144, v7, s[20:23], s38 offen sc1
    s_mov_b32 exec_hi, 0
    buffer_load_dword v104, v7, s[20:23], s37 offen offset:1024 sc1
    buffer_load_dword v108, v7, s[20:23], s37 offen offset:2176 sc1
    s_mov_b32 exec_hi, -1
    s_mov_b32 s39, 0
AT_PASS:
    s_add_u32 s34, s33, s35
    s_mov_b32 s40, s35
    s_mov_b32 m0, s40
    s_add_u32 s41, s34, 4096
    buffer_load_dwordx4 v5, s[20:23], s34 offen sc1 lds
    buffer_load_dwordx4 v5, s[20:23], s34 offen offset:1024 sc1 lds
    buffer_load_dwordx4 v5, s[20:23], s34 offen offset:2048 sc1 lds
    buffer_load_dwordx4 v5, s[20:23], s34 offen offset:3072 sc1 lds
    s_add_u32 m0, s40, 4096
    s_add_u32 s34, s34, 20480
    buffer_load_dwordx4 v5, s[20:23], s41 offen sc1 lds
    s_add_u32 s40, s40, 20480
    s_sub_u32 s41, s40, 81920
    s_cmp_ge_u32 s40, 81920
    s_cselect_b32 s40, s41, s40
    s_mov_b32 m0, s40
    s_add_u32 s41, s34, 4096
    buffer_load_dwordx4 v5, s[20:23], s34 offen sc1 lds
    buffer_load_dwordx4 v5, s[20:23], s34 offen offset:1024 sc1 lds
    buffer_load_dwordx4 v5, s[20:23], s34 offen offset:2048 sc1 lds
    buffer_load_dwordx4 v5, s[20:23], s34 offen offset:3072 sc1 lds
    s_add_u32 m0, s40, 4096
    s_add_u32 s34, s34, 20480
    buffer_load_dwordx4 v5, s[20:23], s41 offen sc1 lds
    s_add_u32 s40, s40, 20480
    s_sub_u32 s41, s40, 81920
    s_cmp_ge_u32 s40, 81920
    s_cselect_b32 s40, s41, s40
    s_mov_b32 m0, s40
    s_add_u32 s41, s34, 4096
    buffer_load_dwordx4 v5, s[20:23], s34 offen sc1 lds
    buffer_load_dwordx4 v5, s[20:23], s34 offen offset:1024 sc1 lds
    buffer_load_dwordx4 v5, s[20:23], s34 offen offset:2048 sc1 lds
    buffer_load_dwordx4 v5, s[20:23], s34 offen offset:3072 sc1 lds
    s_add_u32 m0, s40, 4096
    s_add_u32 s34, s34, 20480
    buffer_load_dwordx4 v5, s[20:23], s41 offen sc1 lds
    s_add_u32 s40, s40, 20480
    s_sub_u32 s41, s40, 81920
    s_cmp_ge_u32 s40, 81920
    s_cselect_b32 s40, s41, s40
    v_mov_b32 v2, v5
    v_and_b32 v8, 31, v1
    v_lshrrev_b32 v9, 5, v1
    v_lshlrev_b32 v3, 4, v8
    v_add_u32 v10, 20, v3
    v_and_b32 v11, 7, v8
    v_cmp_eq_u32 vcc, 0, v11
    s_nop 1
    v_cndmask_b32 v3, v3, v10, vcc
    v_mov_b32 v10, 36
    v_cmp_ne_u32 vcc, 0, v9
    s_nop 1
    v_cndmask_b32 v3, v3, v10, vcc
    v_mov_b32 v14, v3
    v_add_u32 v3, 2048, v3
    v_bfe_u32 v10, v1, 2, 2
    v_lshl_add_u32 v10, v9, 2, v10
    v_lshlrev_b32 v10, 4, v10
    v_and_b32 v11, 1, v1
    v_lshlrev_b32 v11, 9, v11
    v_bfe_u32 v12, v1, 1, 1
    v_lshl_add_u32 v11, v12, 3, v11
    v_add_u32 v11, 1024, v11
    v_mov_b32 v12, 2056
    v_and_b32 v13, 16, v1
    v_cmp_ne_u32 vcc, 0, v13
    s_nop 1
    v_cndmask_b32 v11, v11, v12, vcc
    v_add_u32 v4, v10, v11
    v_and_b32 v13, 19, v1
    v_mov_b32 v12, 2048
    v_cmp_lt_u32 vcc, 16, v13
    s_nop 1
    v_cndmask_b32 v4, v4, v12, vcc
    v_mov_b32 v48, 0
    v_mov_b32 v49, 0
    v_mov_b32 v50, 0
    v_mov_b32 v51, 0
    v_mov_b32 v52, 0
    v_mov_b32 v53, 0
    v_mov_b32 v54, 0
    v_mov_b32 v55, 0
    v_mov_b32 v56, 0
    v_mov_b32 v57, 0
    v_mov_b32 v58, 0
    v_mov_b32 v59, 0
    v_mov_b32 v60, 0
    v_mov_b32 v61, 0
    v_mov_b32 v62, 0
    v_mov_b32 v63, 0
    v_mov_b32 v64, 0
    v_mov_b32 v65, 0
    v_mov_b32 v66, 0
    v_mov_b32 v67, 0
    v_mov_b32 v68, 0
    v_mov_b32 v69, 0
    v_mov_b32 v70, 0
    v_mov_b32 v71, 0
    v_mov_b32 v72, 0
    v_mov_b32 v73, 0
    v_mov_b32 v74, 0
    v_mov_b32 v75, 0
    v_mov_b32 v76, 0
    v_mov_b32 v77, 0
    v_mov_b32 v78, 0
    v_mov_b32 v79, 0
    v_mov_b32 v92, 0
    v_mov_b32 v93, 0
    v_mov_b32 v94, 0
    v_mov_b32 v95, 0
    v_mov_b32 v136, 0
    v_mov_b32 v137, 0
    v_mov_b32 v138, 0
    v_mov_b32 v139, 0
    v_mov_b32 v140, 0
    v_mov_b32 v141, 0
    v_mov_b32 v142, 0
    v_mov_b32 v143, 0
    v_mov_b32 v105, 0
    v_mov_b32 v106, 0
    v_mov_b32 v107, 0
    v_mov_b32 v109, 0
    v_mov_b32 v110, 0
    v_mov_b32 v111, 0
    v_mov_b32 v121, 0
    v_mov_b32 v122, 0
    v_mov_b32 v123, 0
    v_mov_b32 v125, 0
    v_mov_b32 v126, 0
    v_mov_b32 v127, 0
    s_cmp_lg_u32 s39, 0
    s_cbranch_scc1 AT_GO
    v_mul_f32 v240, v232, v232
    v_mul_f32 v241, v233, v233
    v_mul_f32 v242, v234, v234
    v_mul_f32 v243, v235, v235
    v_mul_f32 v244, v236, v236
    v_mul_f32 v245, v237, v237
    v_mul_f32 v246, v238, v238
    v_mul_f32 v247, v239, v239
    v_fma_f32 v240, v240, v249, s56
    v_fma_f32 v241, v241, v249, s56
    v_fma_f32 v242, v242, v249, s56
    v_fma_f32 v243, v243, v249, s56
    v_fma_f32 v244, v244, v249, s56
    v_fma_f32 v245, v245, v249, s56
    v_fma_f32 v246, v246, v249, s56
    v_fma_f32 v247, v247, v249, s56
    v_mul_f32 v240, v240, v232
    v_mul_f32 v241, v241, v233
    v_mul_f32 v242, v242, v234
    v_mul_f32 v243, v243, v235
    v_mul_f32 v244, v244, v236
    v_mul_f32 v245, v245, v237
    v_mul_f32 v246, v246, v238
    v_mul_f32 v247, v247, v239
    v_exp_f32 v240, v240
    v_exp_f32 v241, v241
    v_exp_f32 v242, v242
    v_exp_f32 v243, v243
    v_exp_f32 v244, v244
    v_exp_f32 v245, v245
    v_exp_f32 v246, v246
    v_exp_f32 v247, v247
    v_add_f32 v240, 1.0, v240
    v_add_f32 v241, 1.0, v241
    v_add_f32 v242, 1.0, v242
    v_add_f32 v243, 1.0, v243
    v_add_f32 v244, 1.0, v244
    v_add_f32 v245, 1.0, v245
    v_add_f32 v246, 1.0, v246
    v_add_f32 v247, 1.0, v247
    v_rcp_f32 v240, v240
    v_rcp_f32 v241, v241
    v_rcp_f32 v242, v242
    v_rcp_f32 v243, v243
    v_rcp_f32 v244, v244
    v_rcp_f32 v245, v245
    v_rcp_f32 v246, v246
    v_rcp_f32 v247, v247
    v_mul_f32 v232, v232, v240
    v_mul_f32 v233, v233, v241
    v_mul_f32 v234, v234, v242
    v_mul_f32 v235, v235, v243
    v_mul_f32 v236, v236, v244
    v_mul_f32 v237, v237, v245
    v_mul_f32 v238, v238, v246
    v_mul_f32 v239, v239, v247
    v_cvt_pk_bf16_f32 v232, v232, v233
    v_cvt_pk_bf16_f32 v233, v234, v235
    v_cvt_pk_bf16_f32 v234, v236, v237
    v_cvt_pk_bf16_f32 v235, v238, v239
    v_mul_f32 v240, v168, v168
    v_mul_f32 v241, v169, v169
    v_mul_f32 v242, v170, v170
    v_mul_f32 v243, v171, v171
    v_mul_f32 v244, v172, v172
    v_mul_f32 v245, v173, v173
    v_mul_f32 v246, v174, v174
    v_mul_f32 v247, v175, v175
    v_fma_f32 v240, v240, v249, s56
    v_fma_f32 v241, v241, v249, s56
    v_fma_f32 v242, v242, v249, s56
    v_fma_f32 v243, v243, v249, s56
    v_fma_f32 v244, v244, v249, s56
    v_fma_f32 v245, v245, v249, s56
    v_fma_f32 v246, v246, v249, s56
    v_fma_f32 v247, v247, v249, s56
    v_mul_f32 v240, v240, v168
    v_mul_f32 v241, v241, v169
    v_mul_f32 v242, v242, v170
    v_mul_f32 v243, v243, v171
    v_mul_f32 v244, v244, v172
    v_mul_f32 v245, v245, v173
    v_mul_f32 v246, v246, v174
    v_mul_f32 v247, v247, v175
    v_exp_f32 v240, v240
    v_exp_f32 v241, v241
    v_exp_f32 v242, v242
    v_exp_f32 v243, v243
    v_exp_f32 v244, v244
    v_exp_f32 v245, v245
    v_exp_f32 v246, v246
    v_exp_f32 v247, v247
    v_add_f32 v240, 1.0, v240
    v_add_f32 v241, 1.0, v241
    v_add_f32 v242, 1.0, v242
    v_add_f32 v243, 1.0, v243
    v_add_f32 v244, 1.0, v244
    v_add_f32 v245, 1.0, v245
    v_add_f32 v246, 1.0, v246
    v_add_f32 v247, 1.0, v247
    v_rcp_f32 v240, v240
    v_rcp_f32 v241, v241
    v_rcp_f32 v242, v242
    v_rcp_f32 v243, v243
    v_rcp_f32 v244, v244
    v_rcp_f32 v245, v245
    v_rcp_f32 v246, v246
    v_rcp_f32 v247, v247
    v_mul_f32 v168, v168, v240
    v_mul_f32 v169, v169, v241
    v_mul_f32 v170, v170, v242
    v_mul_f32 v171, v171, v243
    v_mul_f32 v172, v172, v244
    v_mul_f32 v173, v173, v245
    v_mul_f32 v174, v174, v246
    v_mul_f32 v175, v175, v247
    v_cvt_pk_bf16_f32 v168, v168, v169
    v_cvt_pk_bf16_f32 v169, v170, v171
    v_cvt_pk_bf16_f32 v170, v172, v173
    v_cvt_pk_bf16_f32 v171, v174, v175
    s_waitcnt vmcnt(15)
    v_max_f32_dpp v144, v144, v144 quad_perm:[1,0,3,2] row_mask:0xf bank_mask:0xf
    s_nop 1
    v_max_f32_dpp v144, v144, v144 quad_perm:[2,3,0,1] row_mask:0xf bank_mask:0xf
    s_nop 1
    v_max_f32_dpp v144, v144, v144 row_half_mirror row_mask:0xf bank_mask:0xf
    s_nop 1
    v_max_f32_dpp v144, v144, v144 row_mirror row_mask:0xf bank_mask:0xf
    v_mov_b32 v145, v144
    s_nop 1
    v_permlane16_swap_b32 v144, v145
    v_max_f32 v144, v144, v145
    v_mov_b32 v145, v144
    s_nop 1
    v_permlane32_swap_b32 v144, v145
    v_max_f32 v144, v144, v145
    v_dot2_f32_bf16 v146, v104, v104, 0
    v_dot2_f32_bf16 v146, v96, v96, v146
    v_dot2_f32_bf16 v146, v97, v97, v146
    v_dot2_f32_bf16 v146, v98, v98, v146
    v_dot2_f32_bf16 v146, v99, v99, v146
    v_dot2_f32_bf16 v147, v108, v108, 0
    v_dot2_f32_bf16 v147, v100, v100, v147
    v_dot2_f32_bf16 v147, v101, v101, v147
    v_dot2_f32_bf16 v147, v102, v102, v147
    v_dot2_f32_bf16 v147, v103, v103, v147
    s_nop 2
    v_mov_b32 v145, v146
    s_nop 1
    v_permlane32_swap_b32 v146, v145
    v_add_f32 v146, v146, v145
    v_mul_f32 v146, v146, v144
    v_sqrt_f32 v146, v146
    s_nop 0
    v_mul_f32 v146, 0xbf828f5c, v146
    v_mov_b32 v145, 0
    v_cvt_pk_bf16_f32 v146, v146, v145
    s_mov_b32 exec_lo, 0
    v_mov_b32 v104, v146
    s_mov_b32 exec_lo, -1
    v_mov_b32 v145, v147
    s_nop 1
    v_permlane32_swap_b32 v147, v145
    v_add_f32 v147, v147, v145
    v_mul_f32 v147, v147, v144
    v_sqrt_f32 v147, v147
    s_nop 0
    v_mul_f32 v147, 0xbf828f5c, v147
    v_mov_b32 v145, 0
    v_cvt_pk_bf16_f32 v147, v147, v145
    s_mov_b32 exec_lo, 0
    v_mov_b32 v108, v147
    s_mov_b32 exec_lo, -1
AT_GO:
    s_waitcnt vmcnt(10)
    s_barrier
    ds_read_b128 v[112:115], v2
    ds_read_b32 v120, v3
    ds_read_b128 v[116:119], v2 offset:2560
    ds_read_b32 v124, v3 offset:2560
    ds_read_b64_tr_b16 v[128:129], v4 offset:0
    ds_read_b64_tr_b16 v[130:131], v4 offset:128
    ds_read_b64_tr_b16 v[132:133], v4 offset:256
    ds_read_b64_tr_b16 v[134:135], v4 offset:384
    s_lshl_b32 s52, s3, 2
    s_add_u32 s52, s52, s32
    s_mul_i32 s50, s52, 2688
    s_mul_i32 s51, s52, 768
    v_lshlrev_b32 v153, 7, v1
    v_mov_b32 v154, 0x40000000
    v_cmp_gt_u32 vcc, 5, v1
    s_nop 1
    v_cndmask_b32 v152, v154, v153, vcc
    v_cmp_gt_u32 vcc, 2, v1
    s_nop 1
    v_cndmask_b32 v153, v154, v153, vcc
    s_waitcnt lgkmcnt(0)
    v_mfma_f32_32x32x8bf16_1k v[16:31], v[120:121], v[104:105], 0
    s_nop 9
    v_mfma_f32_32x32x16_bf16 v[16:31], v[112:115], v[96:99], v[16:31]
    s_mov_b32 s42, 0
    s_mov_b32 s43, 0
    s_nop 9
AT_LOOP:
    s_cmp_lg_u32 s42, 1
    s_cbranch_scc1 AT_KEEP
    s_setprio 1
AT_KEEP:
    v_mfma_f32_32x32x8bf16_1k v[32:47], v[120:121], v[108:109], 0
    v_exp_f32 v16, v16
    v_exp_f32 v17, v17
    v_exp_f32 v18, v18
    v_exp_f32 v19, v19
    v_cvt_pk_bf16_f32 v80, v16, v17
    v_cvt_pk_bf16_f32 v81, v18, v19
    v_mfma_f32_32x32x16_bf16 v[64:79], v[140:143], v[92:95], v[64:79]
    v_exp_f32 v20, v20
    v_exp_f32 v21, v21
    v_exp_f32 v22, v22
    v_exp_f32 v23, v23
    v_cvt_pk_bf16_f32 v82, v20, v21
    v_cvt_pk_bf16_f32 v83, v22, v23
    v_mfma_f32_32x32x16_bf16 v[32:47], v[112:115], v[100:103], v[32:47]
    v_exp_f32 v24, v24
    v_exp_f32 v25, v25
    v_exp_f32 v26, v26
    v_exp_f32 v27, v27
    v_cvt_pk_bf16_f32 v84, v24, v25
    v_cvt_pk_bf16_f32 v85, v26, v27
    s_waitcnt lgkmcnt(0)
    v_mfma_f32_32x32x16_bf16 v[48:63], v[128:131], v[80:83], v[48:63]
    ds_read_b128 v[112:115], v2 offset:5120
    ds_read_b32 v120, v3 offset:5120
    v_exp_f32 v28, v28
    v_exp_f32 v29, v29
    v_exp_f32 v30, v30
    v_exp_f32 v31, v31
    v_cvt_pk_bf16_f32 v86, v28, v29
    v_cvt_pk_bf16_f32 v87, v30, v31
    v_mfma_f32_32x32x8bf16_1k v[16:31], v[124:125], v[104:105], 0
    ds_read_b64_tr_b16 v[136:137], v4 offset:2560
    ds_read_b64_tr_b16 v[138:139], v4 offset:2688
    v_exp_f32 v32, v32
    v_exp_f32 v33, v33
    v_exp_f32 v34, v34
    v_exp_f32 v35, v35
    v_cvt_pk_bf16_f32 v88, v32, v33
    v_cvt_pk_bf16_f32 v89, v34, v35
    v_mfma_f32_32x32x16_bf16 v[48:63], v[132:135], v[84:87], v[48:63]
    ds_read_b64_tr_b16 v[140:141], v4 offset:2816
    ds_read_b64_tr_b16 v[142:143], v4 offset:2944
    v_exp_f32 v36, v36
    v_exp_f32 v37, v37
    v_exp_f32 v38, v38
    v_exp_f32 v39, v39
    v_cvt_pk_bf16_f32 v90, v36, v37
    v_cvt_pk_bf16_f32 v91, v38, v39
    v_mfma_f32_32x32x16_bf16 v[16:31], v[116:119], v[96:99], v[16:31]
    v_exp_f32 v40, v40
    v_exp_f32 v41, v41
    v_exp_f32 v42, v42
    v_exp_f32 v43, v43
    v_cvt_pk_bf16_f32 v92, v40, v41
    v_cvt_pk_bf16_f32 v93, v42, v43
    v_mfma_f32_32x32x16_bf16 v[64:79], v[128:131], v[88:91], v[64:79]
    v_exp_f32 v44, v44
    v_exp_f32 v45, v45
    v_exp_f32 v46, v46
    v_exp_f32 v47, v47
    v_cvt_pk_bf16_f32 v94, v44, v45
    v_cvt_pk_bf16_f32 v95, v46, v47
    v_mfma_f32_32x32x8bf16_1k v[32:47], v[124:125], v[108:109], 0
    v_exp_f32 v16, v16
    v_exp_f32 v17, v17
    v_exp_f32 v18, v18
    v_exp_f32 v19, v19
    v_cvt_pk_bf16_f32 v80, v16, v17
    v_cvt_pk_bf16_f32 v81, v18, v19
    v_mfma_f32_32x32x16_bf16 v[64:79], v[132:135], v[92:95], v[64:79]
    v_exp_f32 v20, v20
    v_exp_f32 v21, v21
    v_exp_f32 v22, v22
    v_exp_f32 v23, v23
    v_cvt_pk_bf16_f32 v82, v20, v21
    v_cvt_pk_bf16_f32 v83, v22, v23
    v_mfma_f32_32x32x16_bf16 v[32:47], v[116:119], v[100:103], v[32:47]
    v_exp_f32 v24, v24
    v_exp_f32 v25, v25
    v_exp_f32 v26, v26
    v_exp_f32 v27, v27
    v_cvt_pk_bf16_f32 v84, v24, v25
    v_cvt_pk_bf16_f32 v85, v26, v27
    s_waitcnt lgkmcnt(0)
    v_mfma_f32_32x32x16_bf16 v[48:63], v[136:139], v[80:83], v[48:63]
    ds_read_b128 v[116:119], v2 offset:7680
    ds_read_b32 v124, v3 offset:7680
    v_exp_f32 v28, v28
    v_exp_f32 v29, v29
    v_exp_f32 v30, v30
    v_exp_f32 v31, v31
    v_cvt_pk_bf16_f32 v86, v28, v29
    v_cvt_pk_bf16_f32 v87, v30, v31
    v_mfma_f32_32x32x8bf16_1k v[16:31], v[120:121], v[104:105], 0
    ds_read_b64_tr_b16 v[128:129], v4 offset:5120
    ds_read_b64_tr_b16 v[130:131], v4 offset:5248
    v_exp_f32 v32, v32
    v_exp_f32 v33, v33
    v_exp_f32 v34, v34
    v_exp_f32 v35, v35
    v_cvt_pk_bf16_f32 v88, v32, v33
    v_cvt_pk_bf16_f32 v89, v34, v35
    v_mfma_f32_32x32x16_bf16 v[48:63], v[140:143], v[84:87], v[48:63]
    ds_read_b64_tr_b16 v[132:133], v4 offset:5376
    ds_read_b64_tr_b16 v[134:135], v4 offset:5504
    v_exp_f32 v36, v36
    v_exp_f32 v37, v37
    v_exp_f32 v38, v38
    v_exp_f32 v39, v39
    v_cvt_pk_bf16_f32 v90, v36, v37
    v_cvt_pk_bf16_f32 v91, v38, v39
    v_mfma_f32_32x32x16_bf16 v[16:31], v[112:115], v[96:99], v[16:31]
    v_exp_f32 v40, v40
    v_exp_f32 v41, v41
    v_exp_f32 v42, v42
    v_exp_f32 v43, v43
    v_cvt_pk_bf16_f32 v92, v40, v41
    v_cvt_pk_bf16_f32 v93, v42, v43
    v_mfma_f32_32x32x16_bf16 v[64:79], v[136:139], v[88:91], v[64:79]
    v_exp_f32 v44, v44
    v_exp_f32 v45, v45
    v_exp_f32 v46, v46
    v_exp_f32 v47, v47
    v_cvt_pk_bf16_f32 v94, v44, v45
    v_cvt_pk_bf16_f32 v95, v46, v47
    v_mfma_f32_32x32x8bf16_1k v[32:47], v[120:121], v[108:109], 0
    v_exp_f32 v16, v16
    v_exp_f32 v17, v17
    v_exp_f32 v18, v18
    v_exp_f32 v19, v19
    v_cvt_pk_bf16_f32 v80, v16, v17
    v_cvt_pk_bf16_f32 v81, v18, v19
    v_mfma_f32_32x32x16_bf16 v[64:79], v[140:143], v[92:95], v[64:79]
    v_exp_f32 v20, v20
    v_exp_f32 v21, v21
    v_exp_f32 v22, v22
    v_exp_f32 v23, v23
    v_cvt_pk_bf16_f32 v82, v20, v21
    v_cvt_pk_bf16_f32 v83, v22, v23
    v_mfma_f32_32x32x16_bf16 v[32:47], v[112:115], v[100:103], v[32:47]
    v_exp_f32 v24, v24
    v_exp_f32 v25, v25
    v_exp_f32 v26, v26
    v_exp_f32 v27, v27
    v_cvt_pk_bf16_f32 v84, v24, v25
    v_cvt_pk_bf16_f32 v85, v26, v27
    s_waitcnt lgkmcnt(0)
    v_mfma_f32_32x32x16_bf16 v[48:63], v[128:131], v[80:83], v[48:63]
    ds_read_b128 v[112:115], v2 offset:10240
    ds_read_b32 v120, v3 offset:10240
    v_exp_f32 v28, v28
    v_exp_f32 v29, v29
    v_exp_f32 v30, v30
    v_exp_f32 v31, v31
    v_cvt_pk_bf16_f32 v86, v28, v29
    v_cvt_pk_bf16_f32 v87, v30, v31
    v_mfma_f32_32x32x8bf16_1k v[16:31], v[124:125], v[104:105], 0
    ds_read_b64_tr_b16 v[136:137], v4 offset:7680
    ds_read_b64_tr_b16 v[138:139], v4 offset:7808
    v_exp_f32 v32, v32
    v_exp_f32 v33, v33
    v_exp_f32 v34, v34
    v_exp_f32 v35, v35
    v_cvt_pk_bf16_f32 v88, v32, v33
    v_cvt_pk_bf16_f32 v89, v34, v35
    v_mfma_f32_32x32x16_bf16 v[48:63], v[132:135], v[84:87], v[48:63]
    ds_read_b64_tr_b16 v[140:141], v4 offset:7936
    ds_read_b64_tr_b16 v[142:143], v4 offset:8064
    v_exp_f32 v36, v36
    v_exp_f32 v37, v37
    v_exp_f32 v38, v38
    v_exp_f32 v39, v39
    v_cvt_pk_bf16_f32 v90, v36, v37
    v_cvt_pk_bf16_f32 v91, v38, v39
    v_mfma_f32_32x32x16_bf16 v[16:31], v[116:119], v[96:99], v[16:31]
    v_exp_f32 v40, v40
    v_exp_f32 v41, v41
    v_exp_f32 v42, v42
    v_exp_f32 v43, v43
    v_cvt_pk_bf16_f32 v92, v40, v41
    v_cvt_pk_bf16_f32 v93, v42, v43
    v_mfma_f32_32x32x16_bf16 v[64:79], v[128:131], v[88:91], v[64:79]
    v_exp_f32 v44, v44
    v_exp_f32 v45, v45
    v_exp_f32 v46, v46
    v_exp_f32 v47, v47
    v_cvt_pk_bf16_f32 v94, v44, v45
    v_cvt_pk_bf16_f32 v95, v46, v47
    v_mfma_f32_32x32x8bf16_1k v[32:47], v[124:125], v[108:109], 0
    v_exp_f32 v16, v16
    v_exp_f32 v17, v17
    v_exp_f32 v18, v18
    v_exp_f32 v19, v19
    v_cvt_pk_bf16_f32 v80, v16, v17
    v_cvt_pk_bf16_f32 v81, v18, v19
    v_mfma_f32_32x32x16_bf16 v[64:79], v[132:135], v[92:95], v[64:79]
    v_exp_f32 v20, v20
    v_exp_f32 v21, v21
    v_exp_f32 v22, v22
    v_exp_f32 v23, v23
    v_cvt_pk_bf16_f32 v82, v20, v21
    v_cvt_pk_bf16_f32 v83, v22, v23
    v_mfma_f32_32x32x16_bf16 v[32:47], v[116:119], v[100:103], v[32:47]
    v_exp_f32 v24, v24
    v_exp_f32 v25, v25
    v_exp_f32 v26, v26
    v_exp_f32 v27, v27
    v_cvt_pk_bf16_f32 v84, v24, v25
    v_cvt_pk_bf16_f32 v85, v26, v27
    s_waitcnt lgkmcnt(0)
    v_mfma_f32_32x32x16_bf16 v[48:63], v[136:139], v[80:83], v[48:63]
    ds_read_b128 v[116:119], v2 offset:12800
    ds_read_b32 v124, v3 offset:12800
    v_exp_f32 v28, v28
    v_exp_f32 v29, v29
    v_exp_f32 v30, v30
    v_exp_f32 v31, v31
    v_cvt_pk_bf16_f32 v86, v28, v29
    v_cvt_pk_bf16_f32 v87, v30, v31
    v_mfma_f32_32x32x8bf16_1k v[16:31], v[120:121], v[104:105], 0
    ds_read_b64_tr_b16 v[128:129], v4 offset:10240
    ds_read_b64_tr_b16 v[130:131], v4 offset:10368
    v_exp_f32 v32, v32
    v_exp_f32 v33, v33
    v_exp_f32 v34, v34
    v_exp_f32 v35, v35
    v_cvt_pk_bf16_f32 v88, v32, v33
    v_cvt_pk_bf16_f32 v89, v34, v35
    v_mfma_f32_32x32x16_bf16 v[48:63], v[140:143], v[84:87], v[48:63]
    ds_read_b64_tr_b16 v[132:133], v4 offset:10496
    ds_read_b64_tr_b16 v[134:135], v4 offset:10624
    v_exp_f32 v36, v36
    v_exp_f32 v37, v37
    v_exp_f32 v38, v38
    v_exp_f32 v39, v39
    v_cvt_pk_bf16_f32 v90, v36, v37
    v_cvt_pk_bf16_f32 v91, v38, v39
    v_mfma_f32_32x32x16_bf16 v[16:31], v[112:115], v[96:99], v[16:31]
    v_exp_f32 v40, v40
    v_exp_f32 v41, v41
    v_exp_f32 v42, v42
    v_exp_f32 v43, v43
    v_cvt_pk_bf16_f32 v92, v40, v41
    v_cvt_pk_bf16_f32 v93, v42, v43
    v_mfma_f32_32x32x16_bf16 v[64:79], v[136:139], v[88:91], v[64:79]
    v_exp_f32 v44, v44
    v_exp_f32 v45, v45
    v_exp_f32 v46, v46
    v_exp_f32 v47, v47
    v_cvt_pk_bf16_f32 v94, v44, v45
    v_cvt_pk_bf16_f32 v95, v46, v47
    v_mfma_f32_32x32x8bf16_1k v[32:47], v[120:121], v[108:109], 0
    v_exp_f32 v16, v16
    v_exp_f32 v17, v17
    v_exp_f32 v18, v18
    v_exp_f32 v19, v19
    v_cvt_pk_bf16_f32 v80, v16, v17
    v_cvt_pk_bf16_f32 v81, v18, v19
    v_mfma_f32_32x32x16_bf16 v[64:79], v[140:143], v[92:95], v[64:79]
    v_exp_f32 v20, v20
    v_exp_f32 v21, v21
    v_exp_f32 v22, v22
    v_exp_f32 v23, v23
    v_cvt_pk_bf16_f32 v82, v20, v21
    v_cvt_pk_bf16_f32 v83, v22, v23
    v_mfma_f32_32x32x16_bf16 v[32:47], v[112:115], v[100:103], v[32:47]
    v_exp_f32 v24, v24
    v_exp_f32 v25, v25
    v_exp_f32 v26, v26
    v_exp_f32 v27, v27
    v_cvt_pk_bf16_f32 v84, v24, v25
    v_cvt_pk_bf16_f32 v85, v26, v27
    s_waitcnt lgkmcnt(0)
    v_mfma_f32_32x32x16_bf16 v[48:63], v[128:131], v[80:83], v[48:63]
    ds_read_b128 v[112:115], v2 offset:15360
    ds_read_b32 v120, v3 offset:15360
    v_exp_f32 v28, v28
    v_exp_f32 v29, v29
    v_exp_f32 v30, v30
    v_exp_f32 v31, v31
    v_cvt_pk_bf16_f32 v86, v28, v29
    v_cvt_pk_bf16_f32 v87, v30, v31
    v_mfma_f32_32x32x8bf16_1k v[16:31], v[124:125], v[104:105], 0
    ds_read_b64_tr_b16 v[136:137], v4 offset:12800
    ds_read_b64_tr_b16 v[138:139], v4 offset:12928
    v_exp_f32 v32, v32
    v_exp_f32 v33, v33
    v_exp_f32 v34, v34
    v_exp_f32 v35, v35
    v_cvt_pk_bf16_f32 v88, v32, v33
    v_cvt_pk_bf16_f32 v89, v34, v35
    v_mfma_f32_32x32x16_bf16 v[48:63], v[132:135], v[84:87], v[48:63]
    ds_read_b64_tr_b16 v[140:141], v4 offset:13056
    ds_read_b64_tr_b16 v[142:143], v4 offset:13184
    v_exp_f32 v36, v36
    v_exp_f32 v37, v37
    v_exp_f32 v38, v38
    v_exp_f32 v39, v39
    v_cvt_pk_bf16_f32 v90, v36, v37
    v_cvt_pk_bf16_f32 v91, v38, v39
    v_mfma_f32_32x32x16_bf16 v[16:31], v[116:119], v[96:99], v[16:31]
    v_exp_f32 v40, v40
    v_exp_f32 v41, v41
    v_exp_f32 v42, v42
    v_exp_f32 v43, v43
    v_cvt_pk_bf16_f32 v92, v40, v41
    v_cvt_pk_bf16_f32 v93, v42, v43
    v_mfma_f32_32x32x16_bf16 v[64:79], v[128:131], v[88:91], v[64:79]
    v_exp_f32 v44, v44
    v_exp_f32 v45, v45
    v_exp_f32 v46, v46
    v_exp_f32 v47, v47
    v_cvt_pk_bf16_f32 v94, v44, v45
    v_cvt_pk_bf16_f32 v95, v46, v47
    v_mfma_f32_32x32x8bf16_1k v[32:47], v[124:125], v[108:109], 0
    v_exp_f32 v16, v16
    v_exp_f32 v17, v17
    v_exp_f32 v18, v18
    v_exp_f32 v19, v19
    v_cvt_pk_bf16_f32 v80, v16, v17
    v_cvt_pk_bf16_f32 v81, v18, v19
    v_mfma_f32_32x32x16_bf16 v[64:79], v[132:135], v[92:95], v[64:79]
    v_exp_f32 v20, v20
    v_exp_f32 v21, v21
    v_exp_f32 v22, v22
    v_exp_f32 v23, v23
    v_cvt_pk_bf16_f32 v82, v20, v21
    v_cvt_pk_bf16_f32 v83, v22, v23
    v_mfma_f32_32x32x16_bf16 v[32:47], v[116:119], v[100:103], v[32:47]
    v_exp_f32 v24, v24
    v_exp_f32 v25, v25
    v_exp_f32 v26, v26
    v_exp_f32 v27, v27
    v_cvt_pk_bf16_f32 v84, v24, v25
    v_cvt_pk_bf16_f32 v85, v26, v27
    s_waitcnt lgkmcnt(0)
    v_mfma_f32_32x32x16_bf16 v[48:63], v[136:139], v[80:83], v[48:63]
    ds_read_b128 v[116:119], v2 offset:17920
    ds_read_b32 v124, v3 offset:17920
    v_exp_f32 v28, v28
    v_exp_f32 v29, v29
    v_exp_f32 v30, v30
    v_exp_f32 v31, v31
    v_cvt_pk_bf16_f32 v86, v28, v29
    v_cvt_pk_bf16_f32 v87, v30, v31
    v_mfma_f32_32x32x8bf16_1k v[16:31], v[120:121], v[104:105], 0
    ds_read_b64_tr_b16 v[128:129], v4 offset:15360
    ds_read_b64_tr_b16 v[130:131], v4 offset:15488
    v_exp_f32 v32, v32
    v_exp_f32 v33, v33
    v_exp_f32 v34, v34
    v_exp_f32 v35, v35
    v_cvt_pk_bf16_f32 v88, v32, v33
    v_cvt_pk_bf16_f32 v89, v34, v35
    v_mfma_f32_32x32x16_bf16 v[48:63], v[140:143], v[84:87], v[48:63]
    ds_read_b64_tr_b16 v[132:133], v4 offset:15616
    ds_read_b64_tr_b16 v[134:135], v4 offset:15744
    v_exp_f32 v36, v36
    v_exp_f32 v37, v37
    v_exp_f32 v38, v38
    v_exp_f32 v39, v39
    v_cvt_pk_bf16_f32 v90, v36, v37
    v_cvt_pk_bf16_f32 v91, v38, v39
    v_mfma_f32_32x32x16_bf16 v[16:31], v[112:115], v[96:99], v[16:31]
    v_exp_f32 v40, v40
    v_exp_f32 v41, v41
    v_exp_f32 v42, v42
    v_exp_f32 v43, v43
    v_cvt_pk_bf16_f32 v92, v40, v41
    v_cvt_pk_bf16_f32 v93, v42, v43
    v_mfma_f32_32x32x16_bf16 v[64:79], v[136:139], v[88:91], v[64:79]
    v_exp_f32 v44, v44
    v_exp_f32 v45, v45
    v_exp_f32 v46, v46
    v_exp_f32 v47, v47
    v_cvt_pk_bf16_f32 v94, v44, v45
    v_cvt_pk_bf16_f32 v95, v46, v47
    v_mfma_f32_32x32x8bf16_1k v[32:47], v[120:121], v[108:109], 0
    v_exp_f32 v16, v16
    v_exp_f32 v17, v17
    v_exp_f32 v18, v18
    v_exp_f32 v19, v19
    v_cvt_pk_bf16_f32 v80, v16, v17
    v_cvt_pk_bf16_f32 v81, v18, v19
    v_mfma_f32_32x32x16_bf16 v[64:79], v[140:143], v[92:95], v[64:79]
    v_exp_f32 v20, v20
    v_exp_f32 v21, v21
    v_exp_f32 v22, v22
    v_exp_f32 v23, v23
    v_cvt_pk_bf16_f32 v82, v20, v21
    v_cvt_pk_bf16_f32 v83, v22, v23
    v_mfma_f32_32x32x16_bf16 v[32:47], v[112:115], v[100:103], v[32:47]
    v_exp_f32 v24, v24
    v_exp_f32 v25, v25
    v_exp_f32 v26, v26
    v_exp_f32 v27, v27
    v_cvt_pk_bf16_f32 v84, v24, v25
    v_cvt_pk_bf16_f32 v85, v26, v27
    s_waitcnt lgkmcnt(0)
    v_mfma_f32_32x32x16_bf16 v[48:63], v[128:131], v[80:83], v[48:63]
    s_cmp_ge_u32 s42, 5
    s_cbranch_scc1 AT_NODMA
    s_waitcnt vmcnt(5)
    s_barrier
    s_or_b32 s44, s42, s39
    s_cmp_lg_u32 s44, 0
    s_cbranch_scc1 AT_NZS
    buffer_store_dwordx4 v[176:179], v248, s[20:23], s61 offen offset:0 sc1
    buffer_store_dwordx4 v[184:187], v248, s[20:23], s61 offen offset:1024 sc1
    buffer_store_dwordx4 v[192:195], v248, s[20:23], s61 offen offset:2048 sc1
    buffer_store_dwordx4 v[200:203], v248, s[20:23], s61 offen offset:3072 sc1
    buffer_store_dwordx4 v[208:211], v250, s[20:23], s61 offen offset:0 sc1
    buffer_store_dwordx4 v[216:219], v250, s[20:23], s61 offen offset:1024 sc1
    buffer_store_dwordx4 v[224:227], v250, s[20:23], s61 offen offset:2048 sc1
    buffer_store_dwordx4 v[232:235], v250, s[20:23], s61 offen offset:3072 sc1
    buffer_store_dwordx4 v[168:171], v251, s[20:23], s61 offen offset:0 sc1
AT_NZS:
    s_cmp_lg_u32 s42, 1
    s_cbranch_scc1 AT_LF
    s_cmp_lg_u32 s32, 0
    s_cbranch_scc1 AT_LF
    v_mov_b32 v148, 0
    v_mov_b32 v149, 1
    s_mov_b64 exec, 1
    buffer_store_dword v149, v148, s[20:23], s60 offen sc1
    s_mov_b64 exec, -1
AT_LF:
    buffer_load_dword v154, v152, s[12:15], s50 offen
    buffer_load_dword v155, v153, s[8:11], s51 offen
    s_add_u32 s50, s50, 640
    s_add_u32 s51, s51, 256
    s_mov_b32 m0, s40
    s_add_u32 s41, s34, 4096
    buffer_load_dwordx4 v5, s[20:23], s34 offen sc1 lds
    buffer_load_dwordx4 v5, s[20:23], s34 offen offset:1024 sc1 lds
    buffer_load_dwordx4 v5, s[20:23], s34 offen offset:2048 sc1 lds
    buffer_load_dwordx4 v5, s[20:23], s34 offen offset:3072 sc1 lds
    s_add_u32 m0, s40, 4096
    s_add_u32 s34, s34, 20480
    buffer_load_dwordx4 v5, s[20:23], s41 offen sc1 lds
    s_add_u32 s40, s40, 20480
    s_sub_u32 s41, s40, 81920
    s_cmp_ge_u32 s40, 81920
    s_cselect_b32 s40, s41, s40
    s_branch AT_DMADONE
AT_NODMA:
    s_waitcnt vmcnt(0)
    s_barrier
AT_DMADONE:
    s_add_u32 s43, s43, 20480
    s_mov_b32 s44, 20480
    s_cmp_ge_u32 s43, 81920
    s_cselect_b32 s44, 4294905856, s44
    s_cselect_b32 s43, 0, s43
    v_add_u32 v2, s44, v2
    v_add_u32 v3, s44, v3
    ds_read_b128 v[112:115], v2 offset:0
    ds_read_b32 v120, v3 offset:0
    v_exp_f32 v28, v28
    v_exp_f32 v29, v29
    v_exp_f32 v30, v30
    v_exp_f32 v31, v31
    v_cvt_pk_bf16_f32 v86, v28, v29
    v_cvt_pk_bf16_f32 v87, v30, v31
    v_mfma_f32_32x32x8bf16_1k v[16:31], v[124:125], v[104:105], 0
    ds_read_b64_tr_b16 v[136:137], v4 offset:17920
    ds_read_b64_tr_b16 v[138:139], v4 offset:18048
    v_exp_f32 v32, v32
    v_exp_f32 v33, v33
    v_exp_f32 v34, v34
    v_exp_f32 v35, v35
    v_cvt_pk_bf16_f32 v88, v32, v33
    v_cvt_pk_bf16_f32 v89, v34, v35
    v_mfma_f32_32x32x16_bf16 v[48:63], v[132:135], v[84:87], v[48:63]
    ds_read_b64_tr_b16 v[140:141], v4 offset:18176
    ds_read_b64_tr_b16 v[142:143], v4 offset:18304
    v_exp_f32 v36, v36
    v_exp_f32 v37, v37
    v_exp_f32 v38, v38
    v_exp_f32 v39, v39
    v_cvt_pk_bf16_f32 v90, v36, v37
    v_cvt_pk_bf16_f32 v91, v38, v39
    v_mfma_f32_32x32x16_bf16 v[16:31], v[116:119], v[96:99], v[16:31]
    v_exp_f32 v40, v40
    v_exp_f32 v41, v41
    v_exp_f32 v42, v42
    v_exp_f32 v43, v43
    v_cvt_pk_bf16_f32 v92, v40, v41
    v_cvt_pk_bf16_f32 v93, v42, v43
    v_mfma_f32_32x32x16_bf16 v[64:79], v[128:131], v[88:91], v[64:79]
    v_exp_f32 v44, v44
    v_exp_f32 v45, v45
    v_exp_f32 v46, v46
    v_exp_f32 v47, v47
    v_cvt_pk_bf16_f32 v94, v44, v45
    v_cvt_pk_bf16_f32 v95, v46, v47
    v_mfma_f32_32x32x8bf16_1k v[32:47], v[124:125], v[108:109], 0
    v_exp_f32 v16, v16
    v_exp_f32 v17, v17
    v_exp_f32 v18, v18
    v_exp_f32 v19, v19
    v_cvt_pk_bf16_f32 v80, v16, v17
    v_cvt_pk_bf16_f32 v81, v18, v19
    v_mfma_f32_32x32x16_bf16 v[64:79], v[132:135], v[92:95], v[64:79]
    v_exp_f32 v20, v20
    v_exp_f32 v21, v21
    v_exp_f32 v22, v22
    v_exp_f32 v23, v23
    v_cvt_pk_bf16_f32 v82, v20, v21
    v_cvt_pk_bf16_f32 v83, v22, v23
    v_mfma_f32_32x32x16_bf16 v[32:47], v[116:119], v[100:103], v[32:47]
    v_exp_f32 v24, v24
    v_exp_f32 v25, v25
    v_exp_f32 v26, v26
    v_exp_f32 v27, v27
    v_cvt_pk_bf16_f32 v84, v24, v25
    v_cvt_pk_bf16_f32 v85, v26, v27
    s_waitcnt lgkmcnt(0)
    v_mfma_f32_32x32x16_bf16 v[48:63], v[136:139], v[80:83], v[48:63]
    v_add_u32 v4, s44, v4
    ds_read_b128 v[116:119], v2 offset:2560
    ds_read_b32 v124, v3 offset:2560
    v_exp_f32 v28, v28
    v_exp_f32 v29, v29
    v_exp_f32 v30, v30
    v_exp_f32 v31, v31
    v_cvt_pk_bf16_f32 v86, v28, v29
    v_cvt_pk_bf16_f32 v87, v30, v31
    v_mfma_f32_32x32x8bf16_1k v[16:31], v[120:121], v[104:105], 0
    ds_read_b64_tr_b16 v[128:129], v4 offset:0
    ds_read_b64_tr_b16 v[130:131], v4 offset:128
    v_exp_f32 v32, v32
    v_exp_f32 v33, v33
    v_exp_f32 v34, v34
    v_exp_f32 v35, v35
    v_cvt_pk_bf16_f32 v88, v32, v33
    v_cvt_pk_bf16_f32 v89, v34, v35
    v_mfma_f32_32x32x16_bf16 v[48:63], v[140:143], v[84:87], v[48:63]
    ds_read_b64_tr_b16 v[132:133], v4 offset:256
    ds_read_b64_tr_b16 v[134:135], v4 offset:384
    v_exp_f32 v36, v36
    v_exp_f32 v37, v37
    v_exp_f32 v38, v38
    v_exp_f32 v39, v39
    v_cvt_pk_bf16_f32 v90, v36, v37
    v_cvt_pk_bf16_f32 v91, v38, v39
    v_mfma_f32_32x32x16_bf16 v[16:31], v[112:115], v[96:99], v[16:31]
    v_exp_f32 v40, v40
    v_exp_f32 v41, v41
    v_exp_f32 v42, v42
    v_exp_f32 v43, v43
    v_cvt_pk_bf16_f32 v92, v40, v41
    v_cvt_pk_bf16_f32 v93, v42, v43
    v_mfma_f32_32x32x16_bf16 v[64:79], v[136:139], v[88:91], v[64:79]
    v_exp_f32 v44, v44
    v_exp_f32 v45, v45
    v_exp_f32 v46, v46
    v_exp_f32 v47, v47
    v_cvt_pk_bf16_f32 v94, v44, v45
    v_cvt_pk_bf16_f32 v95, v46, v47
    s_add_u32 s42, s42, 1
    s_cmp_lt_u32 s42, 8
    s_cbranch_scc1 AT_LOOP
    v_mfma_f32_32x32x16_bf16 v[64:79], v[140:143], v[92:95], v[64:79]
    v_mov_b32 v144, v58
    s_nop 10
    v_mov_b32 v145, v74
    v_permlane32_swap_b32 v58, v144
    s_nop 0
    v_permlane32_swap_b32 v74, v145
    s_mov_b32 s44, 0x1c800000
    v_cmp_nle_f32 vcc, s44, v58
    v_cmp_nle_f32 s[46:47], s44, v74
    s_nop 1
    s_or_b64 vcc, vcc, s[46:47]
    s_cselect_b32 s44, 1, 0
    v_mov_b32 v146, s44
    v_lshlrev_b32 v147, 2, v6
    ds_write_b32 v147, v146 offset:20480
    s_mul_i32 s44, s36, 36864
    s_add_u32 s44, s44, 4718592
    s_lshl_b32 s45, s30, 10
    s_add_u32 s45, s45, s44
    s_add_u32 s46, s45, 36864
    s_lshr_b32 s47, s30, 2
    s_lshl_b32 s47, s47, 9
    s_and_b32 s48, s30, 3
    s_lshl_b32 s48, s48, 2
    s_add_u32 s47, s47, s48
    s_add_u32 s47, s47, s44
    s_add_u32 s47, s47, 32768
    s_add_u32 s48, s47, 36864
    v_rcp_f32 v144, v58
    v_rcp_f32 v145, v74
    v_mul_f32 v48, v48, v144
    v_mul_f32 v49, v49, v144
    v_mul_f32 v50, v50, v144
    v_mul_f32 v51, v51, v144
    v_mul_f32 v52, v52, v144
    v_mul_f32 v53, v53, v144
    v_mul_f32 v54, v54, v144
    v_mul_f32 v55, v55, v144
    v_mul_f32 v56, v56, v144
    v_mul_f32 v57, v57, v144
    v_cvt_pk_bf16_f32 v80, v48, v49
    v_cvt_pk_bf16_f32 v81, v50, v51
    v_cvt_pk_bf16_f32 v82, v52, v53
    v_cvt_pk_bf16_f32 v83, v54, v55
    v_cvt_pk_bf16_f32 v84, v56, v57
    buffer_store_dwordx4 v[80:83], v5, s[20:23], s45 offen sc1
    v_mul_f32 v64, v64, v145
    v_mul_f32 v65, v65, v145
    v_mul_f32 v66, v66, v145
    v_mul_f32 v67, v67, v145
    v_mul_f32 v68, v68, v145
    v_mul_f32 v69, v69, v145
    v_mul_f32 v70, v70, v145
    v_mul_f32 v71, v71, v145
    v_mul_f32 v72, v72, v145
    v_mul_f32 v73, v73, v145
    v_cvt_pk_bf16_f32 v88, v64, v65
    v_cvt_pk_bf16_f32 v89, v66, v67
    v_cvt_pk_bf16_f32 v90, v68, v69
    v_cvt_pk_bf16_f32 v91, v70, v71
    v_cvt_pk_bf16_f32 v92, v72, v73
    buffer_store_dwordx4 v[88:91], v5, s[20:23], s46 offen sc1
    s_mov_b32 exec_hi, 0
    buffer_store_dword v84, v5, s[20:23], s47 offen sc1
    buffer_store_dword v92, v5, s[20:23], s48 offen sc1
    s_mov_b32 exec_hi, -1
    v_mov_b32 v145, 0
    s_waitcnt vmcnt(0) lgkmcnt(0)
    s_barrier
    s_cmp_lg_u32 s39, 0
    s_cbranch_scc1 AT_OUT
    ds_read_b128 v[146:149], v145 offset:20480
    s_waitcnt lgkmcnt(0)
    v_or_b32 v146, v146, v147
    v_or3_b32 v146, v146, v148, v149
    s_nop 0
    v_readfirstlane_b32 s44, v146
    s_nop 1
    s_cmp_eq_u32 s44, 0
    s_cbranch_scc1 AT_OUT
    s_barrier
    s_mov_b32 s39, 1
    s_mov_b32 exec_lo, 0
    v_mov_b32 v104, 0
    v_mov_b32 v108, 0
    s_mov_b32 exec_lo, -1
    v_mov_b32 v144, 0xff800000
    v_mov_b32 v145, 0xff800000
    s_mov_b32 s44, s33
    s_mov_b32 s45, 0
AT_MAXL:
    buffer_load_dwordx4 v[112:115], v5, s[20:23], s44 offen sc1
    buffer_load_dword v120, v14, s[20:23], s44 offen offset:2048 sc1
    s_waitcnt vmcnt(0)
    v_mfma_f32_32x32x8bf16_1k v[16:31], v[120:121], v[104:105], 0
    v_mfma_f32_32x32x8bf16_1k v[32:47], v[120:121], v[108:109], 0
    s_nop 8
    v_mfma_f32_32x32x16_bf16 v[16:31], v[112:115], v[96:99], v[16:31]
    v_mfma_f32_32x32x16_bf16 v[32:47], v[112:115], v[100:103], v[32:47]
    s_nop 10
    v_max3_f32 v144, v16, v17, v144
    v_max3_f32 v144, v18, v19, v144
    v_max3_f32 v144, v20, v21, v144
    v_max3_f32 v144, v22, v23, v144
    v_max3_f32 v144, v24, v25, v144
    v_max3_f32 v144, v26, v27, v144
    v_max3_f32 v144, v28, v29, v144
    v_max3_f32 v144, v30, v31, v144
    v_max3_f32 v145, v32, v33, v145
    v_max3_f32 v145, v34, v35, v145
    v_max3_f32 v145, v36, v37, v145
    v_max3_f32 v145, v38, v39, v145
    v_max3_f32 v145, v40, v41, v145
    v_max3_f32 v145, v42, v43, v145
    v_max3_f32 v145, v44, v45, v145
    v_max3_f32 v145, v46, v47, v145
    s_add_u32 s44, s44, 2560
    s_add_u32 s45, s45, 1
    s_cmp_lt_u32 s45, 64
    s_cbranch_scc1 AT_MAXL
    v_mov_b32 v146, v144
    s_nop 1
    v_permlane32_swap_b32 v144, v146
    v_max_f32 v144, v144, v146
    v_sub_f32 v144, 0, v144
    v_cvt_pk_bf16_f32 v146, v144, v144
    v_lshlrev_b32 v146, 16, v146
    v_sub_f32 v147, v144, v146
    v_cvt_pk_bf16_f32 v146, v146, v147
    s_mov_b32 exec_lo, 0
    v_mov_b32 v104, v146
    s_mov_b32 exec_lo, -1
    v_mov_b32 v146, v145
    s_nop 1
    v_permlane32_swap_b32 v145, v146
    v_max_f32 v145, v145, v146
    v_sub_f32 v145, 0, v145
    v_cvt_pk_bf16_f32 v146, v145, v145
    v_lshlrev_b32 v146, 16, v146
    v_sub_f32 v147, v145, v146
    v_cvt_pk_bf16_f32 v146, v146, v147
    s_mov_b32 exec_lo, 0
    v_mov_b32 v108, v146
    s_mov_b32 exec_lo, -1
    s_branch AT_PASS
AT_OUT:
    s_cmp_lg_u32 s32, 0
    s_cbranch_scc1 K2_NOSIG2
    s_lshl_b32 s31, s31, 7
    s_lshl_b32 s30, s30, 2
    s_add_u32 s30, s30, s31
    s_add_u32 s30, s30, 12601344
    v_mov_b32 v1, 0
    v_mov_b32 v2, 1
    s_mov_b64 exec, 1
    buffer_store_dword v2, v1, s[20:23], s30 offen sc1
    s_mov_b64 exec, -1
K2_NOSIG2:
K2_END:
    s_endpgm
ALL_CODE_END:
    s_endpgm
.section .rodata,"a"
.p2align 6
.amdhsa_kernel k0_prep_kernel
  .amdhsa_next_free_vgpr 64
  .amdhsa_next_free_sgpr 96
  .amdhsa_accum_offset 64
  .amdhsa_group_segment_fixed_size 0
  .amdhsa_kernarg_size 88
  .amdhsa_user_sgpr_count 2
  .amdhsa_user_sgpr_kernarg_segment_ptr 1
  .amdhsa_system_sgpr_workgroup_id_x 1
.end_amdhsa_kernel
.p2align 6
.amdhsa_kernel k2_mix_kernel
  .amdhsa_next_free_vgpr 256
  .amdhsa_next_free_sgpr 102
  .amdhsa_accum_offset 256
  .amdhsa_group_segment_fixed_size 0
  .amdhsa_kernarg_size 88
  .amdhsa_user_sgpr_count 2
  .amdhsa_user_sgpr_kernarg_segment_ptr 1
  .amdhsa_system_sgpr_workgroup_id_x 1
.end_amdhsa_kernel
```
